```python
import torch

def _softmax(x, axis=-1):
    return torch.softmax(x, dim=axis)
def _gelu(x):
    return torch.nn.functional.gelu(x, approximate="tanh")
def _silu(x):
    return torch.nn.functional.silu(x)
def _sigmoid(x):
    return torch.sigmoid(x)
def _layernorm(x, axis=-1, eps=1e-5):
    m = x.mean(dim=axis, keepdim=True)
    v = x.var(dim=axis, keepdim=True, unbiased=False)
    return (x - m) / torch.sqrt(v + eps)
def _scatter_add(tgt, idx, src, axis=0):
    return tgt.clone().index_add_(axis, idx, src)
def _segment_sum(src, seg, n):
    out = torch.zeros((n,) + src.shape[1:], dtype=src.dtype)
    return out.index_add_(0, seg, src)
def _pad(x, pw):
    flat = tuple(v for pair in reversed(pw) for v in pair)
    return torch.nn.functional.pad(x, flat)

kernel_name = 'parallel_sum__ssm_conv_h3__dense_activation_relu__prompt'

def setup_inputs():

    _w = (lambda a: (lambda t: t.to(torch.bfloat16) if t.is_floating_point() else t)(torch.as_tensor(a)))
    def _A_setup():
        B, S, D = 1, 2048, 1024
        ks = 4
        return {
            "q": _w((lambda *s: torch.randn(*s, dtype=torch.bfloat16) * 0.05)(B, S, D)),
            "k": _w((lambda *s: torch.randn(*s, dtype=torch.bfloat16) * 0.8)(B, S, D)),
            "v": _w((lambda *s: torch.randn(*s, dtype=torch.bfloat16) * 0.8)(B, S, D)),
            "shift_k": _w((lambda *s: torch.randn(*s, dtype=torch.bfloat16) * 0.8)(D, ks) * 0.5),
            "ssm_k": _w((lambda *s: torch.randn(*s, dtype=torch.bfloat16) * 0.8)(D, S) * (1.0 / S ** 0.5)),
            "ssm_D": _w((lambda *s: torch.randn(*s, dtype=torch.bfloat16) * 0.8)(D)),
        }
    _A_in = _A_setup()

    def _B_setup():
        B, S, D, Dff = 1, 2048, 1024, 3584
        return {
            "x": _w((lambda *s: torch.randn(*s, dtype=torch.bfloat16) * 0.05)(B, S, D)),
            "w1": _w((lambda *s: torch.randn(*s, dtype=torch.bfloat16) * 0.05)(D, Dff)),
            "w2": _w((lambda *s: torch.randn(*s, dtype=torch.bfloat16) * 0.05)(Dff, D)),
        }
    _B_in = _B_setup()

    return {
        "A_q": _A_in["q"],
        "A_k": _A_in["k"],
        "A_v": _A_in["v"],
        "A_shift_k": _A_in["shift_k"],
        "A_ssm_k": _A_in["ssm_k"],
        "A_ssm_D": _A_in["ssm_D"],
        "B_x": _B_in["x"],
        "B_w1": _B_in["w1"],
        "B_w2": _B_in["w2"],
    }

def reference(A_q, A_k, A_v, A_shift_k, A_ssm_k, A_ssm_D, B_x, B_w1, B_w2):
    def _A_ref(q, k, v, shift_k, ssm_k, ssm_D):
        B, S, D = q.shape
        ks = shift_k.shape[-1]
        k_pad = _pad(k, ((0, 0), (ks - 1, 0), (0, 0)))
        k_shift = torch.zeros_like(k)
        for t in range(ks):
            k_shift = k_shift + k_pad[:, t:t + S, :] * shift_k[:, ks - 1 - t][None, None, :]
        kv = k_shift * v
        L = 2 * S
        kv_pad = _pad(kv, ((0, 0), (0, S), (0, 0)))
        kf_pad = _pad(ssm_k, ((0, 0), (0, S)))
        kv_f = (lambda x, axes=(-2,-1): torch.fft.rfft2(x.float(), dim=axes))(kv_pad[:, None, :, :], axes=(1, 2))
        kf_f = (lambda x, axes=(-2,-1): torch.fft.rfft2(x.float(), dim=axes))(kf_pad[:, None, :], axes=(1, 2))
        kf_f = (lambda x, *d: x.permute(*d))(kf_f, 1, 2, 0)
        y_f = kv_f * kf_f[None, :, :, :]
        y = (lambda x, s, axes=(-2,-1): torch.fft.irfft2(x, s=s, dim=axes).to(torch.bfloat16))(y_f, (1, L), axes=(1, 2))[:, 0, :S, :]
        y = y + kv * ssm_D[None, None, :]
        return q * y

    def _B_ref(x, w1, w2):
        h = torch.einsum("bsd,df->bsf", x, w1)
        zero = torch.zeros_like(h)
        h = torch.maximum(h, zero)
        return torch.einsum("bsf,fd->bsd", h, w2)

    x = A_q
    xn = _layernorm(x, axis=-1)
    return x + _A_ref(xn, A_k, A_v, A_shift_k, A_ssm_k, A_ssm_D) + _B_ref(xn, B_w1, B_w2)
```

```asm
; @launch grid=(256,1,1) block=(512,1,1) lds=163840
.amdgcn_target "amdgcn-amd-amdhsa--gfx950"
.text
.globl parallel_sum__ssm_conv_h3__dense_activation_relu__prompt_kernel
.p2align 8
.type parallel_sum__ssm_conv_h3__dense_activation_relu__prompt_kernel,@function
parallel_sum__ssm_conv_h3__dense_activation_relu__prompt_kernel:

    s_cmp_ge_u32 s2, 256
    s_cbranch_scc1 L_end
    s_load_dwordx16 s[76:91], s[0:1], 0
    s_load_dwordx8 s[92:99], s[0:1], 64
    v_lshrrev_b32 v1, 6, v0
    s_nop 0
    v_readfirstlane_b32 s3, v1
    v_and_b32 v0, 63, v0
    s_and_b32 s12, s2, 7
    s_lshr_b32 s13, s2, 3
    s_and_b32 s14, s12, 1
    s_lshl_b32 s14, s14, 3
    s_and_b32 s4, s13, 7
    s_add_u32 s14, s14, s4
    s_lshr_b32 s15, s12, 1
    s_lshl_b32 s15, s15, 2
    s_lshr_b32 s4, s13, 3
    s_add_u32 s15, s15, s4
    s_lshr_b32 s16, s15, 3
    s_mov_b32 s17, s14
    s_add_u32 s18, s15, 0
    s_and_b32 s18, s18, 7
    s_add_u32 s19, s14, s15
    s_and_b32 s19, s19, 15
    s_cmp_ge_u32 s3, 4
    s_cbranch_scc0 L_consumer
    s_sub_u32 s40, s3, 4
    v_lshrrev_b32 v2, 3, v0
    v_and_b32 v3, 7, v0
    s_lshl_b32 s41, s14, 7
    s_lshl_b32 s42, s40, 5
    s_add_u32 s41, s41, s42
    v_lshrrev_b32 v5, 1, v2
    v_xor_b32 v1, v5, v3
    v_lshlrev_b32 v1, 4, v1
    v_xor_b32 v7, 64, v1
    v_add_u32 v6, s41, v2
    v_lshlrev_b32 v6, 11, v6
    v_add_u32 v8, v6, v1
    v_add_u32 v9, v6, v7
    v_add_u32 v9, 15360, v9
    v_add_u32 v10, v6, v1
    v_add_u32 v10, 30720, v10
    v_add_u32 v11, v6, v7
    v_add_u32 v11, 46080, v11
    s_mul_i32 s42, s15, 448
    s_lshl_b32 s43, s40, 4
    s_movk_i32 s46, 7168
    v_add_u32 v4, 0, v0
    v_mul_u32_u24 v5, 2341, v4
    v_lshrrev_b32 v5, 16, v5
    v_mul_u32_u24 v6, 28, v5
    v_sub_u32 v6, v4, v6
    v_lshrrev_b32 v7, 2, v5
    v_and_b32 v7, 2, v7
    v_xor_b32 v6, v6, v7
    v_lshlrev_b32 v6, 4, v6
    v_add_u32 v5, s43, v5
    v_mul_lo_u32 v5, v5, s46
    v_add3_u32 v5, v5, v6, s42
    v_subrev_u32 v12, 0, v5
    v_add_u32 v4, 64, v0
    v_mul_u32_u24 v5, 2341, v4
    v_lshrrev_b32 v5, 16, v5
    v_mul_u32_u24 v6, 28, v5
    v_sub_u32 v6, v4, v6
    v_lshrrev_b32 v7, 2, v5
    v_and_b32 v7, 2, v7
    v_xor_b32 v6, v6, v7
    v_lshlrev_b32 v6, 4, v6
    v_add_u32 v5, s43, v5
    v_mul_lo_u32 v5, v5, s46
    v_add3_u32 v5, v5, v6, s42
    v_subrev_u32 v13, 1024, v5
    v_add_u32 v4, 128, v0
    v_mul_u32_u24 v5, 2341, v4
    v_lshrrev_b32 v5, 16, v5
    v_mul_u32_u24 v6, 28, v5
    v_sub_u32 v6, v4, v6
    v_lshrrev_b32 v7, 2, v5
    v_and_b32 v7, 2, v7
    v_xor_b32 v6, v6, v7
    v_lshlrev_b32 v6, 4, v6
    v_add_u32 v5, s43, v5
    v_mul_lo_u32 v5, v5, s46
    v_add3_u32 v5, v5, v6, s42
    v_subrev_u32 v14, 2048, v5
    v_add_u32 v4, 192, v0
    v_mul_u32_u24 v5, 2341, v4
    v_lshrrev_b32 v5, 16, v5
    v_mul_u32_u24 v6, 28, v5
    v_sub_u32 v6, v4, v6
    v_lshrrev_b32 v7, 2, v5
    v_and_b32 v7, 2, v7
    v_xor_b32 v6, v6, v7
    v_lshlrev_b32 v6, 4, v6
    v_add_u32 v5, s43, v5
    v_mul_lo_u32 v5, v5, s46
    v_add3_u32 v5, v5, v6, s42
    v_subrev_u32 v15, 3072, v5
    v_add_u32 v4, 256, v0
    v_mul_u32_u24 v5, 2341, v4
    v_lshrrev_b32 v5, 16, v5
    v_mul_u32_u24 v6, 28, v5
    v_sub_u32 v6, v4, v6
    v_lshrrev_b32 v7, 2, v5
    v_and_b32 v7, 2, v7
    v_xor_b32 v6, v6, v7
    v_lshlrev_b32 v6, 4, v6
    v_add_u32 v5, s43, v5
    v_mul_lo_u32 v5, v5, s46
    v_add3_u32 v5, v5, v6, s42
    v_subrev_u32 v16, 0, v5
    v_add_u32 v4, 320, v0
    v_mul_u32_u24 v5, 2341, v4
    v_lshrrev_b32 v5, 16, v5
    v_mul_u32_u24 v6, 28, v5
    v_sub_u32 v6, v4, v6
    v_lshrrev_b32 v7, 2, v5
    v_and_b32 v7, 2, v7
    v_xor_b32 v6, v6, v7
    v_lshlrev_b32 v6, 4, v6
    v_add_u32 v5, s43, v5
    v_mul_lo_u32 v5, v5, s46
    v_add3_u32 v5, v5, v6, s42
    v_subrev_u32 v17, 1024, v5
    v_add_u32 v4, 384, v0
    v_mul_u32_u24 v5, 2341, v4
    v_lshrrev_b32 v5, 16, v5
    v_mul_u32_u24 v6, 28, v5
    v_sub_u32 v6, v4, v6
    v_lshrrev_b32 v7, 2, v5
    v_and_b32 v7, 2, v7
    v_xor_b32 v6, v6, v7
    v_lshlrev_b32 v6, 4, v6
    v_add_u32 v5, s43, v5
    v_mul_lo_u32 v5, v5, s46
    v_add3_u32 v5, v5, v6, s42
    v_subrev_u32 v18, 2048, v5
    s_lshl_b32 s50, s40, 12
    s_mul_i32 s51, s40, 7168
    s_add_u32 s51, s51, 16384
    s_lshl_b32 s52, s19, 7
    s_mul_i32 s53, s19, 458752
    v_lshlrev_b32 v19, 4, v0
    s_waitcnt lgkmcnt(0)
    s_mov_b32 s20, s76
    s_mov_b32 s21, s77
    s_mov_b32 s22, 0x400000
    s_mov_b32 s23, 0x20000
    s_mov_b32 s24, s90
    s_mov_b32 s25, s91
    s_mov_b32 s26, 0x700000
    s_mov_b32 s27, 0x20000
    s_mov_b32 s12, s19
    s_lshl_b32 s52, s12, 7
    s_mul_i32 s53, s12, 458752
    s_add_u32 m0, s50, 0
    s_add_u32 s54, s51, 0
    buffer_load_dwordx4 v8, s[20:23], s52 offen offset:0 lds
    buffer_load_dwordx4 v9, s[20:23], s52 offen offset:1024 lds
    buffer_load_dwordx4 v10, s[20:23], s52 offen offset:2048 lds
    buffer_load_dwordx4 v11, s[20:23], s52 offen offset:3072 lds
    s_mov_b32 m0, s54
    s_nop 0
    buffer_load_dwordx4 v12, s[24:27], s53 offen offset:0 lds
    buffer_load_dwordx4 v13, s[24:27], s53 offen offset:1024 lds
    buffer_load_dwordx4 v14, s[24:27], s53 offen offset:2048 lds
    buffer_load_dwordx4 v15, s[24:27], s53 offen offset:3072 lds
    s_add_u32 m0, s54, 4096
    s_and_b32 s52, s52, 2047
    buffer_load_dwordx4 v16, s[24:27], s53 offen offset:0 lds
    buffer_load_dwordx4 v17, s[24:27], s53 offen offset:1024 lds
    buffer_load_dwordx4 v18, s[24:27], s53 offen offset:2048 lds
    s_add_u32 s8, s98, 0x2400000
    s_addc_u32 s9, s99, 0
    s_mov_b32 s10, 0x6000
    s_mov_b32 s11, 0x20000
    s_lshl_b32 s42, s14, 4
    s_add_u32 s42, s42, s15
    s_lshl_b32 s43, s15, 4
    s_add_u32 s43, s43, s14
    v_mov_b32 v5, s2
    v_mov_b32 v6, s42
    v_mov_b32 v7, s43
    v_cmp_eq_u32 vcc, 0, v0
    s_nop 1
    v_cndmask_b32 v5, v5, v6, vcc
    v_cmp_eq_u32 vcc, 3, v0
    s_nop 1
    v_cndmask_b32 v5, v5, v6, vcc
    v_cmp_eq_u32 vcc, 1, v0
    s_nop 1
    v_cndmask_b32 v5, v5, v7, vcc
    v_lshlrev_b32 v5, 4, v5
    v_lshlrev_b32 v4, 12, v0
    v_add_u32 v5, v5, v4
    s_lshl_b32 s42, s40, 2
    v_add_u32 v5, s42, v5
    v_mov_b32 v6, 0
    buffer_store_dword v6, v5, s[8:11], 0 offen sc1
    s_cmp_gt_u32 s19, 0
    s_cselect_b32 s12, 0, 1
    s_lshl_b32 s52, s12, 7
    s_mul_i32 s53, s12, 458752
    s_add_u32 m0, s50, 45056
    s_add_u32 s54, s51, 45056
    buffer_load_dwordx4 v8, s[20:23], s52 offen offset:0 lds
    buffer_load_dwordx4 v9, s[20:23], s52 offen offset:1024 lds
    buffer_load_dwordx4 v10, s[20:23], s52 offen offset:2048 lds
    buffer_load_dwordx4 v11, s[20:23], s52 offen offset:3072 lds
    s_mov_b32 m0, s54
    s_nop 0
    buffer_load_dwordx4 v12, s[24:27], s53 offen offset:0 lds
    buffer_load_dwordx4 v13, s[24:27], s53 offen offset:1024 lds
    buffer_load_dwordx4 v14, s[24:27], s53 offen offset:2048 lds
    buffer_load_dwordx4 v15, s[24:27], s53 offen offset:3072 lds
    s_add_u32 m0, s54, 4096
    s_and_b32 s52, s52, 2047
    buffer_load_dwordx4 v16, s[24:27], s53 offen offset:0 lds
    buffer_load_dwordx4 v17, s[24:27], s53 offen offset:1024 lds
    buffer_load_dwordx4 v18, s[24:27], s53 offen offset:2048 lds
    s_add_u32 s28, s98, 0x2500000
    s_addc_u32 s29, s99, 0
    s_mov_b32 s30, 0x4000
    s_mov_b32 s31, 0x20000
    s_waitcnt vmcnt(12)
    s_barrier
    s_cmp_gt_u32 s19, 1
    s_cselect_b32 s12, 1, 2
    s_lshl_b32 s52, s12, 7
    s_mul_i32 s53, s12, 458752
    s_add_u32 m0, s50, 90112
    s_add_u32 s54, s51, 90112
    buffer_load_dwordx4 v8, s[20:23], s52 offen offset:0 lds
    s_and_b32 s42, s2, 15
    s_lshl_b32 s42, s42, 7
    s_lshl_b32 s43, s40, 5
    s_add_u32 s42, s42, s43
    buffer_load_dwordx4 v9, s[20:23], s52 offen offset:1024 lds
    v_and_b32 v2, 15, v0
    v_lshrrev_b32 v3, 4, v0
    v_lshlrev_b32 v4, 3, v3
    v_add_u32 v182, s42, v4
    buffer_load_dwordx4 v10, s[20:23], s52 offen offset:2048 lds
    s_lshr_b32 s43, s2, 4
    s_lshl_b32 s43, s43, 7
    v_lshlrev_b32 v5, 3, v2
    v_add_u32 v183, s43, v5
    buffer_load_dwordx4 v11, s[20:23], s52 offen offset:3072 lds
    v_lshlrev_b32 v6, 11, v182
    v_add_u32 v39, v6, v183
    v_add_u32 v200, 4294961152, v39
    v_add_u32 v201, 4294963200, v39
    s_mov_b32 m0, s54
    s_nop 0
    buffer_load_dwordx4 v12, s[24:27], s53 offen offset:0 lds
    v_add_u32 v202, 4294965248, v39
    v_add_u32 v203, 0, v39
    v_add_u32 v204, 2048, v39
    v_add_u32 v205, 4096, v39
    buffer_load_dwordx4 v13, s[24:27], s53 offen offset:1024 lds
    v_add_u32 v206, 6144, v39
    v_add_u32 v207, 8192, v39
    v_add_u32 v208, 10240, v39
    v_add_u32 v209, 12288, v39
    buffer_load_dwordx4 v14, s[24:27], s53 offen offset:2048 lds
    v_add_u32 v210, 14336, v39
    v_lshlrev_b32 v211, 2, v183
    buffer_load_dwordx4 v15, s[24:27], s53 offen offset:3072 lds
    s_add_u32 m0, s54, 4096
    s_and_b32 s52, s52, 2047
    buffer_load_dwordx4 v16, s[24:27], s53 offen offset:0 lds
    buffer_load_dwordx4 v17, s[24:27], s53 offen offset:1024 lds
    buffer_load_dwordx4 v18, s[24:27], s53 offen offset:2048 lds
    s_waitcnt vmcnt(11)
    s_barrier
    s_cmp_gt_u32 s19, 2
    s_cselect_b32 s12, 2, 3
    s_lshl_b32 s52, s12, 7
    s_mul_i32 s53, s12, 458752
    s_add_u32 m0, s50, 0
    s_add_u32 s54, s51, 0
    buffer_load_dwordx4 v8, s[20:23], s52 offen offset:0 lds
    v_add_u32 v4, 0, v0
    v_mul_u32_u24 v5, 10923, v4
    v_lshrrev_b32 v5, 16, v5
    v_mul_u32_u24 v6, 6, v5
    buffer_load_dwordx4 v9, s[20:23], s52 offen offset:1024 lds
    v_sub_u32 v6, v4, v6
    v_min_u32 v6, 3, v6
    v_lshlrev_b32 v6, 4, v6
    v_lshlrev_b32 v5, 6, v5
    buffer_load_dwordx4 v10, s[20:23], s52 offen offset:2048 lds
    v_add_u32 v20, v5, v6
    v_add_u32 v4, 64, v0
    v_mul_u32_u24 v5, 10923, v4
    v_lshrrev_b32 v5, 16, v5
    buffer_load_dwordx4 v11, s[20:23], s52 offen offset:3072 lds
    v_mul_u32_u24 v6, 6, v5
    v_sub_u32 v6, v4, v6
    v_min_u32 v6, 3, v6
    v_lshlrev_b32 v6, 4, v6
    s_mov_b32 m0, s54
    s_nop 0
    buffer_load_dwordx4 v12, s[24:27], s53 offen offset:0 lds
    v_lshlrev_b32 v5, 6, v5
    v_add_u32 v21, v5, v6
    v_add_u32 v4, 128, v0
    v_mul_u32_u24 v5, 10923, v4
    buffer_load_dwordx4 v13, s[24:27], s53 offen offset:1024 lds
    v_lshrrev_b32 v5, 16, v5
    v_mul_u32_u24 v6, 6, v5
    v_sub_u32 v6, v4, v6
    v_min_u32 v6, 3, v6
    buffer_load_dwordx4 v14, s[24:27], s53 offen offset:2048 lds
    v_lshlrev_b32 v6, 4, v6
    v_lshlrev_b32 v5, 6, v5
    v_add_u32 v22, v5, v6
    v_add_u32 v4, 192, v0
    buffer_load_dwordx4 v15, s[24:27], s53 offen offset:3072 lds
    v_mul_u32_u24 v5, 10923, v4
    v_lshrrev_b32 v5, 16, v5
    v_mul_u32_u24 v6, 6, v5
    v_sub_u32 v6, v4, v6
    s_add_u32 m0, s54, 4096
    s_and_b32 s52, s52, 2047
    buffer_load_dwordx4 v16, s[24:27], s53 offen offset:0 lds
    v_min_u32 v6, 3, v6
    v_lshlrev_b32 v6, 4, v6
    v_lshlrev_b32 v5, 6, v5
    v_add_u32 v23, v5, v6
    buffer_load_dwordx4 v17, s[24:27], s53 offen offset:1024 lds
    v_add_u32 v4, 256, v0
    v_mul_u32_u24 v5, 10923, v4
    v_lshrrev_b32 v5, 16, v5
    v_mul_u32_u24 v6, 6, v5
    buffer_load_dwordx4 v18, s[24:27], s53 offen offset:2048 lds
    v_sub_u32 v6, v4, v6
    v_min_u32 v6, 3, v6
    v_lshlrev_b32 v6, 4, v6
    v_lshlrev_b32 v5, 6, v5
    v_add_u32 v24, v5, v6
    v_add_u32 v4, 320, v0
    v_mul_u32_u24 v5, 10923, v4
    v_lshrrev_b32 v5, 16, v5
    v_mul_u32_u24 v6, 6, v5
    v_sub_u32 v6, v4, v6
    v_min_u32 v6, 3, v6
    v_lshlrev_b32 v6, 4, v6
    v_lshlrev_b32 v5, 6, v5
    v_add_u32 v25, v5, v6
    s_mul_i32 s56, s40, 22848
    s_add_u32 s56, s56, 67264
    s_cmp_eq_u32 s40, 3
    s_cselect_b32 s56, 140992, s56
    s_lshl_b32 s57, s2, 2
    s_add_u32 s57, s57, s40
    s_lshl_b32 s57, s57, 12
    s_mov_b32 s32, s82
    s_mov_b32 s33, s83
    s_mov_b32 s34, 0x2000
    s_mov_b32 s35, 0x20000
    s_mov_b32 s36, s78
    s_mov_b32 s37, s79
    s_mov_b32 s38, 0x400000
    s_mov_b32 s39, 0x20000
    buffer_load_dwordx4 v[40:43], v211, s[32:35], 0 offen
    buffer_load_dwordx4 v[44:47], v211, s[32:35], 0 offen offset:16
    buffer_load_dwordx2 v[48:49], v200, s[36:39], 0 offen nt
    buffer_load_dwordx2 v[50:51], v201, s[36:39], 0 offen nt
    buffer_load_dwordx2 v[52:53], v202, s[36:39], 0 offen nt
    buffer_load_dwordx2 v[54:55], v203, s[36:39], 0 offen nt
    buffer_load_dwordx2 v[56:57], v204, s[36:39], 0 offen nt
    buffer_load_dwordx2 v[58:59], v205, s[36:39], 0 offen nt
    buffer_load_dwordx2 v[60:61], v206, s[36:39], 0 offen nt
    buffer_load_dwordx2 v[62:63], v207, s[36:39], 0 offen nt
    buffer_load_dwordx2 v[64:65], v208, s[36:39], 0 offen nt
    buffer_load_dwordx2 v[66:67], v209, s[36:39], 0 offen nt
    buffer_load_dwordx2 v[68:69], v210, s[36:39], 0 offen nt
    s_waitcnt vmcnt(24)
    s_barrier
    s_cmp_gt_u32 s19, 3
    s_cselect_b32 s12, 3, 4
    s_lshl_b32 s52, s12, 7
    s_mul_i32 s53, s12, 458752
    s_add_u32 m0, s50, 45056
    s_add_u32 s54, s51, 45056
    buffer_load_dwordx4 v8, s[20:23], s52 offen offset:0 lds
    s_add_u32 s4, s98, 0x2510000
    s_addc_u32 s5, s99, 0
    s_mov_b32 s6, 0x38000
    s_mov_b32 s7, 0x20000
    buffer_load_dwordx4 v9, s[20:23], s52 offen offset:1024 lds
    v_min_u32 v4, 13, v0
    v_lshlrev_b32 v4, 4, v4
    s_mul_i32 s42, s40, 224
    v_add_u32 v4, s42, v4
    buffer_load_dwordx4 v10, s[20:23], s52 offen offset:2048 lds
    v_add_u32 v5, 137344, v4
    ds_read_b128 v[212:215], v5
    s_mul_i32 s42, s19, 3584
    s_mul_i32 s43, s15, 224
    buffer_load_dwordx4 v11, s[20:23], s52 offen offset:3072 lds
    s_add_u32 s42, s42, s43
    s_lshl_b32 s42, s42, 2
    s_waitcnt lgkmcnt(0)
    buffer_store_dwordx4 v[212:215], v4, s[4:7], s42 offen sc1
    s_mov_b32 m0, s54
    s_nop 0
    buffer_load_dwordx4 v12, s[24:27], s53 offen offset:0 lds
    buffer_load_dwordx4 v13, s[24:27], s53 offen offset:1024 lds
    buffer_load_dwordx4 v14, s[24:27], s53 offen offset:2048 lds
    buffer_load_dwordx4 v15, s[24:27], s53 offen offset:3072 lds
    s_add_u32 m0, s54, 4096
    s_and_b32 s52, s52, 2047
    buffer_load_dwordx4 v16, s[24:27], s53 offen offset:0 lds
    buffer_load_dwordx4 v17, s[24:27], s53 offen offset:1024 lds
    buffer_load_dwordx4 v18, s[24:27], s53 offen offset:2048 lds
    s_waitcnt vmcnt(25)
    s_barrier
    s_cmp_gt_u32 s19, 4
    s_cselect_b32 s12, 4, 5
    s_lshl_b32 s52, s12, 7
    s_mul_i32 s53, s12, 458752
    s_add_u32 m0, s50, 90112
    s_add_u32 s54, s51, 90112
    buffer_load_dwordx4 v8, s[20:23], s52 offen offset:0 lds
    s_waitcnt vmcnt(13)
    v_lshlrev_b32 v88, 16, v40
    v_and_b32 v92, 0xffff0000, v40
    v_lshlrev_b32 v96, 16, v41
    v_and_b32 v100, 0xffff0000, v41
    buffer_load_dwordx4 v9, s[20:23], s52 offen offset:1024 lds
    v_lshlrev_b32 v89, 16, v42
    v_and_b32 v93, 0xffff0000, v42
    v_lshlrev_b32 v97, 16, v43
    v_and_b32 v101, 0xffff0000, v43
    buffer_load_dwordx4 v10, s[20:23], s52 offen offset:2048 lds
    v_lshlrev_b32 v90, 16, v44
    v_and_b32 v94, 0xffff0000, v44
    v_lshlrev_b32 v98, 16, v45
    v_and_b32 v102, 0xffff0000, v45
    buffer_load_dwordx4 v11, s[20:23], s52 offen offset:3072 lds
    v_lshlrev_b32 v91, 16, v46
    v_and_b32 v95, 0xffff0000, v46
    v_lshlrev_b32 v99, 16, v47
    v_and_b32 v103, 0xffff0000, v47
    s_mov_b32 m0, s54
    s_nop 0
    buffer_load_dwordx4 v12, s[24:27], s53 offen offset:0 lds
    v_lshlrev_b32 v104, 16, v48
    v_and_b32 v105, 0xffff0000, v48
    v_lshlrev_b32 v106, 16, v49
    v_and_b32 v107, 0xffff0000, v49
    buffer_load_dwordx4 v13, s[24:27], s53 offen offset:1024 lds
    v_lshlrev_b32 v108, 16, v50
    v_and_b32 v109, 0xffff0000, v50
    v_lshlrev_b32 v110, 16, v51
    v_and_b32 v111, 0xffff0000, v51
    buffer_load_dwordx4 v14, s[24:27], s53 offen offset:2048 lds
    v_lshlrev_b32 v112, 16, v52
    v_and_b32 v113, 0xffff0000, v52
    v_lshlrev_b32 v114, 16, v53
    v_and_b32 v115, 0xffff0000, v53
    buffer_load_dwordx4 v15, s[24:27], s53 offen offset:3072 lds
    v_lshlrev_b32 v116, 16, v54
    v_and_b32 v117, 0xffff0000, v54
    v_lshlrev_b32 v118, 16, v55
    v_and_b32 v119, 0xffff0000, v55
    s_add_u32 m0, s54, 4096
    s_and_b32 s52, s52, 2047
    buffer_load_dwordx4 v16, s[24:27], s53 offen offset:0 lds
    v_lshlrev_b32 v120, 16, v56
    v_and_b32 v121, 0xffff0000, v56
    v_lshlrev_b32 v122, 16, v57
    v_and_b32 v123, 0xffff0000, v57
    buffer_load_dwordx4 v17, s[24:27], s53 offen offset:1024 lds
    v_lshlrev_b32 v124, 16, v58
    v_and_b32 v125, 0xffff0000, v58
    v_lshlrev_b32 v126, 16, v59
    v_and_b32 v127, 0xffff0000, v59
    buffer_load_dwordx4 v18, s[24:27], s53 offen offset:2048 lds
    v_lshlrev_b32 v128, 16, v60
    v_and_b32 v129, 0xffff0000, v60
    v_lshlrev_b32 v130, 16, v61
    v_and_b32 v131, 0xffff0000, v61
    s_waitcnt vmcnt(11)
    s_barrier
    s_cmp_gt_u32 s19, 5
    s_cselect_b32 s12, 5, 6
    s_lshl_b32 s52, s12, 7
    s_mul_i32 s53, s12, 458752
    s_add_u32 m0, s50, 0
    s_add_u32 s54, s51, 0
    buffer_load_dwordx4 v8, s[20:23], s52 offen offset:0 lds
    v_lshlrev_b32 v132, 16, v62
    v_and_b32 v133, 0xffff0000, v62
    v_lshlrev_b32 v134, 16, v63
    v_and_b32 v135, 0xffff0000, v63
    buffer_load_dwordx4 v9, s[20:23], s52 offen offset:1024 lds
    v_lshlrev_b32 v136, 16, v64
    v_and_b32 v137, 0xffff0000, v64
    v_lshlrev_b32 v138, 16, v65
    v_and_b32 v139, 0xffff0000, v65
    buffer_load_dwordx4 v10, s[20:23], s52 offen offset:2048 lds
    v_lshlrev_b32 v140, 16, v66
    v_and_b32 v141, 0xffff0000, v66
    v_lshlrev_b32 v142, 16, v67
    v_and_b32 v143, 0xffff0000, v67
    buffer_load_dwordx4 v11, s[20:23], s52 offen offset:3072 lds
    v_lshlrev_b32 v144, 16, v68
    v_and_b32 v145, 0xffff0000, v68
    v_lshlrev_b32 v146, 16, v69
    v_and_b32 v147, 0xffff0000, v69
    s_mov_b32 m0, s54
    s_nop 0
    buffer_load_dwordx4 v12, s[24:27], s53 offen offset:0 lds
    buffer_load_dwordx4 v13, s[24:27], s53 offen offset:1024 lds
    buffer_load_dwordx4 v14, s[24:27], s53 offen offset:2048 lds
    buffer_load_dwordx4 v15, s[24:27], s53 offen offset:3072 lds
    s_add_u32 m0, s54, 4096
    s_and_b32 s52, s52, 2047
    buffer_load_dwordx4 v16, s[24:27], s53 offen offset:0 lds
    buffer_load_dwordx4 v17, s[24:27], s53 offen offset:1024 lds
    buffer_load_dwordx4 v18, s[24:27], s53 offen offset:2048 lds
    s_mov_b32 s32, s80
    s_mov_b32 s33, s81
    s_mov_b32 s34, 0x400000
    s_mov_b32 s35, 0x20000
    buffer_load_dwordx2 v[70:71], v203, s[32:35], 0 offen nt
    buffer_load_dwordx2 v[72:73], v204, s[32:35], 0 offen nt
    buffer_load_dwordx2 v[74:75], v205, s[32:35], 0 offen nt
    buffer_load_dwordx2 v[76:77], v206, s[32:35], 0 offen nt
    buffer_load_dwordx2 v[78:79], v207, s[32:35], 0 offen nt
    buffer_load_dwordx2 v[80:81], v208, s[32:35], 0 offen nt
    buffer_load_dwordx2 v[82:83], v209, s[32:35], 0 offen nt
    buffer_load_dwordx2 v[84:85], v210, s[32:35], 0 offen nt
    s_waitcnt vmcnt(19)
    s_barrier
    s_cmp_gt_u32 s19, 6
    s_cselect_b32 s12, 6, 7
    s_lshl_b32 s52, s12, 7
    s_mul_i32 s53, s12, 458752
    s_add_u32 m0, s50, 45056
    s_add_u32 s54, s51, 45056
    buffer_load_dwordx4 v8, s[20:23], s52 offen offset:0 lds
    s_lshl_b32 s58, s14, 4
    s_add_u32 s58, s58, s15
    s_lshl_b32 s58, s58, 2
    buffer_load_dwordx4 v9, s[20:23], s52 offen offset:1024 lds
    s_add_u32 s58, s58, s40
    s_lshl_b32 s58, s58, 2
    s_add_u32 s58, s58, 0
    s_mov_b32 s59, s58
    buffer_load_dwordx4 v10, s[20:23], s52 offen offset:2048 lds
    s_lshl_b32 s58, s15, 4
    s_add_u32 s58, s58, s14
    s_lshl_b32 s58, s58, 2
    s_add_u32 s58, s58, s40
    buffer_load_dwordx4 v11, s[20:23], s52 offen offset:3072 lds
    s_lshl_b32 s58, s58, 2
    s_add_u32 s58, s58, 4096
    v_mov_b32 v5, s59
    v_mov_b32 v6, s58
    s_mov_b32 m0, s54
    s_nop 0
    buffer_load_dwordx4 v12, s[24:27], s53 offen offset:0 lds
    v_cmp_eq_u32 vcc, 0, v0
    s_nop 1
    v_cndmask_b32 v4, v6, v5, vcc
    v_mov_b32 v5, 1
    buffer_load_dwordx4 v13, s[24:27], s53 offen offset:1024 lds
    buffer_store_dword v5, v4, s[8:11], 0 offen sc1
    buffer_load_dwordx4 v14, s[24:27], s53 offen offset:2048 lds
    buffer_load_dwordx4 v15, s[24:27], s53 offen offset:3072 lds
    s_add_u32 m0, s54, 4096
    s_and_b32 s52, s52, 2047
    buffer_load_dwordx4 v16, s[24:27], s53 offen offset:0 lds
    buffer_load_dwordx4 v17, s[24:27], s53 offen offset:1024 lds
    buffer_load_dwordx4 v18, s[24:27], s53 offen offset:2048 lds
    s_waitcnt vmcnt(20)
    s_barrier
    s_cmp_gt_u32 s19, 7
    s_cselect_b32 s12, 7, 8
    s_lshl_b32 s52, s12, 7
    s_mul_i32 s53, s12, 458752
    s_add_u32 m0, s50, 90112
    s_add_u32 s54, s51, 90112
    buffer_load_dwordx4 v8, s[20:23], s52 offen offset:0 lds
    s_waitcnt vmcnt(13)
    v_lshlrev_b32 v148, 16, v70
    v_and_b32 v149, 0xffff0000, v70
    v_lshlrev_b32 v150, 16, v71
    v_and_b32 v151, 0xffff0000, v71
    buffer_load_dwordx4 v9, s[20:23], s52 offen offset:1024 lds
    v_mul_f32 v40, v116, v88
    v_mul_f32 v41, v117, v89
    v_mul_f32 v42, v118, v90
    v_mul_f32 v43, v119, v91
    buffer_load_dwordx4 v10, s[20:23], s52 offen offset:2048 lds
    v_fmac_f32 v40, v112, v92
    v_fmac_f32 v41, v113, v93
    v_fmac_f32 v42, v114, v94
    v_fmac_f32 v43, v115, v95
    buffer_load_dwordx4 v11, s[20:23], s52 offen offset:3072 lds
    v_fmac_f32 v40, v108, v96
    v_fmac_f32 v41, v109, v97
    v_fmac_f32 v42, v110, v98
    v_fmac_f32 v43, v111, v99
    s_mov_b32 m0, s54
    s_nop 0
    buffer_load_dwordx4 v12, s[24:27], s53 offen offset:0 lds
    v_fmac_f32 v40, v104, v100
    v_fmac_f32 v41, v105, v101
    v_fmac_f32 v42, v106, v102
    v_fmac_f32 v43, v107, v103
    buffer_load_dwordx4 v13, s[24:27], s53 offen offset:1024 lds
    v_mul_f32 v148, v40, v148
    v_mul_f32 v149, v41, v149
    v_mul_f32 v150, v42, v150
    v_mul_f32 v151, v43, v151
    buffer_load_dwordx4 v14, s[24:27], s53 offen offset:2048 lds
    v_lshlrev_b32 v152, 16, v72
    v_and_b32 v153, 0xffff0000, v72
    v_lshlrev_b32 v154, 16, v73
    v_and_b32 v155, 0xffff0000, v73
    buffer_load_dwordx4 v15, s[24:27], s53 offen offset:3072 lds
    v_mul_f32 v40, v120, v88
    v_mul_f32 v41, v121, v89
    v_mul_f32 v42, v122, v90
    v_mul_f32 v43, v123, v91
    s_add_u32 m0, s54, 4096
    s_and_b32 s52, s52, 2047
    buffer_load_dwordx4 v16, s[24:27], s53 offen offset:0 lds
    v_fmac_f32 v40, v116, v92
    v_fmac_f32 v41, v117, v93
    v_fmac_f32 v42, v118, v94
    v_fmac_f32 v43, v119, v95
    buffer_load_dwordx4 v17, s[24:27], s53 offen offset:1024 lds
    v_fmac_f32 v40, v112, v96
    v_fmac_f32 v41, v113, v97
    v_fmac_f32 v42, v114, v98
    v_fmac_f32 v43, v115, v99
    buffer_load_dwordx4 v18, s[24:27], s53 offen offset:2048 lds
    v_fmac_f32 v40, v108, v100
    v_fmac_f32 v41, v109, v101
    v_fmac_f32 v42, v110, v102
    v_fmac_f32 v43, v111, v103
    v_and_b32 v4, 3, v0
    v_lshlrev_b32 v37, 6, v4
    global_load_dword v38, v37, s[96:97] sc1
    s_waitcnt vmcnt(12)
    s_barrier
    s_cmp_gt_u32 s19, 8
    s_cselect_b32 s12, 8, 9
    s_lshl_b32 s52, s12, 7
    s_mul_i32 s53, s12, 458752
    s_add_u32 m0, s50, 0
    s_add_u32 s54, s51, 0
    buffer_load_dwordx4 v8, s[20:23], s52 offen offset:0 lds
    v_mul_f32 v152, v40, v152
    v_mul_f32 v153, v41, v153
    v_mul_f32 v154, v42, v154
    v_mul_f32 v155, v43, v155
    buffer_load_dwordx4 v9, s[20:23], s52 offen offset:1024 lds
    v_lshlrev_b32 v156, 16, v74
    v_and_b32 v157, 0xffff0000, v74
    v_lshlrev_b32 v158, 16, v75
    v_and_b32 v159, 0xffff0000, v75
    buffer_load_dwordx4 v10, s[20:23], s52 offen offset:2048 lds
    v_mul_f32 v40, v124, v88
    v_mul_f32 v41, v125, v89
    v_mul_f32 v42, v126, v90
    v_mul_f32 v43, v127, v91
    buffer_load_dwordx4 v11, s[20:23], s52 offen offset:3072 lds
    v_fmac_f32 v40, v120, v92
    v_fmac_f32 v41, v121, v93
    v_fmac_f32 v42, v122, v94
    v_fmac_f32 v43, v123, v95
    s_mov_b32 m0, s54
    s_nop 0
    buffer_load_dwordx4 v12, s[24:27], s53 offen offset:0 lds
    v_fmac_f32 v40, v116, v96
    v_fmac_f32 v41, v117, v97
    v_fmac_f32 v42, v118, v98
    v_fmac_f32 v43, v119, v99
    buffer_load_dwordx4 v13, s[24:27], s53 offen offset:1024 lds
    v_fmac_f32 v40, v112, v100
    v_fmac_f32 v41, v113, v101
    v_fmac_f32 v42, v114, v102
    v_fmac_f32 v43, v115, v103
    buffer_load_dwordx4 v14, s[24:27], s53 offen offset:2048 lds
    v_mul_f32 v156, v40, v156
    v_mul_f32 v157, v41, v157
    v_mul_f32 v158, v42, v158
    v_mul_f32 v159, v43, v159
    buffer_load_dwordx4 v15, s[24:27], s53 offen offset:3072 lds
    v_lshlrev_b32 v160, 16, v76
    v_and_b32 v161, 0xffff0000, v76
    v_lshlrev_b32 v162, 16, v77
    v_and_b32 v163, 0xffff0000, v77
    s_add_u32 m0, s54, 4096
    s_and_b32 s52, s52, 2047
    buffer_load_dwordx4 v16, s[24:27], s53 offen offset:0 lds
    v_mul_f32 v40, v128, v88
    v_mul_f32 v41, v129, v89
    v_mul_f32 v42, v130, v90
    v_mul_f32 v43, v131, v91
    buffer_load_dwordx4 v17, s[24:27], s53 offen offset:1024 lds
    v_fmac_f32 v40, v124, v92
    v_fmac_f32 v41, v125, v93
    v_fmac_f32 v42, v126, v94
    v_fmac_f32 v43, v127, v95
    buffer_load_dwordx4 v18, s[24:27], s53 offen offset:2048 lds
    v_fmac_f32 v40, v120, v96
    v_fmac_f32 v41, v121, v97
    v_fmac_f32 v42, v122, v98
    v_fmac_f32 v43, v123, v99
    s_waitcnt vmcnt(12)
    s_barrier
    s_cmp_gt_u32 s19, 9
    s_cselect_b32 s12, 9, 10
    s_lshl_b32 s52, s12, 7
    s_mul_i32 s53, s12, 458752
    s_add_u32 m0, s50, 45056
    s_add_u32 s54, s51, 45056
    buffer_load_dwordx4 v8, s[20:23], s52 offen offset:0 lds
    v_fmac_f32 v40, v116, v100
    v_fmac_f32 v41, v117, v101
    v_fmac_f32 v42, v118, v102
    v_fmac_f32 v43, v119, v103
    buffer_load_dwordx4 v9, s[20:23], s52 offen offset:1024 lds
    v_mul_f32 v160, v40, v160
    v_mul_f32 v161, v41, v161
    v_mul_f32 v162, v42, v162
    v_mul_f32 v163, v43, v163
    buffer_load_dwordx4 v10, s[20:23], s52 offen offset:2048 lds
    v_lshlrev_b32 v164, 16, v78
    v_and_b32 v165, 0xffff0000, v78
    v_lshlrev_b32 v166, 16, v79
    v_and_b32 v167, 0xffff0000, v79
    buffer_load_dwordx4 v11, s[20:23], s52 offen offset:3072 lds
    v_mul_f32 v40, v132, v88
    v_mul_f32 v41, v133, v89
    v_mul_f32 v42, v134, v90
    v_mul_f32 v43, v135, v91
    s_mov_b32 m0, s54
    s_nop 0
    buffer_load_dwordx4 v12, s[24:27], s53 offen offset:0 lds
    v_fmac_f32 v40, v128, v92
    v_fmac_f32 v41, v129, v93
    v_fmac_f32 v42, v130, v94
    v_fmac_f32 v43, v131, v95
    buffer_load_dwordx4 v13, s[24:27], s53 offen offset:1024 lds
    v_fmac_f32 v40, v124, v96
    v_fmac_f32 v41, v125, v97
    v_fmac_f32 v42, v126, v98
    v_fmac_f32 v43, v127, v99
    buffer_load_dwordx4 v14, s[24:27], s53 offen offset:2048 lds
    v_fmac_f32 v40, v120, v100
    v_fmac_f32 v41, v121, v101
    v_fmac_f32 v42, v122, v102
    v_fmac_f32 v43, v123, v103
    buffer_load_dwordx4 v15, s[24:27], s53 offen offset:3072 lds
    v_mul_f32 v164, v40, v164
    v_mul_f32 v165, v41, v165
    v_mul_f32 v166, v42, v166
    v_mul_f32 v167, v43, v167
    s_add_u32 m0, s54, 4096
    s_and_b32 s52, s52, 2047
    buffer_load_dwordx4 v16, s[24:27], s53 offen offset:0 lds
    v_lshlrev_b32 v168, 16, v80
    v_and_b32 v169, 0xffff0000, v80
    v_lshlrev_b32 v170, 16, v81
    v_and_b32 v171, 0xffff0000, v81
    buffer_load_dwordx4 v17, s[24:27], s53 offen offset:1024 lds
    v_mul_f32 v40, v136, v88
    v_mul_f32 v41, v137, v89
    v_mul_f32 v42, v138, v90
    v_mul_f32 v43, v139, v91
    buffer_load_dwordx4 v18, s[24:27], s53 offen offset:2048 lds
    v_fmac_f32 v40, v132, v92
    v_fmac_f32 v41, v133, v93
    v_fmac_f32 v42, v134, v94
    v_fmac_f32 v43, v135, v95
    s_waitcnt vmcnt(22)
    s_mov_b32 s59, 0
L_plp_22:
    v_cmp_gt_u32 vcc, 64, v38
    s_nop 3
    s_cbranch_vccz L_pok_21
    s_sleep 2
    global_load_dword v38, v37, s[96:97] sc1
    s_waitcnt vmcnt(0)
    s_add_u32 s59, s59, 1
    s_cmp_lt_u32 s59, 0x20000
    s_cbranch_scc1 L_plp_22
L_pok_21:
    s_lshl_b32 s42, s14, 8
    s_add_u32 s42, s42, 0
    v_lshlrev_b32 v4, 2, v0
    v_add_u32 v244, s42, v4
    s_lshl_b32 s42, s15, 8
    s_add_u32 s42, s42, 4096
    v_add_u32 v245, s42, v4
    s_lshr_b32 s42, s2, 4
    s_lshl_b32 s42, s42, 8
    s_add_u32 s42, s42, 8192
    v_add_u32 v248, s42, v4
    buffer_load_dword v246, v244, s[8:11], 0 offen sc1
    buffer_load_dword v247, v245, s[8:11], 0 offen sc1
    s_waitcnt vmcnt(13)
    s_barrier
    s_cmp_gt_u32 s19, 10
    s_cselect_b32 s12, 10, 11
    s_lshl_b32 s52, s12, 7
    s_mul_i32 s53, s12, 458752
    s_add_u32 m0, s50, 90112
    s_add_u32 s54, s51, 90112
    buffer_load_dwordx4 v8, s[20:23], s52 offen offset:0 lds
    v_fmac_f32 v40, v128, v96
    v_fmac_f32 v41, v129, v97
    v_fmac_f32 v42, v130, v98
    v_fmac_f32 v43, v131, v99
    buffer_load_dwordx4 v9, s[20:23], s52 offen offset:1024 lds
    v_fmac_f32 v40, v124, v100
    v_fmac_f32 v41, v125, v101
    v_fmac_f32 v42, v126, v102
    v_fmac_f32 v43, v127, v103
    buffer_load_dwordx4 v10, s[20:23], s52 offen offset:2048 lds
    v_mul_f32 v168, v40, v168
    v_mul_f32 v169, v41, v169
    v_mul_f32 v170, v42, v170
    v_mul_f32 v171, v43, v171
    buffer_load_dwordx4 v11, s[20:23], s52 offen offset:3072 lds
    v_lshlrev_b32 v172, 16, v82
    v_and_b32 v173, 0xffff0000, v82
    v_lshlrev_b32 v174, 16, v83
    v_and_b32 v175, 0xffff0000, v83
    s_mov_b32 m0, s54
    s_nop 0
    buffer_load_dwordx4 v12, s[24:27], s53 offen offset:0 lds
    v_mul_f32 v40, v140, v88
    v_mul_f32 v41, v141, v89
    v_mul_f32 v42, v142, v90
    v_mul_f32 v43, v143, v91
    buffer_load_dwordx4 v13, s[24:27], s53 offen offset:1024 lds
    v_fmac_f32 v40, v136, v92
    v_fmac_f32 v41, v137, v93
    v_fmac_f32 v42, v138, v94
    v_fmac_f32 v43, v139, v95
    buffer_load_dwordx4 v14, s[24:27], s53 offen offset:2048 lds
    v_fmac_f32 v40, v132, v96
    v_fmac_f32 v41, v133, v97
    v_fmac_f32 v42, v134, v98
    v_fmac_f32 v43, v135, v99
    buffer_load_dwordx4 v15, s[24:27], s53 offen offset:3072 lds
    v_fmac_f32 v40, v128, v100
    v_fmac_f32 v41, v129, v101
    v_fmac_f32 v42, v130, v102
    v_fmac_f32 v43, v131, v103
    s_add_u32 m0, s54, 4096
    s_and_b32 s52, s52, 2047
    buffer_load_dwordx4 v16, s[24:27], s53 offen offset:0 lds
    v_mul_f32 v172, v40, v172
    v_mul_f32 v173, v41, v173
    v_mul_f32 v174, v42, v174
    v_mul_f32 v175, v43, v175
    buffer_load_dwordx4 v17, s[24:27], s53 offen offset:1024 lds
    v_lshlrev_b32 v176, 16, v84
    v_and_b32 v177, 0xffff0000, v84
    v_lshlrev_b32 v178, 16, v85
    v_and_b32 v179, 0xffff0000, v85
    buffer_load_dwordx4 v18, s[24:27], s53 offen offset:2048 lds
    v_mul_f32 v40, v144, v88
    v_mul_f32 v41, v145, v89
    v_mul_f32 v42, v146, v90
    v_mul_f32 v43, v147, v91
    s_waitcnt vmcnt(13)
    s_barrier
    s_waitcnt vmcnt(12)
    s_mov_b32 s59, 0
L_plp_24:
    v_cmp_ne_u32 vcc, 1, v246
    s_nop 3
    s_cbranch_vccz L_pok_23
    s_sleep 2
    buffer_load_dword v246, v244, s[8:11], 0 offen sc1
    s_waitcnt vmcnt(0)
    s_add_u32 s59, s59, 1
    s_cmp_lt_u32 s59, 0x20000
    s_cbranch_scc1 L_plp_24
L_pok_23:
    s_waitcnt vmcnt(11)
    s_mov_b32 s59, 0
L_plp_26:
    v_cmp_ne_u32 vcc, 1, v247
    s_nop 3
    s_cbranch_vccz L_pok_25
    s_sleep 2
    buffer_load_dword v247, v245, s[8:11], 0 offen sc1
    s_waitcnt vmcnt(0)
    s_add_u32 s59, s59, 1
    s_cmp_lt_u32 s59, 0x20000
    s_cbranch_scc1 L_plp_26
L_pok_25:
    s_cmp_gt_u32 s19, 11
    s_cselect_b32 s12, 11, 12
    s_lshl_b32 s52, s12, 7
    s_mul_i32 s53, s12, 458752
    s_add_u32 m0, s50, 0
    s_add_u32 s54, s51, 0
    buffer_load_dwordx4 v8, s[20:23], s52 offen offset:0 lds
    v_fmac_f32 v40, v140, v92
    v_fmac_f32 v41, v141, v93
    v_fmac_f32 v42, v142, v94
    v_fmac_f32 v43, v143, v95
    buffer_load_dwordx4 v9, s[20:23], s52 offen offset:1024 lds
    v_fmac_f32 v40, v136, v96
    v_fmac_f32 v41, v137, v97
    v_fmac_f32 v42, v138, v98
    v_fmac_f32 v43, v139, v99
    buffer_load_dwordx4 v10, s[20:23], s52 offen offset:2048 lds
    v_fmac_f32 v40, v132, v100
    v_fmac_f32 v41, v133, v101
    v_fmac_f32 v42, v134, v102
    v_fmac_f32 v43, v135, v103
    buffer_load_dwordx4 v11, s[20:23], s52 offen offset:3072 lds
    v_mul_f32 v176, v40, v176
    v_mul_f32 v177, v41, v177
    v_mul_f32 v178, v42, v178
    v_mul_f32 v179, v43, v179
    s_mov_b32 m0, s54
    s_nop 0
    buffer_load_dwordx4 v12, s[24:27], s53 offen offset:0 lds
    v_lshlrev_b32 v7, 11, v183
    v_lshlrev_b32 v4, 1, v182
    v_sub_u32 v4, 4080, v4
    v_add_u32 v7, v7, v4
    buffer_load_dwordx4 v13, s[24:27], s53 offen offset:1024 lds
    v_cvt_pk_bf16_f32 v48, v176, v172
    v_cvt_pk_bf16_f32 v49, v168, v164
    v_cvt_pk_bf16_f32 v50, v160, v156
    v_cvt_pk_bf16_f32 v51, v152, v148
    buffer_load_dwordx4 v14, s[24:27], s53 offen offset:2048 lds
    v_cvt_pk_bf16_f32 v52, v177, v173
    v_cvt_pk_bf16_f32 v53, v169, v165
    v_cvt_pk_bf16_f32 v54, v161, v157
    v_cvt_pk_bf16_f32 v55, v153, v149
    buffer_load_dwordx4 v15, s[24:27], s53 offen offset:3072 lds
    v_cvt_pk_bf16_f32 v56, v178, v174
    v_cvt_pk_bf16_f32 v57, v170, v166
    v_cvt_pk_bf16_f32 v58, v162, v158
    v_cvt_pk_bf16_f32 v59, v154, v150
    s_add_u32 m0, s54, 4096
    s_and_b32 s52, s52, 2047
    buffer_load_dwordx4 v16, s[24:27], s53 offen offset:0 lds
    v_cvt_pk_bf16_f32 v60, v179, v175
    v_cvt_pk_bf16_f32 v61, v171, v167
    v_cvt_pk_bf16_f32 v62, v163, v159
    v_cvt_pk_bf16_f32 v63, v155, v151
    buffer_load_dwordx4 v17, s[24:27], s53 offen offset:1024 lds
    buffer_load_dwordx4 v18, s[24:27], s53 offen offset:2048 lds
    s_add_u32 s32, s98, 0x400000
    s_addc_u32 s33, s99, 0
    s_mov_b32 s34, 0x400000
    s_mov_b32 s35, 0x20000
    s_mov_b32 s47, 0
    buffer_store_dwordx4 v[48:51], v7, s[32:35], s47 offen sc1
    s_mov_b32 s47, 4096
    buffer_store_dwordx4 v[52:55], v7, s[32:35], s47 offen sc1
    s_mov_b32 s47, 8192
    buffer_store_dwordx4 v[56:59], v7, s[32:35], s47 offen sc1
    s_mov_b32 s47, 12288
    buffer_store_dwordx4 v[60:63], v7, s[32:35], s47 offen sc1
    s_waitcnt vmcnt(15)
    s_barrier
    s_cmp_gt_u32 s19, 12
    s_cselect_b32 s12, 12, 13
    s_lshl_b32 s52, s12, 7
    s_mul_i32 s53, s12, 458752
    s_add_u32 m0, s50, 45056
    s_add_u32 s54, s51, 45056
    buffer_load_dwordx4 v8, s[20:23], s52 offen offset:0 lds
    s_add_u32 s32, s98, 0x2510000
    s_addc_u32 s33, s99, 0
    s_mov_b32 s34, 0x38000
    s_mov_b32 s35, 0x20000
    buffer_load_dwordx4 v9, s[20:23], s52 offen offset:1024 lds
    v_min_u32 v250, 55, v0
    v_lshlrev_b32 v4, 4, v250
    s_mul_i32 s42, s15, 896
    v_add_u32 v4, s42, v4
    buffer_load_dwordx4 v10, s[20:23], s52 offen offset:2048 lds
    s_mul_i32 s43, s40, 57344
    buffer_load_dwordx4 v[184:187], v4, s[32:35], s43 offen sc1
    s_add_u32 s43, s43, 14336
    buffer_load_dwordx4 v[188:191], v4, s[32:35], s43 offen sc1
    buffer_load_dwordx4 v11, s[20:23], s52 offen offset:3072 lds
    s_add_u32 s43, s43, 14336
    buffer_load_dwordx4 v[192:195], v4, s[32:35], s43 offen sc1
    s_add_u32 s43, s43, 14336
    buffer_load_dwordx4 v[196:199], v4, s[32:35], s43 offen sc1
    s_mov_b32 m0, s54
    s_nop 0
    buffer_load_dwordx4 v12, s[24:27], s53 offen offset:0 lds
    v_and_b32 v4, 31, v0
    s_lshl_b32 s42, s40, 5
    v_add_u32 v251, s42, v4
    s_lshl_b32 s42, s14, 7
    buffer_load_dwordx4 v13, s[24:27], s53 offen offset:1024 lds
    v_add_u32 v4, s42, v251
    v_lshlrev_b32 v4, 2, v4
    buffer_load_dword v200, v4, s[28:31], 0 offen sc1
    buffer_load_dwordx4 v14, s[24:27], s53 offen offset:2048 lds
    buffer_load_dwordx4 v15, s[24:27], s53 offen offset:3072 lds
    s_add_u32 m0, s54, 4096
    s_and_b32 s52, s52, 2047
    buffer_load_dwordx4 v16, s[24:27], s53 offen offset:0 lds
    buffer_load_dwordx4 v17, s[24:27], s53 offen offset:1024 lds
    buffer_load_dwordx4 v18, s[24:27], s53 offen offset:2048 lds
    s_waitcnt vmcnt(20)
    s_barrier
    s_cmp_gt_u32 s19, 13
    s_cselect_b32 s12, 13, 14
    s_lshl_b32 s52, s12, 7
    s_mul_i32 s53, s12, 458752
    s_add_u32 m0, s50, 90112
    s_add_u32 s54, s51, 90112
    buffer_load_dwordx4 v8, s[20:23], s52 offen offset:0 lds
    buffer_load_dwordx4 v9, s[20:23], s52 offen offset:1024 lds
    buffer_load_dwordx4 v10, s[20:23], s52 offen offset:2048 lds
    buffer_load_dwordx4 v11, s[20:23], s52 offen offset:3072 lds
    s_mov_b32 m0, s54
    s_nop 0
    buffer_load_dwordx4 v12, s[24:27], s53 offen offset:0 lds
    buffer_load_dwordx4 v13, s[24:27], s53 offen offset:1024 lds
    buffer_load_dwordx4 v14, s[24:27], s53 offen offset:2048 lds
    buffer_load_dwordx4 v15, s[24:27], s53 offen offset:3072 lds
    s_add_u32 m0, s54, 4096
    s_and_b32 s52, s52, 2047
    buffer_load_dwordx4 v16, s[24:27], s53 offen offset:0 lds
    buffer_load_dwordx4 v17, s[24:27], s53 offen offset:1024 lds
    buffer_load_dwordx4 v18, s[24:27], s53 offen offset:2048 lds
    s_waitcnt vmcnt(27)
    s_mov_b32 s58, s2
    s_lshl_b32 s58, s58, 2
    s_add_u32 s58, s58, s40
    s_lshl_b32 s58, s58, 2
    s_add_u32 s58, s58, 8192
    v_mov_b32 v4, s58
    v_mov_b32 v5, 1
    buffer_store_dword v5, v4, s[8:11], 0 offen sc1
    s_waitcnt vmcnt(12)
    s_barrier
    s_cmp_gt_u32 s19, 14
    s_cselect_b32 s12, 14, 15
    s_lshl_b32 s52, s12, 7
    s_mul_i32 s53, s12, 458752
    s_add_u32 m0, s50, 0
    s_add_u32 s54, s51, 0
    buffer_load_dwordx4 v8, s[20:23], s52 offen offset:0 lds
    v_add_f32 v184, v184, v188
    v_add_f32 v185, v185, v189
    v_add_f32 v186, v186, v190
    v_add_f32 v187, v187, v191
    buffer_load_dwordx4 v9, s[20:23], s52 offen offset:1024 lds
    v_add_f32 v184, v184, v192
    v_add_f32 v185, v185, v193
    v_add_f32 v186, v186, v194
    v_add_f32 v187, v187, v195
    buffer_load_dwordx4 v10, s[20:23], s52 offen offset:2048 lds
    v_add_f32 v184, v184, v196
    v_add_f32 v185, v185, v197
    v_add_f32 v186, v186, v198
    v_add_f32 v187, v187, v199
    buffer_load_dwordx4 v11, s[20:23], s52 offen offset:3072 lds
    v_sub_f32 v200, 0, v200
    s_mul_i32 s42, s40, 896
    s_add_u32 s42, s42, 137344
    v_lshlrev_b32 v4, 4, v250
    s_mov_b32 m0, s54
    s_nop 0
    buffer_load_dwordx4 v12, s[24:27], s53 offen offset:0 lds
    v_add_u32 v4, s42, v4
    ds_write_b128 v4, v[184:187]
    v_lshlrev_b32 v4, 2, v251
    v_add_u32 v4, 136832, v4
    buffer_load_dwordx4 v13, s[24:27], s53 offen offset:1024 lds
    ds_write_b32 v4, v200
    buffer_load_dwordx4 v14, s[24:27], s53 offen offset:2048 lds
    buffer_load_dwordx4 v15, s[24:27], s53 offen offset:3072 lds
    s_add_u32 m0, s54, 4096
    s_and_b32 s52, s52, 2047
    buffer_load_dwordx4 v16, s[24:27], s53 offen offset:0 lds
    buffer_load_dwordx4 v17, s[24:27], s53 offen offset:1024 lds
    buffer_load_dwordx4 v18, s[24:27], s53 offen offset:2048 lds
    s_mov_b32 s32, s84
    s_mov_b32 s33, s85
    s_mov_b32 s34, 0x400000
    s_mov_b32 s35, 0x20000
    s_add_u32 s36, s98, 0x400000
    s_addc_u32 s37, s99, 0
    s_mov_b32 s38, 0x400000
    s_mov_b32 s39, 0x20000
    s_cmp_eq_u32 s40, 3
    s_cbranch_scc1 L_tail3
    s_cmp_eq_u32 s40, 0
    s_cbranch_scc1 L_tail0
    buffer_load_dwordx4 v[40:43], v19, s[32:35], s57 offen offset:0
    buffer_load_dwordx4 v[40:43], v19, s[32:35], s57 offen offset:1024
    buffer_load_dwordx4 v[40:43], v19, s[32:35], s57 offen offset:2048
    buffer_load_dwordx4 v[40:43], v19, s[32:35], s57 offen offset:3072
    s_waitcnt vmcnt(16)
    s_waitcnt lgkmcnt(0)
    s_barrier
    s_mul_i32 s42, s40, 224
    v_lshlrev_b32 v4, 2, v250
    v_add_u32 v4, s42, v4
    v_add_u32 v5, 137344, v4
    ds_read_b32 v184, v5 offset:0
    ds_read_b32 v185, v5 offset:896
    ds_read_b32 v186, v5 offset:1792
    ds_read_b32 v187, v5 offset:2688
    v_add_u32 v4, 135808, v4
    s_waitcnt lgkmcnt(0)
    v_add_f32 v184, v184, v185
    v_add_f32 v186, v186, v187
    v_add_f32 v184, v184, v186
    ds_write_b32 v4, v184
    buffer_load_dword v249, v248, s[8:11], 0 offen sc1
    s_waitcnt vmcnt(5)
    s_waitcnt lgkmcnt(0)
    s_barrier
    s_waitcnt vmcnt(0)
    s_mov_b32 s59, 0
L_plp_28:
    v_cmp_ne_u32 vcc, 1, v249
    s_nop 3
    s_cbranch_vccz L_pok_27
    s_sleep 2
    buffer_load_dword v249, v248, s[8:11], 0 offen sc1
    s_waitcnt vmcnt(0)
    s_add_u32 s59, s59, 1
    s_cmp_lt_u32 s59, 0x20000
    s_cbranch_scc1 L_plp_28
L_pok_27:
    s_add_u32 m0, s56, 16640
    s_nop 0
    buffer_load_dwordx4 v20, s[36:39], s57 offen sc1 lds
    s_add_u32 m0, s56, 17664
    s_nop 0
    buffer_load_dwordx4 v21, s[36:39], s57 offen sc1 lds
    s_add_u32 m0, s56, 18688
    s_nop 0
    buffer_load_dwordx4 v22, s[36:39], s57 offen sc1 lds
    s_add_u32 m0, s56, 19712
    s_nop 0
    buffer_load_dwordx4 v23, s[36:39], s57 offen sc1 lds
    s_add_u32 m0, s56, 20736
    s_nop 0
    buffer_load_dwordx4 v24, s[36:39], s57 offen sc1 lds
    s_add_u32 m0, s56, 21760
    s_nop 0
    buffer_load_dwordx4 v25, s[36:39], s57 offen sc1 lds
    v_and_b32 v4, 3, v0
    v_lshlrev_b32 v5, 1, v4
    buffer_load_ushort v38, v5, s[32:35], s57 offen
    s_add_u32 m0, s56, 64
    s_add_u32 s47, s57, 2
    buffer_load_dwordx4 v19, s[32:35], s47 offen offset:0 lds
    buffer_load_dwordx4 v19, s[32:35], s47 offen offset:1024 lds
    buffer_load_dwordx4 v19, s[32:35], s47 offen offset:2048 lds
    buffer_load_dwordx4 v19, s[32:35], s47 offen offset:3072 lds
    s_add_u32 m0, s56, 4224
    s_add_u32 s47, s57, 4
    buffer_load_dwordx4 v19, s[32:35], s47 offen offset:0 lds
    buffer_load_dwordx4 v19, s[32:35], s47 offen offset:1024 lds
    buffer_load_dwordx4 v19, s[32:35], s47 offen offset:2048 lds
    buffer_load_dwordx4 v19, s[32:35], s47 offen offset:3072 lds
    s_add_u32 m0, s56, 8384
    s_add_u32 s47, s57, 6
    buffer_load_dwordx4 v19, s[32:35], s47 offen offset:0 lds
    buffer_load_dwordx4 v19, s[32:35], s47 offen offset:1024 lds
    buffer_load_dwordx4 v19, s[32:35], s47 offen offset:2048 lds
    buffer_load_dwordx4 v19, s[32:35], s47 offen offset:3072 lds
    s_add_u32 m0, s56, 12544
    s_add_u32 s47, s57, 8
    buffer_load_dwordx4 v19, s[32:35], s47 offen offset:0 lds
    buffer_load_dwordx4 v19, s[32:35], s47 offen offset:1024 lds
    buffer_load_dwordx4 v19, s[32:35], s47 offen offset:2048 lds
    buffer_load_dwordx4 v19, s[32:35], s47 offen offset:3072 lds
    v_mov_b32 v6, 0
    v_mov_b32 v7, 0
    v_lshrrev_b32 v4, 4, v0
    v_mul_u32_u24 v4, 4160, v4
    v_and_b32 v5, 15, v0
    v_lshlrev_b32 v5, 2, v5
    v_add_u32 v4, v4, v5
    v_add_u32 v4, s56, v4
    ds_write_b32 v4, v6
    v_add_u32 v4, 22784, v5
    v_add_u32 v4, s56, v4
    ds_write_b32 v4, v6
    v_lshrrev_b32 v4, 2, v0
    v_and_b32 v5, 3, v0
    v_cmp_ge_u32 vcc, v4, v5
    v_cmp_gt_u32 s[48:49], 16, v0
    s_nop 1
    s_and_b64 vcc, vcc, s[48:49]
    v_sub_u32 v6, v5, v4
    v_add_u32 v6, 31, v6
    v_lshlrev_b32 v6, 1, v6
    v_mul_u32_u24 v7, 4160, v4
    v_add_u32 v6, v6, v7
    v_add_u32 v6, s56, v6
    s_waitcnt vmcnt(16)
    s_and_saveexec_b64 s[48:49], vcc
    ds_write_b16 v6, v38
    s_mov_b64 exec, s[48:49]
    s_branch L_taildone
L_tail0:
    buffer_load_dwordx4 v[40:43], v19, s[32:35], s57 offen offset:0
    buffer_load_dwordx4 v[40:43], v19, s[32:35], s57 offen offset:1024
    buffer_load_dwordx4 v[40:43], v19, s[32:35], s57 offen offset:2048
    buffer_load_dwordx4 v[40:43], v19, s[32:35], s57 offen offset:3072
    s_waitcnt vmcnt(16)
    s_waitcnt lgkmcnt(0)
    s_barrier
    s_mul_i32 s42, s40, 224
    v_lshlrev_b32 v4, 2, v250
    v_add_u32 v4, s42, v4
    v_add_u32 v5, 137344, v4
    ds_read_b32 v184, v5 offset:0
    ds_read_b32 v185, v5 offset:896
    ds_read_b32 v186, v5 offset:1792
    ds_read_b32 v187, v5 offset:2688
    v_add_u32 v4, 135808, v4
    s_waitcnt lgkmcnt(0)
    v_add_f32 v184, v184, v185
    v_add_f32 v186, v186, v187
    v_add_f32 v184, v184, v186
    ds_write_b32 v4, v184
    buffer_load_dword v249, v248, s[8:11], 0 offen sc1
    v_and_b32 v4, 3, v0
    v_lshlrev_b32 v5, 1, v4
    buffer_load_ushort v38, v5, s[32:35], s57 offen
    s_add_u32 m0, s56, 64
    s_add_u32 s47, s57, 2
    buffer_load_dwordx4 v19, s[32:35], s47 offen offset:0 lds
    buffer_load_dwordx4 v19, s[32:35], s47 offen offset:1024 lds
    buffer_load_dwordx4 v19, s[32:35], s47 offen offset:2048 lds
    buffer_load_dwordx4 v19, s[32:35], s47 offen offset:3072 lds
    s_add_u32 m0, s56, 4224
    s_add_u32 s47, s57, 4
    buffer_load_dwordx4 v19, s[32:35], s47 offen offset:0 lds
    buffer_load_dwordx4 v19, s[32:35], s47 offen offset:1024 lds
    buffer_load_dwordx4 v19, s[32:35], s47 offen offset:2048 lds
    buffer_load_dwordx4 v19, s[32:35], s47 offen offset:3072 lds
    s_add_u32 m0, s56, 8384
    s_add_u32 s47, s57, 6
    buffer_load_dwordx4 v19, s[32:35], s47 offen offset:0 lds
    buffer_load_dwordx4 v19, s[32:35], s47 offen offset:1024 lds
    buffer_load_dwordx4 v19, s[32:35], s47 offen offset:2048 lds
    buffer_load_dwordx4 v19, s[32:35], s47 offen offset:3072 lds
    s_add_u32 m0, s56, 12544
    s_add_u32 s47, s57, 8
    buffer_load_dwordx4 v19, s[32:35], s47 offen offset:0 lds
    buffer_load_dwordx4 v19, s[32:35], s47 offen offset:1024 lds
    buffer_load_dwordx4 v19, s[32:35], s47 offen offset:2048 lds
    buffer_load_dwordx4 v19, s[32:35], s47 offen offset:3072 lds
    s_waitcnt vmcnt(22)
    s_waitcnt lgkmcnt(0)
    s_barrier
    s_waitcnt vmcnt(17)
    s_mov_b32 s59, 0
L_plp_30:
    v_cmp_ne_u32 vcc, 1, v249
    s_nop 3
    s_cbranch_vccz L_pok_29
    s_sleep 2
    buffer_load_dword v249, v248, s[8:11], 0 offen sc1
    s_waitcnt vmcnt(0)
    s_add_u32 s59, s59, 1
    s_cmp_lt_u32 s59, 0x20000
    s_cbranch_scc1 L_plp_30
L_pok_29:
    s_add_u32 m0, s56, 16640
    s_nop 0
    buffer_load_dwordx4 v20, s[36:39], s57 offen sc1 lds
    s_add_u32 m0, s56, 17664
    s_nop 0
    buffer_load_dwordx4 v21, s[36:39], s57 offen sc1 lds
    s_add_u32 m0, s56, 18688
    s_nop 0
    buffer_load_dwordx4 v22, s[36:39], s57 offen sc1 lds
    s_add_u32 m0, s56, 19712
    s_nop 0
    buffer_load_dwordx4 v23, s[36:39], s57 offen sc1 lds
    s_add_u32 m0, s56, 20736
    s_nop 0
    buffer_load_dwordx4 v24, s[36:39], s57 offen sc1 lds
    s_add_u32 m0, s56, 21760
    s_nop 0
    buffer_load_dwordx4 v25, s[36:39], s57 offen sc1 lds
    v_mov_b32 v6, 0
    v_mov_b32 v7, 0
    v_lshrrev_b32 v4, 4, v0
    v_mul_u32_u24 v4, 4160, v4
    v_and_b32 v5, 15, v0
    v_lshlrev_b32 v5, 2, v5
    v_add_u32 v4, v4, v5
    v_add_u32 v4, s56, v4
    ds_write_b32 v4, v6
    v_add_u32 v4, 22784, v5
    v_add_u32 v4, s56, v4
    ds_write_b32 v4, v6
    v_lshrrev_b32 v4, 2, v0
    v_and_b32 v5, 3, v0
    v_cmp_ge_u32 vcc, v4, v5
    v_cmp_gt_u32 s[48:49], 16, v0
    s_nop 1
    s_and_b64 vcc, vcc, s[48:49]
    v_sub_u32 v6, v5, v4
    v_add_u32 v6, 31, v6
    v_lshlrev_b32 v6, 1, v6
    v_mul_u32_u24 v7, 4160, v4
    v_add_u32 v6, v6, v7
    v_add_u32 v6, s56, v6
    s_waitcnt vmcnt(22)
    s_and_saveexec_b64 s[48:49], vcc
    ds_write_b16 v6, v38
    s_mov_b64 exec, s[48:49]
    s_branch L_taildone
L_tail3:
    v_and_b32 v4, 3, v0
    v_lshlrev_b32 v5, 1, v4
    buffer_load_ushort v38, v5, s[32:35], s57 offen
    s_add_u32 m0, s56, 64
    s_add_u32 s47, s57, 2
    buffer_load_dwordx4 v19, s[32:35], s47 offen offset:0 lds
    buffer_load_dwordx4 v19, s[32:35], s47 offen offset:1024 lds
    buffer_load_dwordx4 v19, s[32:35], s47 offen offset:2048 lds
    buffer_load_dwordx4 v19, s[32:35], s47 offen offset:3072 lds
    s_add_u32 m0, s56, 4224
    s_add_u32 s47, s57, 4
    buffer_load_dwordx4 v19, s[32:35], s47 offen offset:0 lds
    buffer_load_dwordx4 v19, s[32:35], s47 offen offset:1024 lds
    buffer_load_dwordx4 v19, s[32:35], s47 offen offset:2048 lds
    buffer_load_dwordx4 v19, s[32:35], s47 offen offset:3072 lds
    s_add_u32 m0, s56, 8384
    s_add_u32 s47, s57, 6
    buffer_load_dwordx4 v19, s[32:35], s47 offen offset:0 lds
    buffer_load_dwordx4 v19, s[32:35], s47 offen offset:1024 lds
    buffer_load_dwordx4 v19, s[32:35], s47 offen offset:2048 lds
    buffer_load_dwordx4 v19, s[32:35], s47 offen offset:3072 lds
    s_add_u32 m0, s56, 12544
    s_add_u32 s47, s57, 8
    buffer_load_dwordx4 v19, s[32:35], s47 offen offset:0 lds
    buffer_load_dwordx4 v19, s[32:35], s47 offen offset:1024 lds
    buffer_load_dwordx4 v19, s[32:35], s47 offen offset:2048 lds
    buffer_load_dwordx4 v19, s[32:35], s47 offen offset:3072 lds
    s_waitcnt vmcnt(29)
    s_waitcnt lgkmcnt(0)
    s_barrier
    s_mul_i32 s42, s40, 224
    v_lshlrev_b32 v4, 2, v250
    v_add_u32 v4, s42, v4
    v_add_u32 v5, 137344, v4
    ds_read_b32 v184, v5 offset:0
    ds_read_b32 v185, v5 offset:896
    ds_read_b32 v186, v5 offset:1792
    ds_read_b32 v187, v5 offset:2688
    v_add_u32 v4, 135808, v4
    s_waitcnt lgkmcnt(0)
    v_add_f32 v184, v184, v185
    v_add_f32 v186, v186, v187
    v_add_f32 v184, v184, v186
    ds_write_b32 v4, v184
    buffer_load_dword v249, v248, s[8:11], 0 offen sc1
    s_waitcnt vmcnt(18)
    s_waitcnt lgkmcnt(0)
    s_barrier
    s_waitcnt vmcnt(0)
    s_mov_b32 s59, 0
L_plp_32:
    v_cmp_ne_u32 vcc, 1, v249
    s_nop 3
    s_cbranch_vccz L_pok_31
    s_sleep 2
    buffer_load_dword v249, v248, s[8:11], 0 offen sc1
    s_waitcnt vmcnt(0)
    s_add_u32 s59, s59, 1
    s_cmp_lt_u32 s59, 0x20000
    s_cbranch_scc1 L_plp_32
L_pok_31:
    s_add_u32 m0, s56, 16640
    s_nop 0
    buffer_load_dwordx4 v20, s[36:39], s57 offen sc1 lds
    s_add_u32 m0, s56, 17664
    s_nop 0
    buffer_load_dwordx4 v21, s[36:39], s57 offen sc1 lds
    s_add_u32 m0, s56, 18688
    s_nop 0
    buffer_load_dwordx4 v22, s[36:39], s57 offen sc1 lds
    s_add_u32 m0, s56, 19712
    s_nop 0
    buffer_load_dwordx4 v23, s[36:39], s57 offen sc1 lds
    s_add_u32 m0, s56, 20736
    s_nop 0
    buffer_load_dwordx4 v24, s[36:39], s57 offen sc1 lds
    s_add_u32 m0, s56, 21760
    s_nop 0
    buffer_load_dwordx4 v25, s[36:39], s57 offen sc1 lds
    v_mov_b32 v6, 0
    v_mov_b32 v7, 0
    v_lshrrev_b32 v4, 4, v0
    v_mul_u32_u24 v4, 4160, v4
    v_and_b32 v5, 15, v0
    v_lshlrev_b32 v5, 2, v5
    v_add_u32 v4, v4, v5
    v_add_u32 v4, s56, v4
    ds_write_b32 v4, v6
    v_add_u32 v4, 22784, v5
    v_add_u32 v4, s56, v4
    ds_write_b32 v4, v6
    v_lshrrev_b32 v4, 2, v0
    v_and_b32 v5, 3, v0
    v_cmp_ge_u32 vcc, v4, v5
    v_cmp_gt_u32 s[48:49], 16, v0
    s_nop 1
    s_and_b64 vcc, vcc, s[48:49]
    v_sub_u32 v6, v5, v4
    v_add_u32 v6, 31, v6
    v_lshlrev_b32 v6, 1, v6
    v_mul_u32_u24 v7, 4160, v4
    v_add_u32 v6, v6, v7
    v_add_u32 v6, s56, v6
    s_and_saveexec_b64 s[48:49], vcc
    ds_write_b16 v6, v38
    s_mov_b64 exec, s[48:49]
L_taildone:
    s_lshl_b32 s41, s17, 3
    s_lshl_b32 s42, s40, 1
    s_add_u32 s41, s41, s42
    s_mul_i32 s41, s41, 112
    s_mul_i32 s42, s16, 56
    s_add_u32 s41, s41, s42
    s_and_b32 s13, s2, 2
    s_mul_i32 s42, s13, 14
    s_add_u32 s41, s41, s42
    s_lshl_b32 s52, s41, 10
    s_add_u32 s55, s52, 114688
    s_lshl_b32 s50, s40, 12
    s_add_u32 s51, s50, 16384
    s_mul_i32 s53, s13, 917504
    s_waitcnt vmcnt(0)
    s_waitcnt lgkmcnt(0)
    s_barrier
    v_lshrrev_b32 v2, 4, v0
    v_and_b32 v3, 15, v0
    s_lshl_b32 s43, s40, 4
    s_mul_i32 s44, s16, 3670016
    s_lshl_b32 s46, s18, 8
    s_add_u32 s44, s44, s46
    v_add_u32 v4, 0, v2
    v_and_b32 v5, 7, v4
    v_lshlrev_b32 v5, 1, v5
    v_xor_b32 v5, v5, v3
    v_lshlrev_b32 v5, 4, v5
    v_add_u32 v4, s43, v4
    v_lshlrev_b32 v4, 11, v4
    v_add3_u32 v4, v4, v5, s44
    v_subrev_u32 v25, 0, v4
    v_add_u32 v4, 4, v2
    v_and_b32 v5, 7, v4
    v_lshlrev_b32 v5, 1, v5
    v_xor_b32 v5, v5, v3
    v_lshlrev_b32 v5, 4, v5
    v_add_u32 v4, s43, v4
    v_lshlrev_b32 v4, 11, v4
    v_add3_u32 v4, v4, v5, s44
    v_subrev_u32 v26, 1024, v4
    v_add_u32 v4, 8, v2
    v_and_b32 v5, 7, v4
    v_lshlrev_b32 v5, 1, v5
    v_xor_b32 v5, v5, v3
    v_lshlrev_b32 v5, 4, v5
    v_add_u32 v4, s43, v4
    v_lshlrev_b32 v4, 11, v4
    v_add3_u32 v4, v4, v5, s44
    v_subrev_u32 v27, 2048, v4
    v_add_u32 v4, 12, v2
    v_and_b32 v5, 7, v4
    v_lshlrev_b32 v5, 1, v5
    v_xor_b32 v5, v5, v3
    v_lshlrev_b32 v5, 4, v5
    v_add_u32 v4, s43, v4
    v_lshlrev_b32 v4, 11, v4
    v_add3_u32 v4, v4, v5, s44
    v_subrev_u32 v28, 3072, v4
    s_lshl_b32 s41, s17, 7
    s_lshl_b32 s42, s16, 5
    s_add_u32 s41, s41, s42
    s_lshr_b32 s42, s40, 1
    s_lshl_b32 s42, s42, 6
    s_add_u32 s41, s41, s42
    s_and_b32 s42, s40, 1
    s_lshl_b32 s42, s42, 4
    s_add_u32 s41, s41, s42
    s_lshl_b32 s43, s18, 8
    v_add_u32 v4, 0, v2
    v_xor_b32 v5, v4, v3
    v_lshlrev_b32 v5, 4, v5
    v_add_u32 v4, s41, v4
    v_lshlrev_b32 v4, 11, v4
    v_add3_u32 v4, v4, v5, s43
    v_subrev_u32 v29, 0, v4
    v_add_u32 v4, 4, v2
    v_xor_b32 v5, v4, v3
    v_lshlrev_b32 v5, 4, v5
    v_add_u32 v4, s41, v4
    v_lshlrev_b32 v4, 11, v4
    v_add3_u32 v4, v4, v5, s43
    v_subrev_u32 v30, 1024, v4
    v_add_u32 v4, 8, v2
    v_xor_b32 v5, v4, v3
    v_lshlrev_b32 v5, 4, v5
    v_add_u32 v4, s41, v4
    v_lshlrev_b32 v4, 11, v4
    v_add3_u32 v4, v4, v5, s43
    v_subrev_u32 v31, 2048, v4
    v_add_u32 v4, 12, v2
    v_xor_b32 v5, v4, v3
    v_lshlrev_b32 v5, 4, v5
    v_add_u32 v4, s41, v4
    v_lshlrev_b32 v4, 11, v4
    v_add3_u32 v4, v4, v5, s43
    v_subrev_u32 v32, 3072, v4
    v_lshrrev_b32 v2, 3, v0
    v_and_b32 v3, 7, v0
    v_lshrrev_b32 v4, 1, v2
    v_and_b32 v4, 3, v4
    v_lshlrev_b32 v4, 1, v4
    v_xor_b32 v4, v4, v3
    v_lshrrev_b32 v5, 2, v4
    v_lshlrev_b32 v5, 7, v5
    v_and_b32 v4, 3, v4
    v_lshlrev_b32 v4, 4, v4
    v_add_u32 v4, v4, v5
    s_lshl_b32 s41, s17, 8
    s_lshl_b32 s42, s16, 6
    s_add_u32 s41, s41, s42
    s_lshl_b32 s42, s18, 7
    s_lshl_b32 s43, s40, 5
    s_add_u32 s42, s42, s43
    v_add_u32 v4, s41, v4
    v_add_u32 v5, 0, v2
    v_add_u32 v5, s42, v5
    v_lshlrev_b32 v5, 12, v5
    v_add_u32 v5, v5, v4
    v_subrev_u32 v33, 0, v5
    v_add_u32 v5, 8, v2
    v_add_u32 v5, s42, v5
    v_lshlrev_b32 v5, 12, v5
    v_add_u32 v5, v5, v4
    v_subrev_u32 v34, 1024, v5
    v_add_u32 v5, 16, v2
    v_add_u32 v5, s42, v5
    v_lshlrev_b32 v5, 12, v5
    v_add_u32 v5, v5, v4
    v_subrev_u32 v35, 2048, v5
    v_add_u32 v5, 24, v2
    v_add_u32 v5, s42, v5
    v_lshlrev_b32 v5, 12, v5
    v_add_u32 v5, v5, v4
    v_subrev_u32 v36, 3072, v5
    s_barrier
    s_mov_b32 s24, s92
    s_mov_b32 s25, s93
    s_mov_b32 s26, 0x700000
    s_mov_b32 s27, 0x20000
    s_mul_i32 s46, s2, 28672
    s_mul_i32 s47, s40, 7168
    s_add_u32 s46, s46, s47
    s_add_u32 s46, s46, 0
    buffer_load_dwordx4 v[40:43], v19, s[24:27], s46 offen
    s_add_u32 s46, s46, 1024
    buffer_load_dwordx4 v[40:43], v19, s[24:27], s46 offen
    s_add_u32 s46, s46, 1024
    buffer_load_dwordx4 v[40:43], v19, s[24:27], s46 offen
    s_add_u32 s46, s46, 1024
    buffer_load_dwordx4 v[40:43], v19, s[24:27], s46 offen
    s_add_u32 s46, s46, 1024
    buffer_load_dwordx4 v[40:43], v19, s[24:27], s46 offen
    s_add_u32 s46, s46, 1024
    buffer_load_dwordx4 v[40:43], v19, s[24:27], s46 offen
    s_add_u32 s46, s46, 1024
    buffer_load_dwordx4 v[40:43], v19, s[24:27], s46 offen
    s_add_u32 s46, s46, 1024
    s_add_u32 s4, s98, 0x400000
    s_addc_u32 s5, s99, 0
    s_mov_b32 s6, 0x400000
    s_mov_b32 s7, 0x20000
    s_lshl_b32 s46, s2, 14
    s_lshl_b32 s47, s40, 12
    s_add_u32 s46, s46, s47
    v_mov_b32 v44, -1
    v_mov_b32 v45, -1
    v_mov_b32 v46, -1
    v_mov_b32 v47, -1
    buffer_store_dwordx4 v[44:47], v19, s[4:7], s46 offen offset:0 sc1
    buffer_store_dwordx4 v[44:47], v19, s[4:7], s46 offen offset:1024 sc1
    buffer_store_dwordx4 v[44:47], v19, s[4:7], s46 offen offset:2048 sc1
    buffer_store_dwordx4 v[44:47], v19, s[4:7], s46 offen offset:3072 sc1
    s_add_u32 s20, s98, 0xc00000
    s_addc_u32 s21, s99, 0
    s_mov_b32 s22, 0xe00000
    s_mov_b32 s23, 0x20000
    s_mov_b32 s24, s92
    s_mov_b32 s25, s93
    s_mov_b32 s26, 0x700000
    s_mov_b32 s27, 0x20000
    s_lshl_b32 s42, s17, 4
    s_lshl_b32 s43, s16, 3
    s_add_u32 s42, s42, s43
    s_lshl_b32 s42, s42, 4
    s_add_u32 s42, s42, 12288
    v_and_b32 v4, 31, v0
    v_lshlrev_b32 v4, 2, v4
    v_add_u32 v244, s42, v4
    s_lshl_b32 s43, s13, 5
    s_add_u32 s42, s42, s43
    v_and_b32 v4, 7, v0
    v_lshlrev_b32 v4, 2, v4
    v_add_u32 v240, s42, v4
    buffer_load_dword v241, v240, s[8:11], 0 offen sc1
    s_waitcnt vmcnt(0)
    s_mov_b32 s59, 0
L_plp_34:
    v_cmp_ne_u32 vcc, 1, v241
    s_nop 3
    s_cbranch_vccz L_pok_33
    s_sleep 2
    buffer_load_dword v241, v240, s[8:11], 0 offen sc1
    s_waitcnt vmcnt(0)
    s_add_u32 s59, s59, 1
    s_cmp_lt_u32 s59, 0x20000
    s_cbranch_scc1 L_plp_34
L_pok_33:
    s_mov_b32 s58, s2
    s_lshl_b32 s58, s58, 2
    s_add_u32 s58, s58, s40
    s_lshl_b32 s58, s58, 2
    s_add_u32 s58, s58, 20480
    v_mov_b32 v4, s58
    v_mov_b32 v5, 1
    buffer_store_dword v5, v4, s[8:11], 0 offen sc1
    s_add_u32 m0, s50, 0
    s_add_u32 s54, s51, 0
    buffer_load_dwordx4 v19, s[20:23], s52 offen sc1 lds
    buffer_load_dwordx4 v19, s[20:23], s52 offen offset:1024 sc1 lds
    s_add_u32 m0, m0, 2048
    s_add_u32 s52, s52, 2048
    buffer_load_dwordx4 v19, s[20:23], s55 offen sc1 lds
    buffer_load_dwordx4 v19, s[20:23], s55 offen offset:1024 sc1 lds
    s_mov_b32 m0, s54
    s_add_u32 s55, s55, 2048
    buffer_load_dwordx4 v25, s[24:27], s53 offen offset:0 lds
    buffer_load_dwordx4 v26, s[24:27], s53 offen offset:1024 lds
    buffer_load_dwordx4 v27, s[24:27], s53 offen offset:2048 lds
    buffer_load_dwordx4 v28, s[24:27], s53 offen offset:3072 lds
    s_add_u32 s53, s53, 131072
    s_add_u32 m0, s50, 32768
    s_add_u32 s54, s51, 32768
    buffer_load_dwordx4 v19, s[20:23], s52 offen sc1 lds
    buffer_load_dwordx4 v19, s[20:23], s52 offen offset:1024 sc1 lds
    s_add_u32 m0, m0, 2048
    s_add_u32 s52, s52, 2048
    buffer_load_dwordx4 v19, s[20:23], s55 offen sc1 lds
    buffer_load_dwordx4 v19, s[20:23], s55 offen offset:1024 sc1 lds
    s_mov_b32 m0, s54
    s_add_u32 s55, s55, 2048
    buffer_load_dwordx4 v25, s[24:27], s53 offen offset:0 lds
    buffer_load_dwordx4 v26, s[24:27], s53 offen offset:1024 lds
    buffer_load_dwordx4 v27, s[24:27], s53 offen offset:2048 lds
    buffer_load_dwordx4 v28, s[24:27], s53 offen offset:3072 lds
    s_add_u32 s53, s53, 131072
    s_xor_b32 s42, s2, 4
    s_lshl_b32 s42, s42, 4
    s_add_u32 s42, s42, 20480
    v_and_b32 v4, 3, v0
    v_lshlrev_b32 v4, 2, v4
    v_add_u32 v242, s42, v4
    s_mov_b32 s28, s76
    s_mov_b32 s29, s77
    s_mov_b32 s30, 0x400000
    s_mov_b32 s31, 0x20000
    s_add_u32 s32, s98, 0x800000
    s_addc_u32 s33, s99, 0
    s_mov_b32 s34, 0x400000
    s_mov_b32 s35, 0x20000
    s_lshl_b32 s42, s18, 9
    s_add_u32 s42, s42, 16384
    v_lshlrev_b32 v4, 3, v0
    v_add_u32 v238, s42, v4
    s_waitcnt vmcnt(8)
    s_barrier
    s_add_u32 m0, s50, 65536
    s_add_u32 s54, s51, 65536
    buffer_load_dwordx4 v19, s[20:23], s52 offen sc1 lds
    buffer_load_dwordx4 v19, s[20:23], s52 offen offset:1024 sc1 lds
    s_add_u32 m0, m0, 2048
    s_add_u32 s52, s52, 2048
    buffer_load_dwordx4 v19, s[20:23], s55 offen sc1 lds
    buffer_load_dwordx4 v19, s[20:23], s55 offen offset:1024 sc1 lds
    s_mov_b32 m0, s54
    s_add_u32 s55, s55, 2048
    buffer_load_dwordx4 v25, s[24:27], s53 offen offset:0 lds
    buffer_load_dwordx4 v26, s[24:27], s53 offen offset:1024 lds
    buffer_load_dwordx4 v27, s[24:27], s53 offen offset:2048 lds
    buffer_load_dwordx4 v28, s[24:27], s53 offen offset:3072 lds
    s_add_u32 s53, s53, 131072
    s_add_u32 m0, s50, 98304
    s_add_u32 s54, s51, 98304
    buffer_load_dwordx4 v19, s[20:23], s52 offen sc1 lds
    buffer_load_dwordx4 v19, s[20:23], s52 offen offset:1024 sc1 lds
    s_add_u32 m0, m0, 2048
    s_add_u32 s52, s52, 2048
    buffer_load_dwordx4 v19, s[20:23], s55 offen sc1 lds
    buffer_load_dwordx4 v19, s[20:23], s55 offen offset:1024 sc1 lds
    s_mov_b32 m0, s54
    s_add_u32 s55, s55, 2048
    buffer_load_dwordx4 v25, s[24:27], s53 offen offset:0 lds
    buffer_load_dwordx4 v26, s[24:27], s53 offen offset:1024 lds
    buffer_load_dwordx4 v27, s[24:27], s53 offen offset:2048 lds
    buffer_load_dwordx4 v28, s[24:27], s53 offen offset:3072 lds
    s_add_u32 s53, s53, 131072
    s_waitcnt vmcnt(16)
    s_barrier
    s_add_u32 m0, s50, 131072
    s_add_u32 s54, s51, 131072
    buffer_load_dwordx4 v19, s[20:23], s52 offen sc1 lds
    buffer_load_dwordx4 v19, s[20:23], s52 offen offset:1024 sc1 lds
    s_add_u32 m0, m0, 2048
    s_add_u32 s52, s52, 2048
    buffer_load_dwordx4 v19, s[20:23], s55 offen sc1 lds
    buffer_load_dwordx4 v19, s[20:23], s55 offen offset:1024 sc1 lds
    s_mov_b32 m0, s54
    s_add_u32 s55, s55, 2048
    buffer_load_dwordx4 v25, s[24:27], s53 offen offset:0 lds
    buffer_load_dwordx4 v26, s[24:27], s53 offen offset:1024 lds
    buffer_load_dwordx4 v27, s[24:27], s53 offen offset:2048 lds
    buffer_load_dwordx4 v28, s[24:27], s53 offen offset:3072 lds
    s_add_u32 s53, s53, 131072
    s_waitcnt vmcnt(16)
    s_barrier
    s_add_u32 m0, s50, 0
    s_add_u32 s54, s51, 0
    buffer_load_dwordx4 v19, s[20:23], s52 offen sc1 lds
    buffer_load_dwordx4 v19, s[20:23], s52 offen offset:1024 sc1 lds
    s_add_u32 m0, m0, 2048
    s_add_u32 s52, s52, 2048
    buffer_load_dwordx4 v19, s[20:23], s55 offen sc1 lds
    buffer_load_dwordx4 v19, s[20:23], s55 offen offset:1024 sc1 lds
    s_mov_b32 m0, s54
    s_add_u32 s55, s55, 2048
    buffer_load_dwordx4 v25, s[24:27], s53 offen offset:0 lds
    buffer_load_dwordx4 v26, s[24:27], s53 offen offset:1024 lds
    buffer_load_dwordx4 v27, s[24:27], s53 offen offset:2048 lds
    buffer_load_dwordx4 v28, s[24:27], s53 offen offset:3072 lds
    s_add_u32 s53, s53, 131072
    buffer_load_dword v246, v244, s[8:11], 0 offen sc1
    s_waitcnt vmcnt(17)
    s_barrier
    s_add_u32 m0, s50, 32768
    s_add_u32 s54, s51, 32768
    buffer_load_dwordx4 v19, s[20:23], s52 offen sc1 lds
    buffer_load_dwordx4 v19, s[20:23], s52 offen offset:1024 sc1 lds
    s_add_u32 m0, m0, 2048
    s_add_u32 s52, s52, 2048
    buffer_load_dwordx4 v19, s[20:23], s55 offen sc1 lds
    buffer_load_dwordx4 v19, s[20:23], s55 offen offset:1024 sc1 lds
    s_mov_b32 m0, s54
    s_add_u32 s55, s55, 2048
    buffer_load_dwordx4 v25, s[24:27], s53 offen offset:0 lds
    buffer_load_dwordx4 v26, s[24:27], s53 offen offset:1024 lds
    buffer_load_dwordx4 v27, s[24:27], s53 offen offset:2048 lds
    buffer_load_dwordx4 v28, s[24:27], s53 offen offset:3072 lds
    s_add_u32 s53, s53, 131072
    s_waitcnt vmcnt(17)
    s_barrier
    s_waitcnt vmcnt(8)
    s_mov_b32 s59, 0
L_plp_36:
    v_cmp_ne_u32 vcc, 1, v246
    s_nop 3
    s_cbranch_vccz L_pok_35
    s_sleep 2
    buffer_load_dword v246, v244, s[8:11], 0 offen sc1
    s_waitcnt vmcnt(0)
    s_add_u32 s59, s59, 1
    s_cmp_lt_u32 s59, 0x20000
    s_cbranch_scc1 L_plp_36
L_pok_35:
    s_add_u32 m0, s50, 65536
    s_add_u32 s54, s51, 65536
    buffer_load_dwordx4 v19, s[20:23], s52 offen sc1 lds
    buffer_load_dwordx4 v19, s[20:23], s52 offen offset:1024 sc1 lds
    s_add_u32 m0, m0, 2048
    s_add_u32 s52, s52, 2048
    buffer_load_dwordx4 v19, s[20:23], s55 offen sc1 lds
    buffer_load_dwordx4 v19, s[20:23], s55 offen offset:1024 sc1 lds
    s_mov_b32 m0, s54
    s_add_u32 s55, s55, 2048
    buffer_load_dwordx4 v25, s[24:27], s53 offen offset:0 lds
    buffer_load_dwordx4 v26, s[24:27], s53 offen offset:1024 lds
    buffer_load_dwordx4 v27, s[24:27], s53 offen offset:2048 lds
    buffer_load_dwordx4 v28, s[24:27], s53 offen offset:3072 lds
    s_add_u32 s53, s53, 131072
    s_barrier
    s_add_u32 m0, s50, 98304
    s_add_u32 s54, s51, 98304
    buffer_load_dwordx4 v19, s[20:23], s52 offen sc1 lds
    buffer_load_dwordx4 v19, s[20:23], s52 offen offset:1024 sc1 lds
    s_add_u32 m0, m0, 2048
    s_add_u32 s52, s52, 2048
    buffer_load_dwordx4 v19, s[20:23], s55 offen sc1 lds
    buffer_load_dwordx4 v19, s[20:23], s55 offen offset:1024 sc1 lds
    s_mov_b32 m0, s54
    s_add_u32 s55, s55, 2048
    buffer_load_dwordx4 v25, s[24:27], s53 offen offset:0 lds
    buffer_load_dwordx4 v26, s[24:27], s53 offen offset:1024 lds
    buffer_load_dwordx4 v27, s[24:27], s53 offen offset:2048 lds
    buffer_load_dwordx4 v28, s[24:27], s53 offen offset:3072 lds
    s_add_u32 s53, s53, 131072
    s_mov_b32 s58, s2
    s_lshl_b32 s58, s58, 2
    s_add_u32 s58, s58, s40
    s_lshl_b32 s58, s58, 2
    s_add_u32 s58, s58, 16384
    v_mov_b32 v4, s58
    v_mov_b32 v5, 1
    buffer_store_dword v5, v4, s[8:11], 0 offen sc1
    s_waitcnt vmcnt(17)
    s_barrier
    s_add_u32 m0, s50, 131072
    s_add_u32 s54, s51, 131072
    buffer_load_dwordx4 v19, s[20:23], s52 offen sc1 lds
    buffer_load_dwordx4 v19, s[20:23], s52 offen offset:1024 sc1 lds
    s_add_u32 m0, m0, 2048
    s_add_u32 s52, s52, 2048
    buffer_load_dwordx4 v19, s[20:23], s55 offen sc1 lds
    buffer_load_dwordx4 v19, s[20:23], s55 offen offset:1024 sc1 lds
    s_mov_b32 m0, s54
    s_add_u32 s55, s55, 2048
    buffer_load_dwordx4 v25, s[24:27], s53 offen offset:0 lds
    buffer_load_dwordx4 v26, s[24:27], s53 offen offset:1024 lds
    buffer_load_dwordx4 v27, s[24:27], s53 offen offset:2048 lds
    buffer_load_dwordx4 v28, s[24:27], s53 offen offset:3072 lds
    s_add_u32 s53, s53, 131072
    s_waitcnt vmcnt(17)
    s_barrier
    s_add_u32 m0, s50, 0
    s_add_u32 s54, s51, 0
    buffer_load_dwordx4 v19, s[20:23], s52 offen sc1 lds
    buffer_load_dwordx4 v19, s[20:23], s52 offen offset:1024 sc1 lds
    s_add_u32 m0, m0, 2048
    s_add_u32 s52, s52, 2048
    buffer_load_dwordx4 v19, s[20:23], s55 offen sc1 lds
    buffer_load_dwordx4 v19, s[20:23], s55 offen offset:1024 sc1 lds
    s_mov_b32 m0, s54
    s_add_u32 s55, s55, 2048
    buffer_load_dwordx4 v25, s[24:27], s53 offen offset:0 lds
    buffer_load_dwordx4 v26, s[24:27], s53 offen offset:1024 lds
    buffer_load_dwordx4 v27, s[24:27], s53 offen offset:2048 lds
    buffer_load_dwordx4 v28, s[24:27], s53 offen offset:3072 lds
    s_add_u32 s53, s53, 131072
    s_waitcnt vmcnt(17)
    s_barrier
    s_add_u32 m0, s50, 32768
    s_add_u32 s54, s51, 32768
    buffer_load_dwordx4 v19, s[20:23], s52 offen sc1 lds
    buffer_load_dwordx4 v19, s[20:23], s52 offen offset:1024 sc1 lds
    s_add_u32 m0, m0, 2048
    s_add_u32 s52, s52, 2048
    buffer_load_dwordx4 v19, s[20:23], s55 offen sc1 lds
    buffer_load_dwordx4 v19, s[20:23], s55 offen offset:1024 sc1 lds
    s_mov_b32 m0, s54
    s_add_u32 s55, s55, 2048
    buffer_load_dwordx4 v25, s[24:27], s53 offen offset:0 lds
    buffer_load_dwordx4 v26, s[24:27], s53 offen offset:1024 lds
    buffer_load_dwordx4 v27, s[24:27], s53 offen offset:2048 lds
    buffer_load_dwordx4 v28, s[24:27], s53 offen offset:3072 lds
    s_add_u32 s53, s53, 131072
    s_waitcnt vmcnt(16)
    s_barrier
    s_add_u32 m0, s50, 65536
    s_add_u32 s54, s51, 65536
    buffer_load_dwordx4 v19, s[20:23], s52 offen sc1 lds
    buffer_load_dwordx4 v19, s[20:23], s52 offen offset:1024 sc1 lds
    s_add_u32 m0, m0, 2048
    s_add_u32 s52, s52, 2048
    buffer_load_dwordx4 v19, s[20:23], s55 offen sc1 lds
    buffer_load_dwordx4 v19, s[20:23], s55 offen offset:1024 sc1 lds
    s_mov_b32 m0, s54
    s_add_u32 s55, s55, 2048
    buffer_load_dwordx4 v25, s[24:27], s53 offen offset:0 lds
    buffer_load_dwordx4 v26, s[24:27], s53 offen offset:1024 lds
    buffer_load_dwordx4 v27, s[24:27], s53 offen offset:2048 lds
    buffer_load_dwordx4 v28, s[24:27], s53 offen offset:3072 lds
    s_add_u32 s53, s53, 131072
    s_waitcnt vmcnt(16)
    s_barrier
    s_add_u32 m0, s50, 98304
    s_add_u32 s54, s51, 98304
    buffer_load_dwordx4 v19, s[20:23], s52 offen sc1 lds
    buffer_load_dwordx4 v19, s[20:23], s52 offen offset:1024 sc1 lds
    s_add_u32 m0, m0, 2048
    s_add_u32 s52, s52, 2048
    buffer_load_dwordx4 v19, s[20:23], s55 offen sc1 lds
    buffer_load_dwordx4 v19, s[20:23], s55 offen offset:1024 sc1 lds
    s_mov_b32 m0, s54
    s_add_u32 s55, s55, 2048
    buffer_load_dwordx4 v25, s[24:27], s53 offen offset:0 lds
    buffer_load_dwordx4 v26, s[24:27], s53 offen offset:1024 lds
    buffer_load_dwordx4 v27, s[24:27], s53 offen offset:2048 lds
    buffer_load_dwordx4 v28, s[24:27], s53 offen offset:3072 lds
    s_add_u32 s53, s53, 131072
    s_cmp_eq_u32 s13, 2
    s_cselect_b32 s12, 57344, 0
    s_cselect_b32 s41, 3670016, 0
    s_sub_u32 s52, s52, s12
    s_sub_u32 s55, s55, s12
    s_sub_u32 s53, s53, s41
    s_waitcnt vmcnt(16)
    s_barrier
    s_add_u32 m0, s50, 131072
    s_add_u32 s54, s51, 131072
    buffer_load_dwordx4 v19, s[20:23], s52 offen sc1 lds
    buffer_load_dwordx4 v19, s[20:23], s52 offen offset:1024 sc1 lds
    s_add_u32 m0, m0, 2048
    s_add_u32 s52, s52, 2048
    buffer_load_dwordx4 v19, s[20:23], s55 offen sc1 lds
    buffer_load_dwordx4 v19, s[20:23], s55 offen offset:1024 sc1 lds
    s_mov_b32 m0, s54
    s_add_u32 s55, s55, 2048
    buffer_load_dwordx4 v25, s[24:27], s53 offen offset:0 lds
    buffer_load_dwordx4 v26, s[24:27], s53 offen offset:1024 lds
    buffer_load_dwordx4 v27, s[24:27], s53 offen offset:2048 lds
    buffer_load_dwordx4 v28, s[24:27], s53 offen offset:3072 lds
    s_add_u32 s53, s53, 131072
    s_waitcnt vmcnt(16)
    s_barrier
    s_add_u32 m0, s50, 0
    s_add_u32 s54, s51, 0
    buffer_load_dwordx4 v19, s[20:23], s52 offen sc1 lds
    buffer_load_dwordx4 v19, s[20:23], s52 offen offset:1024 sc1 lds
    s_add_u32 m0, m0, 2048
    s_add_u32 s52, s52, 2048
    buffer_load_dwordx4 v19, s[20:23], s55 offen sc1 lds
    buffer_load_dwordx4 v19, s[20:23], s55 offen offset:1024 sc1 lds
    s_mov_b32 m0, s54
    s_add_u32 s55, s55, 2048
    buffer_load_dwordx4 v25, s[24:27], s53 offen offset:0 lds
    buffer_load_dwordx4 v26, s[24:27], s53 offen offset:1024 lds
    buffer_load_dwordx4 v27, s[24:27], s53 offen offset:2048 lds
    buffer_load_dwordx4 v28, s[24:27], s53 offen offset:3072 lds
    s_add_u32 s53, s53, 131072
    s_waitcnt vmcnt(16)
    s_barrier
    s_add_u32 m0, s50, 32768
    s_add_u32 s54, s51, 32768
    buffer_load_dwordx4 v19, s[20:23], s52 offen sc1 lds
    buffer_load_dwordx4 v19, s[20:23], s52 offen offset:1024 sc1 lds
    s_add_u32 m0, m0, 2048
    s_add_u32 s52, s52, 2048
    buffer_load_dwordx4 v19, s[20:23], s55 offen sc1 lds
    buffer_load_dwordx4 v19, s[20:23], s55 offen offset:1024 sc1 lds
    s_mov_b32 m0, s54
    s_add_u32 s55, s55, 2048
    buffer_load_dwordx4 v25, s[24:27], s53 offen offset:0 lds
    buffer_load_dwordx4 v26, s[24:27], s53 offen offset:1024 lds
    buffer_load_dwordx4 v27, s[24:27], s53 offen offset:2048 lds
    buffer_load_dwordx4 v28, s[24:27], s53 offen offset:3072 lds
    s_add_u32 s53, s53, 131072
    s_waitcnt vmcnt(16)
    s_barrier
    s_add_u32 m0, s50, 65536
    s_add_u32 s54, s51, 65536
    buffer_load_dwordx4 v19, s[20:23], s52 offen sc1 lds
    buffer_load_dwordx4 v19, s[20:23], s52 offen offset:1024 sc1 lds
    s_add_u32 m0, m0, 2048
    s_add_u32 s52, s52, 2048
    buffer_load_dwordx4 v19, s[20:23], s55 offen sc1 lds
    buffer_load_dwordx4 v19, s[20:23], s55 offen offset:1024 sc1 lds
    s_mov_b32 m0, s54
    s_add_u32 s55, s55, 2048
    buffer_load_dwordx4 v25, s[24:27], s53 offen offset:0 lds
    buffer_load_dwordx4 v26, s[24:27], s53 offen offset:1024 lds
    buffer_load_dwordx4 v27, s[24:27], s53 offen offset:2048 lds
    buffer_load_dwordx4 v28, s[24:27], s53 offen offset:3072 lds
    s_add_u32 s53, s53, 131072
    s_waitcnt vmcnt(16)
    s_barrier
    s_add_u32 m0, s50, 98304
    s_add_u32 s54, s51, 98304
    buffer_load_dwordx4 v19, s[20:23], s52 offen sc1 lds
    buffer_load_dwordx4 v19, s[20:23], s52 offen offset:1024 sc1 lds
    s_add_u32 m0, m0, 2048
    s_add_u32 s52, s52, 2048
    buffer_load_dwordx4 v19, s[20:23], s55 offen sc1 lds
    buffer_load_dwordx4 v19, s[20:23], s55 offen offset:1024 sc1 lds
    s_mov_b32 m0, s54
    s_add_u32 s55, s55, 2048
    buffer_load_dwordx4 v25, s[24:27], s53 offen offset:0 lds
    buffer_load_dwordx4 v26, s[24:27], s53 offen offset:1024 lds
    buffer_load_dwordx4 v27, s[24:27], s53 offen offset:2048 lds
    buffer_load_dwordx4 v28, s[24:27], s53 offen offset:3072 lds
    s_add_u32 s53, s53, 131072
    s_waitcnt vmcnt(16)
    s_barrier
    s_add_u32 m0, s50, 131072
    s_add_u32 s54, s51, 131072
    buffer_load_dwordx4 v19, s[20:23], s52 offen sc1 lds
    buffer_load_dwordx4 v19, s[20:23], s52 offen offset:1024 sc1 lds
    s_add_u32 m0, m0, 2048
    s_add_u32 s52, s52, 2048
    buffer_load_dwordx4 v19, s[20:23], s55 offen sc1 lds
    buffer_load_dwordx4 v19, s[20:23], s55 offen offset:1024 sc1 lds
    s_mov_b32 m0, s54
    s_add_u32 s55, s55, 2048
    buffer_load_dwordx4 v25, s[24:27], s53 offen offset:0 lds
    buffer_load_dwordx4 v26, s[24:27], s53 offen offset:1024 lds
    buffer_load_dwordx4 v27, s[24:27], s53 offen offset:2048 lds
    buffer_load_dwordx4 v28, s[24:27], s53 offen offset:3072 lds
    s_add_u32 s53, s53, 131072
    s_waitcnt vmcnt(16)
    s_barrier
    s_add_u32 m0, s50, 0
    s_add_u32 s54, s51, 0
    buffer_load_dwordx4 v19, s[20:23], s52 offen sc1 lds
    buffer_load_dwordx4 v19, s[20:23], s52 offen offset:1024 sc1 lds
    s_add_u32 m0, m0, 2048
    s_add_u32 s52, s52, 2048
    buffer_load_dwordx4 v19, s[20:23], s55 offen sc1 lds
    buffer_load_dwordx4 v19, s[20:23], s55 offen offset:1024 sc1 lds
    s_mov_b32 m0, s54
    s_add_u32 s55, s55, 2048
    buffer_load_dwordx4 v25, s[24:27], s53 offen offset:0 lds
    buffer_load_dwordx4 v26, s[24:27], s53 offen offset:1024 lds
    buffer_load_dwordx4 v27, s[24:27], s53 offen offset:2048 lds
    buffer_load_dwordx4 v28, s[24:27], s53 offen offset:3072 lds
    s_add_u32 s53, s53, 131072
    s_waitcnt vmcnt(16)
    s_barrier
    s_add_u32 m0, s50, 32768
    s_add_u32 s54, s51, 32768
    buffer_load_dwordx4 v19, s[20:23], s52 offen sc1 lds
    buffer_load_dwordx4 v19, s[20:23], s52 offen offset:1024 sc1 lds
    s_add_u32 m0, m0, 2048
    s_add_u32 s52, s52, 2048
    buffer_load_dwordx4 v19, s[20:23], s55 offen sc1 lds
    buffer_load_dwordx4 v19, s[20:23], s55 offen offset:1024 sc1 lds
    s_mov_b32 m0, s54
    s_add_u32 s55, s55, 2048
    buffer_load_dwordx4 v25, s[24:27], s53 offen offset:0 lds
    buffer_load_dwordx4 v26, s[24:27], s53 offen offset:1024 lds
    buffer_load_dwordx4 v27, s[24:27], s53 offen offset:2048 lds
    buffer_load_dwordx4 v28, s[24:27], s53 offen offset:3072 lds
    s_add_u32 s53, s53, 131072
    s_waitcnt vmcnt(16)
    s_barrier
    s_add_u32 m0, s50, 65536
    s_add_u32 s54, s51, 65536
    buffer_load_dwordx4 v19, s[20:23], s52 offen sc1 lds
    buffer_load_dwordx4 v19, s[20:23], s52 offen offset:1024 sc1 lds
    s_add_u32 m0, m0, 2048
    s_add_u32 s52, s52, 2048
    buffer_load_dwordx4 v19, s[20:23], s55 offen sc1 lds
    buffer_load_dwordx4 v19, s[20:23], s55 offen offset:1024 sc1 lds
    s_mov_b32 m0, s54
    s_add_u32 s55, s55, 2048
    buffer_load_dwordx4 v25, s[24:27], s53 offen offset:0 lds
    buffer_load_dwordx4 v26, s[24:27], s53 offen offset:1024 lds
    buffer_load_dwordx4 v27, s[24:27], s53 offen offset:2048 lds
    buffer_load_dwordx4 v28, s[24:27], s53 offen offset:3072 lds
    s_add_u32 s53, s53, 131072
    buffer_load_dword v243, v242, s[8:11], 0 offen sc1
    s_waitcnt vmcnt(17)
    s_barrier
    s_add_u32 m0, s50, 98304
    s_add_u32 s54, s51, 98304
    buffer_load_dwordx4 v19, s[20:23], s52 offen sc1 lds
    buffer_load_dwordx4 v19, s[20:23], s52 offen offset:1024 sc1 lds
    s_add_u32 m0, m0, 2048
    s_add_u32 s52, s52, 2048
    buffer_load_dwordx4 v19, s[20:23], s55 offen sc1 lds
    buffer_load_dwordx4 v19, s[20:23], s55 offen offset:1024 sc1 lds
    s_mov_b32 m0, s54
    s_add_u32 s55, s55, 2048
    buffer_load_dwordx4 v25, s[24:27], s53 offen offset:0 lds
    buffer_load_dwordx4 v26, s[24:27], s53 offen offset:1024 lds
    buffer_load_dwordx4 v27, s[24:27], s53 offen offset:2048 lds
    buffer_load_dwordx4 v28, s[24:27], s53 offen offset:3072 lds
    s_add_u32 s53, s53, 131072
    s_waitcnt vmcnt(17)
    s_barrier
    s_add_u32 m0, s50, 131072
    s_add_u32 s54, s51, 131072
    buffer_load_dwordx4 v19, s[20:23], s52 offen sc1 lds
    buffer_load_dwordx4 v19, s[20:23], s52 offen offset:1024 sc1 lds
    s_add_u32 m0, m0, 2048
    s_add_u32 s52, s52, 2048
    buffer_load_dwordx4 v19, s[20:23], s55 offen sc1 lds
    buffer_load_dwordx4 v19, s[20:23], s55 offen offset:1024 sc1 lds
    s_mov_b32 m0, s54
    s_add_u32 s55, s55, 2048
    buffer_load_dwordx4 v25, s[24:27], s53 offen offset:0 lds
    buffer_load_dwordx4 v26, s[24:27], s53 offen offset:1024 lds
    buffer_load_dwordx4 v27, s[24:27], s53 offen offset:2048 lds
    buffer_load_dwordx4 v28, s[24:27], s53 offen offset:3072 lds
    s_add_u32 s53, s53, 131072
    buffer_load_dwordx2 v[246:247], v238, s[8:11], 0 offen sc1
    s_waitcnt vmcnt(18)
    s_barrier
    s_add_u32 m0, s50, 0
    s_add_u32 s54, s51, 0
    buffer_load_dwordx4 v19, s[20:23], s52 offen sc1 lds
    buffer_load_dwordx4 v19, s[20:23], s52 offen offset:1024 sc1 lds
    s_add_u32 m0, m0, 2048
    s_add_u32 s52, s52, 2048
    buffer_load_dwordx4 v19, s[20:23], s55 offen sc1 lds
    buffer_load_dwordx4 v19, s[20:23], s55 offen offset:1024 sc1 lds
    s_mov_b32 m0, s54
    s_add_u32 s55, s55, 2048
    buffer_load_dwordx4 v25, s[24:27], s53 offen offset:0 lds
    buffer_load_dwordx4 v26, s[24:27], s53 offen offset:1024 lds
    buffer_load_dwordx4 v27, s[24:27], s53 offen offset:2048 lds
    buffer_load_dwordx4 v28, s[24:27], s53 offen offset:3072 lds
    s_add_u32 s53, s53, 131072
    s_waitcnt vmcnt(25)
    s_mov_b32 s59, 0
L_plp_38:
    v_cmp_ne_u32 vcc, 1, v243
    s_nop 3
    s_cbranch_vccz L_pok_37
    s_sleep 2
    buffer_load_dword v243, v242, s[8:11], 0 offen sc1
    s_waitcnt vmcnt(0)
    s_add_u32 s59, s59, 1
    s_cmp_lt_u32 s59, 0x20000
    s_cbranch_scc1 L_plp_38
L_pok_37:
    s_waitcnt vmcnt(17)
    s_barrier
    s_add_u32 m0, s50, 32768
    s_add_u32 s54, s51, 32768
    buffer_load_dwordx4 v19, s[20:23], s52 offen sc1 lds
    buffer_load_dwordx4 v19, s[20:23], s52 offen offset:1024 sc1 lds
    s_add_u32 m0, m0, 2048
    s_add_u32 s52, s52, 2048
    buffer_load_dwordx4 v19, s[20:23], s55 offen sc1 lds
    buffer_load_dwordx4 v19, s[20:23], s55 offen offset:1024 sc1 lds
    s_mov_b32 m0, s54
    s_add_u32 s55, s55, 2048
    buffer_load_dwordx4 v25, s[24:27], s53 offen offset:0 lds
    buffer_load_dwordx4 v26, s[24:27], s53 offen offset:1024 lds
    buffer_load_dwordx4 v27, s[24:27], s53 offen offset:2048 lds
    buffer_load_dwordx4 v28, s[24:27], s53 offen offset:3072 lds
    s_add_u32 s53, s53, 131072
    s_waitcnt vmcnt(17)
    s_barrier
    s_add_u32 m0, s50, 65536
    s_add_u32 s54, s51, 65536
    buffer_load_dwordx4 v19, s[20:23], s52 offen sc1 lds
    buffer_load_dwordx4 v19, s[20:23], s52 offen offset:1024 sc1 lds
    s_add_u32 m0, m0, 2048
    s_add_u32 s52, s52, 2048
    buffer_load_dwordx4 v19, s[20:23], s55 offen sc1 lds
    buffer_load_dwordx4 v19, s[20:23], s55 offen offset:1024 sc1 lds
    s_mov_b32 m0, s54
    s_add_u32 s55, s55, 2048
    buffer_load_dwordx4 v25, s[24:27], s53 offen offset:0 lds
    buffer_load_dwordx4 v26, s[24:27], s53 offen offset:1024 lds
    buffer_load_dwordx4 v27, s[24:27], s53 offen offset:2048 lds
    buffer_load_dwordx4 v28, s[24:27], s53 offen offset:3072 lds
    s_add_u32 s53, s53, 131072
    s_waitcnt vmcnt(16)
    s_barrier
    s_mov_b32 s59, 0
L_plp_40:
    v_cmp_ne_u32 vcc, 1, v246
    v_cmp_ne_u32 s[56:57], 1, v247
    s_nop 0
    s_or_b64 vcc, vcc, s[56:57]
    s_nop 3
    s_cbranch_vccz L_pok_39
    s_sleep 2
    buffer_load_dwordx2 v[246:247], v238, s[8:11], 0 offen sc1
    s_waitcnt vmcnt(0)
    s_add_u32 s59, s59, 1
    s_cmp_lt_u32 s59, 0x20000
    s_cbranch_scc1 L_plp_40
L_pok_39:
    s_add_u32 m0, s50, 98304
    s_nop 0
    buffer_load_dwordx4 v29, s[28:31], 0 offen offset:0 lds
    buffer_load_dwordx4 v30, s[28:31], 0 offen offset:1024 lds
    buffer_load_dwordx4 v31, s[28:31], 0 offen offset:2048 lds
    buffer_load_dwordx4 v32, s[28:31], 0 offen offset:3072 lds
    s_add_u32 m0, s50, 114688
    s_nop 0
    buffer_load_dwordx4 v33, s[32:35], 0 offen offset:0 sc1 lds
    buffer_load_dwordx4 v34, s[32:35], 0 offen offset:1024 sc1 lds
    buffer_load_dwordx4 v35, s[32:35], 0 offen offset:2048 sc1 lds
    buffer_load_dwordx4 v36, s[32:35], 0 offen offset:3072 sc1 lds
    s_waitcnt vmcnt(16)
    s_barrier
    s_waitcnt vmcnt(8)
    s_barrier
    s_waitcnt vmcnt(0)
    s_barrier
    s_branch L_fin
L_consumer:
    s_waitcnt lgkmcnt(0)
    s_mov_b32 s32, s76
    s_mov_b32 s33, s77
    s_mov_b32 s34, 0x400000
    s_mov_b32 s35, 0x20000
    s_lshl_b32 s42, s14, 7
    s_lshl_b32 s43, s15, 3
    s_add_u32 s42, s42, s43
    s_lshl_b32 s43, s3, 1
    s_add_u32 s12, s42, s43
    s_lshl_b32 s42, s12, 11
    s_add_u32 s43, s42, 2048
    v_lshlrev_b32 v203, 4, v0
    buffer_load_dwordx4 v[204:207], v203, s[32:35], s42 offen
    buffer_load_dwordx4 v[208:211], v203, s[32:35], s42 offen offset:1024
    buffer_load_dwordx4 v[212:215], v203, s[32:35], s43 offen
    buffer_load_dwordx4 v[216:219], v203, s[32:35], s43 offen offset:1024
    s_lshl_b32 s42, s2, 1
    s_lshr_b32 s43, s3, 1
    s_add_u32 s42, s42, s43
    s_lshl_b32 s42, s42, 2
    s_load_dword s53, s[86:87], s42
    s_getpc_b64 s[4:5]
L_pc:
    s_sub_u32 s4, s4, L_pc-parallel_sum__ssm_conv_h3__dense_activation_relu__prompt_kernel
    s_subb_u32 s5, s5, 0
    s_lshr_b32 s6, s2, 3
    s_lshl_b32 s6, s6, 2
    s_add_u32 s6, s6, s3
    s_lshl_b32 s6, s6, 9
    v_lshlrev_b32 v1, 3, v0
    v_add_u32 v1, s6, v1
    v_min_u32 v1, L_codeend-parallel_sum__ssm_conv_h3__dense_activation_relu__prompt_kernel-8, v1
    global_load_dword v55, v1, s[4:5]
    s_and_b32 s40, s3, 1
    s_lshr_b32 s41, s3, 1
    v_and_b32 v2, 15, v0
    v_lshrrev_b32 v3, 4, v0
    v_lshrrev_b32 v4, 1, v2
    v_xor_b32 v4, v4, v3
    v_lshlrev_b32 v5, 7, v2
    s_lshl_b32 s42, s40, 13
    v_add_u32 v5, s42, v5
    v_xor_b32 v6, 0, v4
    v_lshlrev_b32 v6, 4, v6
    v_add_u32 v8, v5, v6
    v_xor_b32 v6, 4, v4
    v_lshlrev_b32 v6, 4, v6
    v_add_u32 v9, v5, v6
    v_lshrrev_b32 v6, 2, v2
    v_and_b32 v7, 3, v2
    v_lshlrev_b32 v1, 3, v3
    v_add_u32 v1, v1, v6
    v_mul_u32_u24 v1, 448, v1
    v_lshlrev_b32 v7, 3, v7
    v_add_u32 v1, v1, v7
    s_mul_i32 s42, s41, 224
    s_add_u32 s42, s42, 16384
    v_add_u32 v1, s42, v1
    v_and_b32 v6, 1, v3
    v_lshlrev_b32 v6, 5, v6
    v_add_u32 v7, v1, v6
    v_sub_u32 v1, v1, v6
    s_cmp_eq_u32 s41, 0
    s_cselect_b64 vcc, -1, 0
    v_cndmask_b32 v10, v1, v7, vcc
    v_cndmask_b32 v11, v7, v1, vcc
    v_add_u32 v12, 45056, v8
    v_add_u32 v13, 45056, v9
    v_add_u32 v14, 45056, v10
    v_add_u32 v15, 45056, v11
    v_add_u32 v16, 90112, v8
    v_add_u32 v17, 90112, v9
    v_add_u32 v18, 90112, v10
    v_add_u32 v19, 90112, v11
    v_mov_b32 v48, 0x3f803f80
    v_mov_b32 v49, 0x3f803f80
    v_mov_b32 v50, 0x3f803f80
    v_mov_b32 v51, 0x3f803f80
    s_mul_i32 s42, s41, 448
    s_add_u32 s42, s42, 137344
    v_lshlrev_b32 v4, 4, v3
    v_add_u32 v52, s42, v4
    v_and_b32 v5, 3, v2
    v_lshlrev_b32 v6, 2, v5
    v_add_u32 v53, v52, v6
    v_and_b32 v6, 1, v5
    v_cmp_eq_u32 s[46:47], 1, v6
    v_cmp_le_u32 s[48:49], 2, v5
    s_add_u32 s20, s98, 0x2510000
    s_addc_u32 s21, s99, 0
    s_mov_b32 s22, 0x38000
    s_mov_b32 s23, 0x20000
    s_add_u32 s24, s98, 0x2400000
    s_addc_u32 s25, s99, 0
    s_mov_b32 s26, 0x6000
    s_mov_b32 s27, 0x20000
    s_add_u32 s28, s98, 0xc00000
    s_addc_u32 s29, s99, 0
    s_mov_b32 s30, 0xe00000
    s_mov_b32 s31, 0x20000
    s_add_u32 s36, s98, 0x2500000
    s_addc_u32 s37, s99, 0
    s_mov_b32 s38, 0x4000
    s_mov_b32 s39, 0x20000
    s_waitcnt vmcnt(1)
    v_lshlrev_b32 v120, 16, v204
    v_and_b32 v121, 0xffff0000, v204
    v_lshlrev_b32 v122, 16, v205
    v_and_b32 v123, 0xffff0000, v205
    v_lshlrev_b32 v124, 16, v206
    v_and_b32 v125, 0xffff0000, v206
    v_lshlrev_b32 v126, 16, v207
    v_and_b32 v127, 0xffff0000, v207
    v_lshlrev_b32 v128, 16, v208
    v_and_b32 v129, 0xffff0000, v208
    v_lshlrev_b32 v130, 16, v209
    v_and_b32 v131, 0xffff0000, v209
    v_lshlrev_b32 v132, 16, v210
    v_and_b32 v133, 0xffff0000, v210
    v_lshlrev_b32 v134, 16, v211
    v_and_b32 v135, 0xffff0000, v211
    v_pk_add_f32 v[160:161], v[120:121], v[122:123]
    v_pk_add_f32 v[160:161], v[160:161], v[124:125]
    v_pk_add_f32 v[160:161], v[160:161], v[126:127]
    v_pk_add_f32 v[160:161], v[160:161], v[128:129]
    v_pk_add_f32 v[160:161], v[160:161], v[130:131]
    v_pk_add_f32 v[160:161], v[160:161], v[132:133]
    v_pk_add_f32 v[160:161], v[160:161], v[134:135]
    v_add_f32 v152, v160, v161
    v_lshlrev_b32 v136, 16, v212
    v_and_b32 v137, 0xffff0000, v212
    v_lshlrev_b32 v138, 16, v213
    v_and_b32 v139, 0xffff0000, v213
    v_lshlrev_b32 v140, 16, v214
    v_and_b32 v141, 0xffff0000, v214
    v_lshlrev_b32 v142, 16, v215
    v_and_b32 v143, 0xffff0000, v215
    v_lshlrev_b32 v144, 16, v216
    v_and_b32 v145, 0xffff0000, v216
    v_lshlrev_b32 v146, 16, v217
    v_and_b32 v147, 0xffff0000, v217
    v_lshlrev_b32 v148, 16, v218
    v_and_b32 v149, 0xffff0000, v218
    v_lshlrev_b32 v150, 16, v219
    v_and_b32 v151, 0xffff0000, v219
    v_pk_add_f32 v[160:161], v[136:137], v[138:139]
    v_pk_add_f32 v[160:161], v[160:161], v[140:141]
    v_pk_add_f32 v[160:161], v[160:161], v[142:143]
    v_pk_add_f32 v[160:161], v[160:161], v[144:145]
    v_pk_add_f32 v[160:161], v[160:161], v[146:147]
    v_pk_add_f32 v[160:161], v[160:161], v[148:149]
    v_pk_add_f32 v[160:161], v[160:161], v[150:151]
    v_add_f32 v153, v160, v161
    s_nop 1
    v_add_f32_dpp v152, v152, v152 quad_perm:[1,0,3,2] row_mask:0xf bank_mask:0xf
    v_add_f32_dpp v153, v153, v153 quad_perm:[1,0,3,2] row_mask:0xf bank_mask:0xf
    s_nop 1
    v_add_f32_dpp v152, v152, v152 quad_perm:[2,3,0,1] row_mask:0xf bank_mask:0xf
    v_add_f32_dpp v153, v153, v153 quad_perm:[2,3,0,1] row_mask:0xf bank_mask:0xf
    s_nop 1
    v_add_f32_dpp v152, v152, v152 row_half_mirror row_mask:0xf bank_mask:0xf
    v_add_f32_dpp v153, v153, v153 row_half_mirror row_mask:0xf bank_mask:0xf
    s_nop 1
    v_add_f32_dpp v152, v152, v152 row_mirror row_mask:0xf bank_mask:0xf
    v_add_f32_dpp v153, v153, v153 row_mirror row_mask:0xf bank_mask:0xf
    v_mov_b32 v158, v152
    v_mov_b32 v159, v153
    s_nop 1
    v_permlane16_swap_b32 v152, v158
    v_permlane16_swap_b32 v153, v159
    s_nop 1
    v_add_f32 v152, v152, v158
    v_add_f32 v153, v153, v159
    v_mov_b32 v158, v152
    v_mov_b32 v159, v153
    s_nop 1
    v_permlane32_swap_b32 v152, v158
    v_permlane32_swap_b32 v153, v159
    s_nop 1
    v_add_f32 v152, v152, v158
    v_add_f32 v153, v153, v159
    v_mul_f32 v152, 0x3a800000, v152
    v_sub_f32 v162, 0, v152
    v_mov_b32 v160, 0
    v_mov_b32 v161, 0
    v_pk_add_f32 v[164:165], v[120:121], v[162:163] op_sel_hi:[1,0]
    v_pk_fma_f32 v[160:161], v[164:165], v[164:165], v[160:161]
    v_pk_add_f32 v[164:165], v[122:123], v[162:163] op_sel_hi:[1,0]
    v_pk_fma_f32 v[160:161], v[164:165], v[164:165], v[160:161]
    v_pk_add_f32 v[164:165], v[124:125], v[162:163] op_sel_hi:[1,0]
    v_pk_fma_f32 v[160:161], v[164:165], v[164:165], v[160:161]
    v_pk_add_f32 v[164:165], v[126:127], v[162:163] op_sel_hi:[1,0]
    v_pk_fma_f32 v[160:161], v[164:165], v[164:165], v[160:161]
    v_pk_add_f32 v[164:165], v[128:129], v[162:163] op_sel_hi:[1,0]
    v_pk_fma_f32 v[160:161], v[164:165], v[164:165], v[160:161]
    v_pk_add_f32 v[164:165], v[130:131], v[162:163] op_sel_hi:[1,0]
    v_pk_fma_f32 v[160:161], v[164:165], v[164:165], v[160:161]
    v_pk_add_f32 v[164:165], v[132:133], v[162:163] op_sel_hi:[1,0]
    v_pk_fma_f32 v[160:161], v[164:165], v[164:165], v[160:161]
    v_pk_add_f32 v[164:165], v[134:135], v[162:163] op_sel_hi:[1,0]
    v_pk_fma_f32 v[160:161], v[164:165], v[164:165], v[160:161]
    v_add_f32 v154, v160, v161
    v_mul_f32 v153, 0x3a800000, v153
    v_sub_f32 v162, 0, v153
    v_mov_b32 v160, 0
    v_mov_b32 v161, 0
    v_pk_add_f32 v[164:165], v[136:137], v[162:163] op_sel_hi:[1,0]
    v_pk_fma_f32 v[160:161], v[164:165], v[164:165], v[160:161]
    v_pk_add_f32 v[164:165], v[138:139], v[162:163] op_sel_hi:[1,0]
    v_pk_fma_f32 v[160:161], v[164:165], v[164:165], v[160:161]
    v_pk_add_f32 v[164:165], v[140:141], v[162:163] op_sel_hi:[1,0]
    v_pk_fma_f32 v[160:161], v[164:165], v[164:165], v[160:161]
    v_pk_add_f32 v[164:165], v[142:143], v[162:163] op_sel_hi:[1,0]
    v_pk_fma_f32 v[160:161], v[164:165], v[164:165], v[160:161]
    v_pk_add_f32 v[164:165], v[144:145], v[162:163] op_sel_hi:[1,0]
    v_pk_fma_f32 v[160:161], v[164:165], v[164:165], v[160:161]
    v_pk_add_f32 v[164:165], v[146:147], v[162:163] op_sel_hi:[1,0]
    v_pk_fma_f32 v[160:161], v[164:165], v[164:165], v[160:161]
    v_pk_add_f32 v[164:165], v[148:149], v[162:163] op_sel_hi:[1,0]
    v_pk_fma_f32 v[160:161], v[164:165], v[164:165], v[160:161]
    v_pk_add_f32 v[164:165], v[150:151], v[162:163] op_sel_hi:[1,0]
    v_pk_fma_f32 v[160:161], v[164:165], v[164:165], v[160:161]
    v_add_f32 v155, v160, v161
    s_nop 1
    v_add_f32_dpp v154, v154, v154 quad_perm:[1,0,3,2] row_mask:0xf bank_mask:0xf
    v_add_f32_dpp v155, v155, v155 quad_perm:[1,0,3,2] row_mask:0xf bank_mask:0xf
    s_nop 1
    v_add_f32_dpp v154, v154, v154 quad_perm:[2,3,0,1] row_mask:0xf bank_mask:0xf
    v_add_f32_dpp v155, v155, v155 quad_perm:[2,3,0,1] row_mask:0xf bank_mask:0xf
    s_nop 1
    v_add_f32_dpp v154, v154, v154 row_half_mirror row_mask:0xf bank_mask:0xf
    v_add_f32_dpp v155, v155, v155 row_half_mirror row_mask:0xf bank_mask:0xf
    s_nop 1
    v_add_f32_dpp v154, v154, v154 row_mirror row_mask:0xf bank_mask:0xf
    v_add_f32_dpp v155, v155, v155 row_mirror row_mask:0xf bank_mask:0xf
    v_mov_b32 v158, v154
    v_mov_b32 v159, v155
    s_nop 1
    v_permlane16_swap_b32 v154, v158
    v_permlane16_swap_b32 v155, v159
    s_nop 1
    v_add_f32 v154, v154, v158
    v_add_f32 v155, v155, v159
    v_mov_b32 v158, v154
    v_mov_b32 v159, v155
    s_nop 1
    v_permlane32_swap_b32 v154, v158
    v_permlane32_swap_b32 v155, v159
    s_nop 1
    v_add_f32 v154, v154, v158
    v_add_f32 v155, v155, v159
    v_mul_f32 v154, 0x3a800000, v154
    v_cvt_pk_bf16_f32 v154, v154, v154
    v_lshlrev_b32 v154, 16, v154
    v_add_f32 v154, 0x3727c5ac, v154
    v_cvt_pk_bf16_f32 v154, v154, v154
    v_lshlrev_b32 v154, 16, v154
    v_sqrt_f32 v154, v154
    s_nop 0
    v_cvt_pk_bf16_f32 v154, v154, v154
    v_lshlrev_b32 v154, 16, v154
    v_cvt_pk_bf16_f32 v152, v152, v152
    v_lshlrev_b32 v152, 16, v152
    v_rcp_f32 v156, v154
    s_nop 0
    v_mul_f32 v155, 0x3a800000, v155
    v_cvt_pk_bf16_f32 v155, v155, v155
    v_lshlrev_b32 v155, 16, v155
    v_add_f32 v155, 0x3727c5ac, v155
    v_cvt_pk_bf16_f32 v155, v155, v155
    v_lshlrev_b32 v155, 16, v155
    v_sqrt_f32 v155, v155
    s_nop 0
    v_cvt_pk_bf16_f32 v155, v155, v155
    v_lshlrev_b32 v155, 16, v155
    v_cvt_pk_bf16_f32 v153, v153, v153
    v_lshlrev_b32 v153, 16, v153
    v_rcp_f32 v157, v155
    s_nop 0
    v_cmp_eq_u32 vcc, 1, v0
    s_nop 1
    v_cndmask_b32 v160, v152, v153, vcc
    v_cndmask_b32 v161, v156, v157, vcc
    v_add_u32 v162, s12, v0
    v_lshlrev_b32 v162, 2, v162
    v_cmp_gt_u32 vcc, 2, v0
    v_mov_b32 v163, 0x7fffffff
    s_nop 0
    v_cndmask_b32 v162, v163, v162, vcc
    buffer_store_dword v160, v162, s[36:39], 0 offen sc1
    v_add_u32 v163, 8192, v162
    buffer_store_dword v161, v163, s[36:39], 0 offen sc1
    s_waitcnt lgkmcnt(0)
    s_barrier
    ds_read_b64_tr_b16 v[56:57], v10 offset:0
    ds_read_b64_tr_b16 v[58:59], v10 offset:1792
    ds_read_b128 v[84:87], v8 offset:0
    ds_read_b128 v[88:91], v8 offset:2048
    ds_read_b128 v[92:95], v8 offset:4096
    ds_read_b128 v[96:99], v8 offset:6144
    ds_read_b64_tr_b16 v[60:61], v11 offset:32
    ds_read_b64_tr_b16 v[62:63], v11 offset:1824
    ds_read_b64_tr_b16 v[64:65], v10 offset:64
    ds_read_b64_tr_b16 v[66:67], v10 offset:1856
    ds_read_b64_tr_b16 v[68:69], v11 offset:96
    ds_read_b64_tr_b16 v[70:71], v11 offset:1888
    ds_read_b64_tr_b16 v[72:73], v10 offset:128
    ds_read_b64_tr_b16 v[74:75], v10 offset:1920
    ds_read_b64_tr_b16 v[76:77], v11 offset:160
    ds_read_b64_tr_b16 v[78:79], v11 offset:1952
    ds_read_b64_tr_b16 v[80:81], v10 offset:192
    ds_read_b64_tr_b16 v[82:83], v10 offset:1984
    s_waitcnt lgkmcnt(0)
    v_mfma_f32_16x16x32_bf16 v[144:147], v[56:59], v[84:87], 0
    ds_read_b64_tr_b16 v[100:101], v10 offset:14336
    v_mfma_f32_16x16x32_bf16 v[148:151], v[56:59], v[88:91], 0
    ds_read_b64_tr_b16 v[102:103], v10 offset:16128
    v_mfma_f32_16x16x32_bf16 v[152:155], v[56:59], v[92:95], 0
    ds_read_b128 v[128:131], v9 offset:0
    v_mfma_f32_16x16x32_bf16 v[156:159], v[56:59], v[96:99], 0
    ds_read_b128 v[132:135], v9 offset:2048
    v_mfma_f32_16x16x32_bf16 v[20:23], v[56:59], v[48:51], 0
    ds_read_b128 v[136:139], v9 offset:4096
    v_mfma_f32_16x16x32_bf16 v[160:163], v[60:63], v[84:87], 0
    ds_read_b128 v[140:143], v9 offset:6144
    v_mfma_f32_16x16x32_bf16 v[164:167], v[60:63], v[88:91], 0
    ds_read_b64_tr_b16 v[104:105], v11 offset:14368
    v_mfma_f32_16x16x32_bf16 v[168:171], v[60:63], v[92:95], 0
    ds_read_b64_tr_b16 v[106:107], v11 offset:16160
    v_mfma_f32_16x16x32_bf16 v[172:175], v[60:63], v[96:99], 0
    ds_read_b64_tr_b16 v[108:109], v10 offset:14400
    v_mfma_f32_16x16x32_bf16 v[24:27], v[60:63], v[48:51], 0
    ds_read_b64_tr_b16 v[110:111], v10 offset:16192
    v_mfma_f32_16x16x32_bf16 v[176:179], v[64:67], v[84:87], 0
    ds_read_b64_tr_b16 v[112:113], v11 offset:14432
    v_mfma_f32_16x16x32_bf16 v[180:183], v[64:67], v[88:91], 0
    ds_read_b64_tr_b16 v[114:115], v11 offset:16224
    v_mfma_f32_16x16x32_bf16 v[184:187], v[64:67], v[92:95], 0
    ds_read_b64_tr_b16 v[116:117], v10 offset:14464
    v_mfma_f32_16x16x32_bf16 v[188:191], v[64:67], v[96:99], 0
    ds_read_b64_tr_b16 v[118:119], v10 offset:16256
    v_mfma_f32_16x16x32_bf16 v[28:31], v[64:67], v[48:51], 0
    ds_read_b64_tr_b16 v[120:121], v11 offset:14496
    v_mfma_f32_16x16x32_bf16 v[192:195], v[68:71], v[84:87], 0
    ds_read_b64_tr_b16 v[122:123], v11 offset:16288
    v_mfma_f32_16x16x32_bf16 v[196:199], v[68:71], v[88:91], 0
    ds_read_b64_tr_b16 v[124:125], v10 offset:14528
    v_mfma_f32_16x16x32_bf16 v[200:203], v[68:71], v[92:95], 0
    ds_read_b64_tr_b16 v[126:127], v10 offset:16320
    v_mfma_f32_16x16x32_bf16 v[204:207], v[68:71], v[96:99], 0
    v_mfma_f32_16x16x32_bf16 v[32:35], v[68:71], v[48:51], 0
    v_mfma_f32_16x16x32_bf16 v[208:211], v[72:75], v[84:87], 0
    v_mfma_f32_16x16x32_bf16 v[212:215], v[72:75], v[88:91], 0
    v_mfma_f32_16x16x32_bf16 v[216:219], v[72:75], v[92:95], 0
    v_mfma_f32_16x16x32_bf16 v[220:223], v[72:75], v[96:99], 0
    v_mfma_f32_16x16x32_bf16 v[36:39], v[72:75], v[48:51], 0
    v_mfma_f32_16x16x32_bf16 v[224:227], v[76:79], v[84:87], 0
    v_mfma_f32_16x16x32_bf16 v[228:231], v[76:79], v[88:91], 0
    v_mfma_f32_16x16x32_bf16 v[232:235], v[76:79], v[92:95], 0
    v_mfma_f32_16x16x32_bf16 v[236:239], v[76:79], v[96:99], 0
    v_mfma_f32_16x16x32_bf16 v[40:43], v[76:79], v[48:51], 0
    v_mfma_f32_16x16x32_bf16 v[240:243], v[80:83], v[84:87], 0
    v_mfma_f32_16x16x32_bf16 v[244:247], v[80:83], v[88:91], 0
    v_mfma_f32_16x16x32_bf16 v[248:251], v[80:83], v[92:95], 0
    v_mfma_f32_16x16x32_bf16 v[252:255], v[80:83], v[96:99], 0
    v_mfma_f32_16x16x32_bf16 v[44:47], v[80:83], v[48:51], 0
    s_waitcnt lgkmcnt(0)
    s_barrier
    v_mfma_f32_16x16x32_bf16 v[144:147], v[100:103], v[128:131], v[144:147]
    ds_read_b64_tr_b16 v[56:57], v14 offset:0
    v_mfma_f32_16x16x32_bf16 v[148:151], v[100:103], v[132:135], v[148:151]
    ds_read_b64_tr_b16 v[58:59], v14 offset:1792
    v_mfma_f32_16x16x32_bf16 v[152:155], v[100:103], v[136:139], v[152:155]
    ds_read_b128 v[84:87], v12 offset:0
    v_mfma_f32_16x16x32_bf16 v[156:159], v[100:103], v[140:143], v[156:159]
    ds_read_b128 v[88:91], v12 offset:2048
    v_mfma_f32_16x16x32_bf16 v[20:23], v[100:103], v[48:51], v[20:23]
    ds_read_b128 v[92:95], v12 offset:4096
    v_mfma_f32_16x16x32_bf16 v[160:163], v[104:107], v[128:131], v[160:163]
    ds_read_b128 v[96:99], v12 offset:6144
    v_mfma_f32_16x16x32_bf16 v[164:167], v[104:107], v[132:135], v[164:167]
    ds_read_b64_tr_b16 v[60:61], v15 offset:32
    v_mfma_f32_16x16x32_bf16 v[168:171], v[104:107], v[136:139], v[168:171]
    ds_read_b64_tr_b16 v[62:63], v15 offset:1824
    v_mfma_f32_16x16x32_bf16 v[172:175], v[104:107], v[140:143], v[172:175]
    ds_read_b64_tr_b16 v[64:65], v14 offset:64
    v_mfma_f32_16x16x32_bf16 v[24:27], v[104:107], v[48:51], v[24:27]
    ds_read_b64_tr_b16 v[66:67], v14 offset:1856
    v_mfma_f32_16x16x32_bf16 v[176:179], v[108:111], v[128:131], v[176:179]
    ds_read_b64_tr_b16 v[68:69], v15 offset:96
    v_mfma_f32_16x16x32_bf16 v[180:183], v[108:111], v[132:135], v[180:183]
    ds_read_b64_tr_b16 v[70:71], v15 offset:1888
    v_mfma_f32_16x16x32_bf16 v[184:187], v[108:111], v[136:139], v[184:187]
    ds_read_b64_tr_b16 v[72:73], v14 offset:128
    v_mfma_f32_16x16x32_bf16 v[188:191], v[108:111], v[140:143], v[188:191]
    ds_read_b64_tr_b16 v[74:75], v14 offset:1920
    v_mfma_f32_16x16x32_bf16 v[28:31], v[108:111], v[48:51], v[28:31]
    ds_read_b64_tr_b16 v[76:77], v15 offset:160
    v_mfma_f32_16x16x32_bf16 v[192:195], v[112:115], v[128:131], v[192:195]
    ds_read_b64_tr_b16 v[78:79], v15 offset:1952
    v_mfma_f32_16x16x32_bf16 v[196:199], v[112:115], v[132:135], v[196:199]
    ds_read_b64_tr_b16 v[80:81], v14 offset:192
    v_mfma_f32_16x16x32_bf16 v[200:203], v[112:115], v[136:139], v[200:203]
    ds_read_b64_tr_b16 v[82:83], v14 offset:1984
    v_mfma_f32_16x16x32_bf16 v[204:207], v[112:115], v[140:143], v[204:207]
    v_mfma_f32_16x16x32_bf16 v[32:35], v[112:115], v[48:51], v[32:35]
    v_mfma_f32_16x16x32_bf16 v[208:211], v[116:119], v[128:131], v[208:211]
    v_mfma_f32_16x16x32_bf16 v[212:215], v[116:119], v[132:135], v[212:215]
    v_mfma_f32_16x16x32_bf16 v[216:219], v[116:119], v[136:139], v[216:219]
    v_mfma_f32_16x16x32_bf16 v[220:223], v[116:119], v[140:143], v[220:223]
    v_mfma_f32_16x16x32_bf16 v[36:39], v[116:119], v[48:51], v[36:39]
    v_mfma_f32_16x16x32_bf16 v[224:227], v[120:123], v[128:131], v[224:227]
    v_mfma_f32_16x16x32_bf16 v[228:231], v[120:123], v[132:135], v[228:231]
    v_mfma_f32_16x16x32_bf16 v[232:235], v[120:123], v[136:139], v[232:235]
    v_mfma_f32_16x16x32_bf16 v[236:239], v[120:123], v[140:143], v[236:239]
    v_mfma_f32_16x16x32_bf16 v[40:43], v[120:123], v[48:51], v[40:43]
    v_mfma_f32_16x16x32_bf16 v[240:243], v[124:127], v[128:131], v[240:243]
    v_mfma_f32_16x16x32_bf16 v[244:247], v[124:127], v[132:135], v[244:247]
    v_mfma_f32_16x16x32_bf16 v[248:251], v[124:127], v[136:139], v[248:251]
    v_mfma_f32_16x16x32_bf16 v[252:255], v[124:127], v[140:143], v[252:255]
    v_mfma_f32_16x16x32_bf16 v[44:47], v[124:127], v[48:51], v[44:47]
    s_waitcnt lgkmcnt(0)
    v_mfma_f32_16x16x32_bf16 v[144:147], v[56:59], v[84:87], v[144:147]
    ds_read_b64_tr_b16 v[100:101], v14 offset:14336
    v_mfma_f32_16x16x32_bf16 v[148:151], v[56:59], v[88:91], v[148:151]
    ds_read_b64_tr_b16 v[102:103], v14 offset:16128
    v_mfma_f32_16x16x32_bf16 v[152:155], v[56:59], v[92:95], v[152:155]
    ds_read_b128 v[128:131], v13 offset:0
    v_mfma_f32_16x16x32_bf16 v[156:159], v[56:59], v[96:99], v[156:159]
    ds_read_b128 v[132:135], v13 offset:2048
    v_mfma_f32_16x16x32_bf16 v[160:163], v[60:63], v[84:87], v[160:163]
    ds_read_b128 v[136:139], v13 offset:4096
    v_mfma_f32_16x16x32_bf16 v[164:167], v[60:63], v[88:91], v[164:167]
    ds_read_b128 v[140:143], v13 offset:6144
    v_mfma_f32_16x16x32_bf16 v[168:171], v[60:63], v[92:95], v[168:171]
    ds_read_b64_tr_b16 v[104:105], v15 offset:14368
    v_mfma_f32_16x16x32_bf16 v[172:175], v[60:63], v[96:99], v[172:175]
    ds_read_b64_tr_b16 v[106:107], v15 offset:16160
    v_mfma_f32_16x16x32_bf16 v[176:179], v[64:67], v[84:87], v[176:179]
    ds_read_b64_tr_b16 v[108:109], v14 offset:14400
    v_mfma_f32_16x16x32_bf16 v[180:183], v[64:67], v[88:91], v[180:183]
    ds_read_b64_tr_b16 v[110:111], v14 offset:16192
    v_mfma_f32_16x16x32_bf16 v[184:187], v[64:67], v[92:95], v[184:187]
    ds_read_b64_tr_b16 v[112:113], v15 offset:14432
    v_mfma_f32_16x16x32_bf16 v[188:191], v[64:67], v[96:99], v[188:191]
    ds_read_b64_tr_b16 v[114:115], v15 offset:16224
    v_mfma_f32_16x16x32_bf16 v[192:195], v[68:71], v[84:87], v[192:195]
    ds_read_b64_tr_b16 v[116:117], v14 offset:14464
    v_mfma_f32_16x16x32_bf16 v[196:199], v[68:71], v[88:91], v[196:199]
    ds_read_b64_tr_b16 v[118:119], v14 offset:16256
    v_mfma_f32_16x16x32_bf16 v[200:203], v[68:71], v[92:95], v[200:203]
    ds_read_b64_tr_b16 v[120:121], v15 offset:14496
    v_mfma_f32_16x16x32_bf16 v[204:207], v[68:71], v[96:99], v[204:207]
    ds_read_b64_tr_b16 v[122:123], v15 offset:16288
    v_mfma_f32_16x16x32_bf16 v[208:211], v[72:75], v[84:87], v[208:211]
    ds_read_b64_tr_b16 v[124:125], v14 offset:14528
    v_mfma_f32_16x16x32_bf16 v[212:215], v[72:75], v[88:91], v[212:215]
    ds_read_b64_tr_b16 v[126:127], v14 offset:16320
    v_mfma_f32_16x16x32_bf16 v[216:219], v[72:75], v[92:95], v[216:219]
    v_cndmask_b32 v20, v20, v21, s[46:47]
    v_cndmask_b32 v22, v22, v23, s[46:47]
    v_cndmask_b32 v20, v20, v22, s[48:49]
    ds_write_b32 v53, v20 offset:0
    v_mfma_f32_16x16x32_bf16 v[220:223], v[72:75], v[96:99], v[220:223]
    v_cndmask_b32 v24, v24, v25, s[46:47]
    v_cndmask_b32 v26, v26, v27, s[46:47]
    v_cndmask_b32 v24, v24, v26, s[48:49]
    ds_write_b32 v53, v24 offset:64
    v_mfma_f32_16x16x32_bf16 v[224:227], v[76:79], v[84:87], v[224:227]
    v_cndmask_b32 v28, v28, v29, s[46:47]
    v_cndmask_b32 v30, v30, v31, s[46:47]
    v_cndmask_b32 v28, v28, v30, s[48:49]
    ds_write_b32 v53, v28 offset:128
    v_mfma_f32_16x16x32_bf16 v[228:231], v[76:79], v[88:91], v[228:231]
    v_cndmask_b32 v32, v32, v33, s[46:47]
    v_cndmask_b32 v34, v34, v35, s[46:47]
    v_cndmask_b32 v32, v32, v34, s[48:49]
    ds_write_b32 v53, v32 offset:192
    v_mfma_f32_16x16x32_bf16 v[232:235], v[76:79], v[92:95], v[232:235]
    v_cndmask_b32 v36, v36, v37, s[46:47]
    v_cndmask_b32 v38, v38, v39, s[46:47]
    v_cndmask_b32 v36, v36, v38, s[48:49]
    ds_write_b32 v53, v36 offset:256
    v_mfma_f32_16x16x32_bf16 v[236:239], v[76:79], v[96:99], v[236:239]
    v_cndmask_b32 v40, v40, v41, s[46:47]
    v_cndmask_b32 v42, v42, v43, s[46:47]
    v_cndmask_b32 v40, v40, v42, s[48:49]
    ds_write_b32 v53, v40 offset:320
    v_mfma_f32_16x16x32_bf16 v[240:243], v[80:83], v[84:87], v[240:243]
    v_cndmask_b32 v44, v44, v45, s[46:47]
    v_cndmask_b32 v46, v46, v47, s[46:47]
    v_cndmask_b32 v44, v44, v46, s[48:49]
    ds_write_b32 v53, v44 offset:384
    v_mfma_f32_16x16x32_bf16 v[244:247], v[80:83], v[88:91], v[244:247]
    v_mfma_f32_16x16x32_bf16 v[248:251], v[80:83], v[92:95], v[248:251]
    v_mfma_f32_16x16x32_bf16 v[252:255], v[80:83], v[96:99], v[252:255]
    s_waitcnt lgkmcnt(0)
    s_barrier
    v_mfma_f32_16x16x32_bf16 v[144:147], v[100:103], v[128:131], v[144:147]
    ds_read_b64_tr_b16 v[56:57], v18 offset:0
    v_mfma_f32_16x16x32_bf16 v[148:151], v[100:103], v[132:135], v[148:151]
    ds_read_b64_tr_b16 v[58:59], v18 offset:1792
    v_mfma_f32_16x16x32_bf16 v[152:155], v[100:103], v[136:139], v[152:155]
    ds_read_b128 v[84:87], v16 offset:0
    v_mfma_f32_16x16x32_bf16 v[156:159], v[100:103], v[140:143], v[156:159]
    ds_read_b128 v[88:91], v16 offset:2048
    v_mfma_f32_16x16x32_bf16 v[160:163], v[104:107], v[128:131], v[160:163]
    ds_read_b128 v[92:95], v16 offset:4096
    v_mfma_f32_16x16x32_bf16 v[164:167], v[104:107], v[132:135], v[164:167]
    ds_read_b128 v[96:99], v16 offset:6144
    v_mfma_f32_16x16x32_bf16 v[168:171], v[104:107], v[136:139], v[168:171]
    ds_read_b64_tr_b16 v[60:61], v19 offset:32
    v_mfma_f32_16x16x32_bf16 v[172:175], v[104:107], v[140:143], v[172:175]
    ds_read_b64_tr_b16 v[62:63], v19 offset:1824
    v_mfma_f32_16x16x32_bf16 v[176:179], v[108:111], v[128:131], v[176:179]
    ds_read_b64_tr_b16 v[64:65], v18 offset:64
    v_mfma_f32_16x16x32_bf16 v[180:183], v[108:111], v[132:135], v[180:183]
    ds_read_b64_tr_b16 v[66:67], v18 offset:1856
    v_mfma_f32_16x16x32_bf16 v[184:187], v[108:111], v[136:139], v[184:187]
    ds_read_b64_tr_b16 v[68:69], v19 offset:96
    v_mfma_f32_16x16x32_bf16 v[188:191], v[108:111], v[140:143], v[188:191]
    ds_read_b64_tr_b16 v[70:71], v19 offset:1888
    v_mfma_f32_16x16x32_bf16 v[192:195], v[112:115], v[128:131], v[192:195]
    ds_read_b64_tr_b16 v[72:73], v18 offset:128
    v_mfma_f32_16x16x32_bf16 v[196:199], v[112:115], v[132:135], v[196:199]
    ds_read_b64_tr_b16 v[74:75], v18 offset:1920
    v_mfma_f32_16x16x32_bf16 v[200:203], v[112:115], v[136:139], v[200:203]
    ds_read_b64_tr_b16 v[76:77], v19 offset:160
    v_mfma_f32_16x16x32_bf16 v[204:207], v[112:115], v[140:143], v[204:207]
    ds_read_b64_tr_b16 v[78:79], v19 offset:1952
    v_mfma_f32_16x16x32_bf16 v[208:211], v[116:119], v[128:131], v[208:211]
    ds_read_b64_tr_b16 v[80:81], v18 offset:192
    v_mfma_f32_16x16x32_bf16 v[212:215], v[116:119], v[132:135], v[212:215]
    ds_read_b64_tr_b16 v[82:83], v18 offset:1984
    v_mfma_f32_16x16x32_bf16 v[216:219], v[116:119], v[136:139], v[216:219]
    v_mfma_f32_16x16x32_bf16 v[220:223], v[116:119], v[140:143], v[220:223]
    v_mfma_f32_16x16x32_bf16 v[224:227], v[120:123], v[128:131], v[224:227]
    v_mfma_f32_16x16x32_bf16 v[228:231], v[120:123], v[132:135], v[228:231]
    v_mfma_f32_16x16x32_bf16 v[232:235], v[120:123], v[136:139], v[232:235]
    v_mfma_f32_16x16x32_bf16 v[236:239], v[120:123], v[140:143], v[236:239]
    v_mfma_f32_16x16x32_bf16 v[240:243], v[124:127], v[128:131], v[240:243]
    v_mfma_f32_16x16x32_bf16 v[244:247], v[124:127], v[132:135], v[244:247]
    v_mfma_f32_16x16x32_bf16 v[248:251], v[124:127], v[136:139], v[248:251]
    v_mfma_f32_16x16x32_bf16 v[252:255], v[124:127], v[140:143], v[252:255]
    s_and_b32 s42, s2, 3
    s_lshl_b32 s42, s42, 6
    v_mov_b32 v6, s42
    v_mov_b32 v7, 1
    s_waitcnt lgkmcnt(0)
    v_mfma_f32_16x16x32_bf16 v[144:147], v[56:59], v[84:87], v[144:147]
    ds_read_b64_tr_b16 v[100:101], v18 offset:14336
    v_mfma_f32_16x16x32_bf16 v[148:151], v[56:59], v[88:91], v[148:151]
    ds_read_b64_tr_b16 v[102:103], v18 offset:16128
    v_mfma_f32_16x16x32_bf16 v[152:155], v[56:59], v[92:95], v[152:155]
    ds_read_b128 v[128:131], v17 offset:0
    v_mfma_f32_16x16x32_bf16 v[156:159], v[56:59], v[96:99], v[156:159]
    ds_read_b128 v[132:135], v17 offset:2048
    v_mfma_f32_16x16x32_bf16 v[160:163], v[60:63], v[84:87], v[160:163]
    ds_read_b128 v[136:139], v17 offset:4096
    v_mfma_f32_16x16x32_bf16 v[164:167], v[60:63], v[88:91], v[164:167]
    ds_read_b128 v[140:143], v17 offset:6144
    v_mfma_f32_16x16x32_bf16 v[168:171], v[60:63], v[92:95], v[168:171]
    ds_read_b64_tr_b16 v[104:105], v19 offset:14368
    v_mfma_f32_16x16x32_bf16 v[172:175], v[60:63], v[96:99], v[172:175]
    ds_read_b64_tr_b16 v[106:107], v19 offset:16160
    v_mfma_f32_16x16x32_bf16 v[176:179], v[64:67], v[84:87], v[176:179]
    ds_read_b64_tr_b16 v[108:109], v18 offset:14400
    v_mfma_f32_16x16x32_bf16 v[180:183], v[64:67], v[88:91], v[180:183]
    ds_read_b64_tr_b16 v[110:111], v18 offset:16192
    v_mfma_f32_16x16x32_bf16 v[184:187], v[64:67], v[92:95], v[184:187]
    ds_read_b64_tr_b16 v[112:113], v19 offset:14432
    v_mfma_f32_16x16x32_bf16 v[188:191], v[64:67], v[96:99], v[188:191]
    ds_read_b64_tr_b16 v[114:115], v19 offset:16224
    v_mfma_f32_16x16x32_bf16 v[192:195], v[68:71], v[84:87], v[192:195]
    ds_read_b64_tr_b16 v[116:117], v18 offset:14464
    v_mfma_f32_16x16x32_bf16 v[196:199], v[68:71], v[88:91], v[196:199]
    ds_read_b64_tr_b16 v[118:119], v18 offset:16256
    v_mfma_f32_16x16x32_bf16 v[200:203], v[68:71], v[92:95], v[200:203]
    ds_read_b64_tr_b16 v[120:121], v19 offset:14496
    v_mfma_f32_16x16x32_bf16 v[204:207], v[68:71], v[96:99], v[204:207]
    ds_read_b64_tr_b16 v[122:123], v19 offset:16288
    v_mfma_f32_16x16x32_bf16 v[208:211], v[72:75], v[84:87], v[208:211]
    ds_read_b64_tr_b16 v[124:125], v18 offset:14528
    v_mfma_f32_16x16x32_bf16 v[212:215], v[72:75], v[88:91], v[212:215]
    ds_read_b64_tr_b16 v[126:127], v18 offset:16320
    v_mfma_f32_16x16x32_bf16 v[216:219], v[72:75], v[92:95], v[216:219]
    v_mfma_f32_16x16x32_bf16 v[220:223], v[72:75], v[96:99], v[220:223]
    v_mfma_f32_16x16x32_bf16 v[224:227], v[76:79], v[84:87], v[224:227]
    v_mfma_f32_16x16x32_bf16 v[228:231], v[76:79], v[88:91], v[228:231]
    v_mfma_f32_16x16x32_bf16 v[232:235], v[76:79], v[92:95], v[232:235]
    v_mfma_f32_16x16x32_bf16 v[236:239], v[76:79], v[96:99], v[236:239]
    v_mfma_f32_16x16x32_bf16 v[240:243], v[80:83], v[84:87], v[240:243]
    v_mfma_f32_16x16x32_bf16 v[244:247], v[80:83], v[88:91], v[244:247]
    v_mfma_f32_16x16x32_bf16 v[248:251], v[80:83], v[92:95], v[248:251]
    v_mfma_f32_16x16x32_bf16 v[252:255], v[80:83], v[96:99], v[252:255]
    s_waitcnt lgkmcnt(0)
    s_barrier
    v_mfma_f32_16x16x32_bf16 v[144:147], v[100:103], v[128:131], v[144:147]
    ds_read_b64_tr_b16 v[56:57], v10 offset:0
    v_mfma_f32_16x16x32_bf16 v[148:151], v[100:103], v[132:135], v[148:151]
    ds_read_b64_tr_b16 v[58:59], v10 offset:1792
    v_mfma_f32_16x16x32_bf16 v[152:155], v[100:103], v[136:139], v[152:155]
    ds_read_b128 v[84:87], v8 offset:0
    v_mfma_f32_16x16x32_bf16 v[156:159], v[100:103], v[140:143], v[156:159]
    ds_read_b128 v[88:91], v8 offset:2048
    v_mfma_f32_16x16x32_bf16 v[160:163], v[104:107], v[128:131], v[160:163]
    ds_read_b128 v[92:95], v8 offset:4096
    v_mfma_f32_16x16x32_bf16 v[164:167], v[104:107], v[132:135], v[164:167]
    ds_read_b128 v[96:99], v8 offset:6144
    v_mfma_f32_16x16x32_bf16 v[168:171], v[104:107], v[136:139], v[168:171]
    ds_read_b64_tr_b16 v[60:61], v11 offset:32
    v_mfma_f32_16x16x32_bf16 v[172:175], v[104:107], v[140:143], v[172:175]
    ds_read_b64_tr_b16 v[62:63], v11 offset:1824
    v_mfma_f32_16x16x32_bf16 v[176:179], v[108:111], v[128:131], v[176:179]
    ds_read_b64_tr_b16 v[64:65], v10 offset:64
    v_mfma_f32_16x16x32_bf16 v[180:183], v[108:111], v[132:135], v[180:183]
    ds_read_b64_tr_b16 v[66:67], v10 offset:1856
    v_mfma_f32_16x16x32_bf16 v[184:187], v[108:111], v[136:139], v[184:187]
    ds_read_b64_tr_b16 v[68:69], v11 offset:96
    v_mfma_f32_16x16x32_bf16 v[188:191], v[108:111], v[140:143], v[188:191]
    ds_read_b64_tr_b16 v[70:71], v11 offset:1888
    v_mfma_f32_16x16x32_bf16 v[192:195], v[112:115], v[128:131], v[192:195]
    ds_read_b64_tr_b16 v[72:73], v10 offset:128
    v_mfma_f32_16x16x32_bf16 v[196:199], v[112:115], v[132:135], v[196:199]
    ds_read_b64_tr_b16 v[74:75], v10 offset:1920
    v_mfma_f32_16x16x32_bf16 v[200:203], v[112:115], v[136:139], v[200:203]
    ds_read_b64_tr_b16 v[76:77], v11 offset:160
    v_mfma_f32_16x16x32_bf16 v[204:207], v[112:115], v[140:143], v[204:207]
    ds_read_b64_tr_b16 v[78:79], v11 offset:1952
    v_mfma_f32_16x16x32_bf16 v[208:211], v[116:119], v[128:131], v[208:211]
    ds_read_b64_tr_b16 v[80:81], v10 offset:192
    v_mfma_f32_16x16x32_bf16 v[212:215], v[116:119], v[132:135], v[212:215]
    ds_read_b64_tr_b16 v[82:83], v10 offset:1984
    v_mfma_f32_16x16x32_bf16 v[216:219], v[116:119], v[136:139], v[216:219]
    v_mfma_f32_16x16x32_bf16 v[220:223], v[116:119], v[140:143], v[220:223]
    v_mfma_f32_16x16x32_bf16 v[224:227], v[120:123], v[128:131], v[224:227]
    v_mfma_f32_16x16x32_bf16 v[228:231], v[120:123], v[132:135], v[228:231]
    v_mfma_f32_16x16x32_bf16 v[232:235], v[120:123], v[136:139], v[232:235]
    v_mfma_f32_16x16x32_bf16 v[236:239], v[120:123], v[140:143], v[236:239]
    v_mfma_f32_16x16x32_bf16 v[240:243], v[124:127], v[128:131], v[240:243]
    v_mfma_f32_16x16x32_bf16 v[244:247], v[124:127], v[132:135], v[244:247]
    v_mfma_f32_16x16x32_bf16 v[248:251], v[124:127], v[136:139], v[248:251]
    v_mfma_f32_16x16x32_bf16 v[252:255], v[124:127], v[140:143], v[252:255]
    s_mov_b32 s45, 4
L_g1loop:
    s_waitcnt lgkmcnt(0)
    v_mfma_f32_16x16x32_bf16 v[144:147], v[56:59], v[84:87], v[144:147]
    ds_read_b64_tr_b16 v[100:101], v10 offset:14336
    v_mfma_f32_16x16x32_bf16 v[148:151], v[56:59], v[88:91], v[148:151]
    ds_read_b64_tr_b16 v[102:103], v10 offset:16128
    v_mfma_f32_16x16x32_bf16 v[152:155], v[56:59], v[92:95], v[152:155]
    ds_read_b128 v[128:131], v9 offset:0
    v_mfma_f32_16x16x32_bf16 v[156:159], v[56:59], v[96:99], v[156:159]
    ds_read_b128 v[132:135], v9 offset:2048
    v_mfma_f32_16x16x32_bf16 v[160:163], v[60:63], v[84:87], v[160:163]
    ds_read_b128 v[136:139], v9 offset:4096
    v_mfma_f32_16x16x32_bf16 v[164:167], v[60:63], v[88:91], v[164:167]
    ds_read_b128 v[140:143], v9 offset:6144
    v_mfma_f32_16x16x32_bf16 v[168:171], v[60:63], v[92:95], v[168:171]
    ds_read_b64_tr_b16 v[104:105], v11 offset:14368
    v_mfma_f32_16x16x32_bf16 v[172:175], v[60:63], v[96:99], v[172:175]
    ds_read_b64_tr_b16 v[106:107], v11 offset:16160
    v_mfma_f32_16x16x32_bf16 v[176:179], v[64:67], v[84:87], v[176:179]
    ds_read_b64_tr_b16 v[108:109], v10 offset:14400
    v_mfma_f32_16x16x32_bf16 v[180:183], v[64:67], v[88:91], v[180:183]
    ds_read_b64_tr_b16 v[110:111], v10 offset:16192
    v_mfma_f32_16x16x32_bf16 v[184:187], v[64:67], v[92:95], v[184:187]
    ds_read_b64_tr_b16 v[112:113], v11 offset:14432
    v_mfma_f32_16x16x32_bf16 v[188:191], v[64:67], v[96:99], v[188:191]
    ds_read_b64_tr_b16 v[114:115], v11 offset:16224
    v_mfma_f32_16x16x32_bf16 v[192:195], v[68:71], v[84:87], v[192:195]
    ds_read_b64_tr_b16 v[116:117], v10 offset:14464
    v_mfma_f32_16x16x32_bf16 v[196:199], v[68:71], v[88:91], v[196:199]
    ds_read_b64_tr_b16 v[118:119], v10 offset:16256
    v_mfma_f32_16x16x32_bf16 v[200:203], v[68:71], v[92:95], v[200:203]
    ds_read_b64_tr_b16 v[120:121], v11 offset:14496
    v_mfma_f32_16x16x32_bf16 v[204:207], v[68:71], v[96:99], v[204:207]
    ds_read_b64_tr_b16 v[122:123], v11 offset:16288
    v_mfma_f32_16x16x32_bf16 v[208:211], v[72:75], v[84:87], v[208:211]
    ds_read_b64_tr_b16 v[124:125], v10 offset:14528
    v_mfma_f32_16x16x32_bf16 v[212:215], v[72:75], v[88:91], v[212:215]
    ds_read_b64_tr_b16 v[126:127], v10 offset:16320
    v_mfma_f32_16x16x32_bf16 v[216:219], v[72:75], v[92:95], v[216:219]
    s_cmp_eq_u32 s45, 4
    s_cbranch_scc0 L_g1once
    s_waitcnt vmcnt(0)
    s_cmp_eq_u32 s3, 0
    s_cbranch_scc0 L_nocf
    s_mov_b64 exec, 1
    global_atomic_add v6, v7, s[96:97] sc1
    s_mov_b64 exec, -1
L_nocf:
L_g1once:
    v_mfma_f32_16x16x32_bf16 v[220:223], v[72:75], v[96:99], v[220:223]
    v_mfma_f32_16x16x32_bf16 v[224:227], v[76:79], v[84:87], v[224:227]
    v_mfma_f32_16x16x32_bf16 v[228:231], v[76:79], v[88:91], v[228:231]
    v_mfma_f32_16x16x32_bf16 v[232:235], v[76:79], v[92:95], v[232:235]
    v_mfma_f32_16x16x32_bf16 v[236:239], v[76:79], v[96:99], v[236:239]
    v_mfma_f32_16x16x32_bf16 v[240:243], v[80:83], v[84:87], v[240:243]
    v_mfma_f32_16x16x32_bf16 v[244:247], v[80:83], v[88:91], v[244:247]
    v_mfma_f32_16x16x32_bf16 v[248:251], v[80:83], v[92:95], v[248:251]
    v_mfma_f32_16x16x32_bf16 v[252:255], v[80:83], v[96:99], v[252:255]
    s_waitcnt lgkmcnt(0)
    s_barrier
    v_mfma_f32_16x16x32_bf16 v[144:147], v[100:103], v[128:131], v[144:147]
    ds_read_b64_tr_b16 v[56:57], v14 offset:0
    v_mfma_f32_16x16x32_bf16 v[148:151], v[100:103], v[132:135], v[148:151]
    ds_read_b64_tr_b16 v[58:59], v14 offset:1792
    v_mfma_f32_16x16x32_bf16 v[152:155], v[100:103], v[136:139], v[152:155]
    ds_read_b128 v[84:87], v12 offset:0
    v_mfma_f32_16x16x32_bf16 v[156:159], v[100:103], v[140:143], v[156:159]
    ds_read_b128 v[88:91], v12 offset:2048
    v_mfma_f32_16x16x32_bf16 v[160:163], v[104:107], v[128:131], v[160:163]
    ds_read_b128 v[92:95], v12 offset:4096
    v_mfma_f32_16x16x32_bf16 v[164:167], v[104:107], v[132:135], v[164:167]
    ds_read_b128 v[96:99], v12 offset:6144
    v_mfma_f32_16x16x32_bf16 v[168:171], v[104:107], v[136:139], v[168:171]
    ds_read_b64_tr_b16 v[60:61], v15 offset:32
    v_mfma_f32_16x16x32_bf16 v[172:175], v[104:107], v[140:143], v[172:175]
    ds_read_b64_tr_b16 v[62:63], v15 offset:1824
    v_mfma_f32_16x16x32_bf16 v[176:179], v[108:111], v[128:131], v[176:179]
    ds_read_b64_tr_b16 v[64:65], v14 offset:64
    v_mfma_f32_16x16x32_bf16 v[180:183], v[108:111], v[132:135], v[180:183]
    ds_read_b64_tr_b16 v[66:67], v14 offset:1856
    v_mfma_f32_16x16x32_bf16 v[184:187], v[108:111], v[136:139], v[184:187]
    ds_read_b64_tr_b16 v[68:69], v15 offset:96
    v_mfma_f32_16x16x32_bf16 v[188:191], v[108:111], v[140:143], v[188:191]
    ds_read_b64_tr_b16 v[70:71], v15 offset:1888
    v_mfma_f32_16x16x32_bf16 v[192:195], v[112:115], v[128:131], v[192:195]
    ds_read_b64_tr_b16 v[72:73], v14 offset:128
    v_mfma_f32_16x16x32_bf16 v[196:199], v[112:115], v[132:135], v[196:199]
    ds_read_b64_tr_b16 v[74:75], v14 offset:1920
    v_mfma_f32_16x16x32_bf16 v[200:203], v[112:115], v[136:139], v[200:203]
    ds_read_b64_tr_b16 v[76:77], v15 offset:160
    v_mfma_f32_16x16x32_bf16 v[204:207], v[112:115], v[140:143], v[204:207]
    ds_read_b64_tr_b16 v[78:79], v15 offset:1952
    v_mfma_f32_16x16x32_bf16 v[208:211], v[116:119], v[128:131], v[208:211]
    ds_read_b64_tr_b16 v[80:81], v14 offset:192
    v_mfma_f32_16x16x32_bf16 v[212:215], v[116:119], v[132:135], v[212:215]
    ds_read_b64_tr_b16 v[82:83], v14 offset:1984
    v_mfma_f32_16x16x32_bf16 v[216:219], v[116:119], v[136:139], v[216:219]
    v_mfma_f32_16x16x32_bf16 v[220:223], v[116:119], v[140:143], v[220:223]
    v_mfma_f32_16x16x32_bf16 v[224:227], v[120:123], v[128:131], v[224:227]
    v_mfma_f32_16x16x32_bf16 v[228:231], v[120:123], v[132:135], v[228:231]
    v_mfma_f32_16x16x32_bf16 v[232:235], v[120:123], v[136:139], v[232:235]
    v_mfma_f32_16x16x32_bf16 v[236:239], v[120:123], v[140:143], v[236:239]
    v_mfma_f32_16x16x32_bf16 v[240:243], v[124:127], v[128:131], v[240:243]
    v_mfma_f32_16x16x32_bf16 v[244:247], v[124:127], v[132:135], v[244:247]
    v_mfma_f32_16x16x32_bf16 v[248:251], v[124:127], v[136:139], v[248:251]
    v_mfma_f32_16x16x32_bf16 v[252:255], v[124:127], v[140:143], v[252:255]
    s_waitcnt lgkmcnt(0)
    v_mfma_f32_16x16x32_bf16 v[144:147], v[56:59], v[84:87], v[144:147]
    ds_read_b64_tr_b16 v[100:101], v14 offset:14336
    v_mfma_f32_16x16x32_bf16 v[148:151], v[56:59], v[88:91], v[148:151]
    ds_read_b64_tr_b16 v[102:103], v14 offset:16128
    v_mfma_f32_16x16x32_bf16 v[152:155], v[56:59], v[92:95], v[152:155]
    ds_read_b128 v[128:131], v13 offset:0
    v_mfma_f32_16x16x32_bf16 v[156:159], v[56:59], v[96:99], v[156:159]
    ds_read_b128 v[132:135], v13 offset:2048
    v_mfma_f32_16x16x32_bf16 v[160:163], v[60:63], v[84:87], v[160:163]
    ds_read_b128 v[136:139], v13 offset:4096
    v_mfma_f32_16x16x32_bf16 v[164:167], v[60:63], v[88:91], v[164:167]
    ds_read_b128 v[140:143], v13 offset:6144
    v_mfma_f32_16x16x32_bf16 v[168:171], v[60:63], v[92:95], v[168:171]
    ds_read_b64_tr_b16 v[104:105], v15 offset:14368
    v_mfma_f32_16x16x32_bf16 v[172:175], v[60:63], v[96:99], v[172:175]
    ds_read_b64_tr_b16 v[106:107], v15 offset:16160
    v_mfma_f32_16x16x32_bf16 v[176:179], v[64:67], v[84:87], v[176:179]
    ds_read_b64_tr_b16 v[108:109], v14 offset:14400
    v_mfma_f32_16x16x32_bf16 v[180:183], v[64:67], v[88:91], v[180:183]
    ds_read_b64_tr_b16 v[110:111], v14 offset:16192
    v_mfma_f32_16x16x32_bf16 v[184:187], v[64:67], v[92:95], v[184:187]
    ds_read_b64_tr_b16 v[112:113], v15 offset:14432
    v_mfma_f32_16x16x32_bf16 v[188:191], v[64:67], v[96:99], v[188:191]
    ds_read_b64_tr_b16 v[114:115], v15 offset:16224
    v_mfma_f32_16x16x32_bf16 v[192:195], v[68:71], v[84:87], v[192:195]
    ds_read_b64_tr_b16 v[116:117], v14 offset:14464
    v_mfma_f32_16x16x32_bf16 v[196:199], v[68:71], v[88:91], v[196:199]
    ds_read_b64_tr_b16 v[118:119], v14 offset:16256
    v_mfma_f32_16x16x32_bf16 v[200:203], v[68:71], v[92:95], v[200:203]
    ds_read_b64_tr_b16 v[120:121], v15 offset:14496
    v_mfma_f32_16x16x32_bf16 v[204:207], v[68:71], v[96:99], v[204:207]
    ds_read_b64_tr_b16 v[122:123], v15 offset:16288
    v_mfma_f32_16x16x32_bf16 v[208:211], v[72:75], v[84:87], v[208:211]
    ds_read_b64_tr_b16 v[124:125], v14 offset:14528
    v_mfma_f32_16x16x32_bf16 v[212:215], v[72:75], v[88:91], v[212:215]
    ds_read_b64_tr_b16 v[126:127], v14 offset:16320
    v_mfma_f32_16x16x32_bf16 v[216:219], v[72:75], v[92:95], v[216:219]
    v_mfma_f32_16x16x32_bf16 v[220:223], v[72:75], v[96:99], v[220:223]
    v_mfma_f32_16x16x32_bf16 v[224:227], v[76:79], v[84:87], v[224:227]
    v_mfma_f32_16x16x32_bf16 v[228:231], v[76:79], v[88:91], v[228:231]
    v_mfma_f32_16x16x32_bf16 v[232:235], v[76:79], v[92:95], v[232:235]
    v_mfma_f32_16x16x32_bf16 v[236:239], v[76:79], v[96:99], v[236:239]
    v_mfma_f32_16x16x32_bf16 v[240:243], v[80:83], v[84:87], v[240:243]
    v_mfma_f32_16x16x32_bf16 v[244:247], v[80:83], v[88:91], v[244:247]
    v_mfma_f32_16x16x32_bf16 v[248:251], v[80:83], v[92:95], v[248:251]
    v_mfma_f32_16x16x32_bf16 v[252:255], v[80:83], v[96:99], v[252:255]
    s_waitcnt lgkmcnt(0)
    s_barrier
    v_mfma_f32_16x16x32_bf16 v[144:147], v[100:103], v[128:131], v[144:147]
    ds_read_b64_tr_b16 v[56:57], v18 offset:0
    v_mfma_f32_16x16x32_bf16 v[148:151], v[100:103], v[132:135], v[148:151]
    ds_read_b64_tr_b16 v[58:59], v18 offset:1792
    v_mfma_f32_16x16x32_bf16 v[152:155], v[100:103], v[136:139], v[152:155]
    ds_read_b128 v[84:87], v16 offset:0
    v_mfma_f32_16x16x32_bf16 v[156:159], v[100:103], v[140:143], v[156:159]
    ds_read_b128 v[88:91], v16 offset:2048
    v_mfma_f32_16x16x32_bf16 v[160:163], v[104:107], v[128:131], v[160:163]
    ds_read_b128 v[92:95], v16 offset:4096
    v_mfma_f32_16x16x32_bf16 v[164:167], v[104:107], v[132:135], v[164:167]
    ds_read_b128 v[96:99], v16 offset:6144
    v_mfma_f32_16x16x32_bf16 v[168:171], v[104:107], v[136:139], v[168:171]
    ds_read_b64_tr_b16 v[60:61], v19 offset:32
    v_mfma_f32_16x16x32_bf16 v[172:175], v[104:107], v[140:143], v[172:175]
    ds_read_b64_tr_b16 v[62:63], v19 offset:1824
    v_mfma_f32_16x16x32_bf16 v[176:179], v[108:111], v[128:131], v[176:179]
    ds_read_b64_tr_b16 v[64:65], v18 offset:64
    v_mfma_f32_16x16x32_bf16 v[180:183], v[108:111], v[132:135], v[180:183]
    ds_read_b64_tr_b16 v[66:67], v18 offset:1856
    v_mfma_f32_16x16x32_bf16 v[184:187], v[108:111], v[136:139], v[184:187]
    ds_read_b64_tr_b16 v[68:69], v19 offset:96
    v_mfma_f32_16x16x32_bf16 v[188:191], v[108:111], v[140:143], v[188:191]
    ds_read_b64_tr_b16 v[70:71], v19 offset:1888
    v_mfma_f32_16x16x32_bf16 v[192:195], v[112:115], v[128:131], v[192:195]
    ds_read_b64_tr_b16 v[72:73], v18 offset:128
    v_mfma_f32_16x16x32_bf16 v[196:199], v[112:115], v[132:135], v[196:199]
    ds_read_b64_tr_b16 v[74:75], v18 offset:1920
    v_mfma_f32_16x16x32_bf16 v[200:203], v[112:115], v[136:139], v[200:203]
    ds_read_b64_tr_b16 v[76:77], v19 offset:160
    v_mfma_f32_16x16x32_bf16 v[204:207], v[112:115], v[140:143], v[204:207]
    ds_read_b64_tr_b16 v[78:79], v19 offset:1952
    v_mfma_f32_16x16x32_bf16 v[208:211], v[116:119], v[128:131], v[208:211]
    ds_read_b64_tr_b16 v[80:81], v18 offset:192
    v_mfma_f32_16x16x32_bf16 v[212:215], v[116:119], v[132:135], v[212:215]
    ds_read_b64_tr_b16 v[82:83], v18 offset:1984
    v_mfma_f32_16x16x32_bf16 v[216:219], v[116:119], v[136:139], v[216:219]
    v_mfma_f32_16x16x32_bf16 v[220:223], v[116:119], v[140:143], v[220:223]
    v_mfma_f32_16x16x32_bf16 v[224:227], v[120:123], v[128:131], v[224:227]
    v_mfma_f32_16x16x32_bf16 v[228:231], v[120:123], v[132:135], v[228:231]
    v_mfma_f32_16x16x32_bf16 v[232:235], v[120:123], v[136:139], v[232:235]
    v_mfma_f32_16x16x32_bf16 v[236:239], v[120:123], v[140:143], v[236:239]
    v_mfma_f32_16x16x32_bf16 v[240:243], v[124:127], v[128:131], v[240:243]
    v_mfma_f32_16x16x32_bf16 v[244:247], v[124:127], v[132:135], v[244:247]
    v_mfma_f32_16x16x32_bf16 v[248:251], v[124:127], v[136:139], v[248:251]
    v_mfma_f32_16x16x32_bf16 v[252:255], v[124:127], v[140:143], v[252:255]
    s_waitcnt lgkmcnt(0)
    v_mfma_f32_16x16x32_bf16 v[144:147], v[56:59], v[84:87], v[144:147]
    ds_read_b64_tr_b16 v[100:101], v18 offset:14336
    v_mfma_f32_16x16x32_bf16 v[148:151], v[56:59], v[88:91], v[148:151]
    ds_read_b64_tr_b16 v[102:103], v18 offset:16128
    v_mfma_f32_16x16x32_bf16 v[152:155], v[56:59], v[92:95], v[152:155]
    ds_read_b128 v[128:131], v17 offset:0
    v_mfma_f32_16x16x32_bf16 v[156:159], v[56:59], v[96:99], v[156:159]
    ds_read_b128 v[132:135], v17 offset:2048
    v_mfma_f32_16x16x32_bf16 v[160:163], v[60:63], v[84:87], v[160:163]
    ds_read_b128 v[136:139], v17 offset:4096
    v_mfma_f32_16x16x32_bf16 v[164:167], v[60:63], v[88:91], v[164:167]
    ds_read_b128 v[140:143], v17 offset:6144
    v_mfma_f32_16x16x32_bf16 v[168:171], v[60:63], v[92:95], v[168:171]
    ds_read_b64_tr_b16 v[104:105], v19 offset:14368
    v_mfma_f32_16x16x32_bf16 v[172:175], v[60:63], v[96:99], v[172:175]
    ds_read_b64_tr_b16 v[106:107], v19 offset:16160
    v_mfma_f32_16x16x32_bf16 v[176:179], v[64:67], v[84:87], v[176:179]
    ds_read_b64_tr_b16 v[108:109], v18 offset:14400
    v_mfma_f32_16x16x32_bf16 v[180:183], v[64:67], v[88:91], v[180:183]
    ds_read_b64_tr_b16 v[110:111], v18 offset:16192
    v_mfma_f32_16x16x32_bf16 v[184:187], v[64:67], v[92:95], v[184:187]
    ds_read_b64_tr_b16 v[112:113], v19 offset:14432
    v_mfma_f32_16x16x32_bf16 v[188:191], v[64:67], v[96:99], v[188:191]
    ds_read_b64_tr_b16 v[114:115], v19 offset:16224
    v_mfma_f32_16x16x32_bf16 v[192:195], v[68:71], v[84:87], v[192:195]
    ds_read_b64_tr_b16 v[116:117], v18 offset:14464
    v_mfma_f32_16x16x32_bf16 v[196:199], v[68:71], v[88:91], v[196:199]
    ds_read_b64_tr_b16 v[118:119], v18 offset:16256
    v_mfma_f32_16x16x32_bf16 v[200:203], v[68:71], v[92:95], v[200:203]
    ds_read_b64_tr_b16 v[120:121], v19 offset:14496
    v_mfma_f32_16x16x32_bf16 v[204:207], v[68:71], v[96:99], v[204:207]
    ds_read_b64_tr_b16 v[122:123], v19 offset:16288
    v_mfma_f32_16x16x32_bf16 v[208:211], v[72:75], v[84:87], v[208:211]
    ds_read_b64_tr_b16 v[124:125], v18 offset:14528
    v_mfma_f32_16x16x32_bf16 v[212:215], v[72:75], v[88:91], v[212:215]
    ds_read_b64_tr_b16 v[126:127], v18 offset:16320
    v_mfma_f32_16x16x32_bf16 v[216:219], v[72:75], v[92:95], v[216:219]
    v_mfma_f32_16x16x32_bf16 v[220:223], v[72:75], v[96:99], v[220:223]
    v_mfma_f32_16x16x32_bf16 v[224:227], v[76:79], v[84:87], v[224:227]
    v_mfma_f32_16x16x32_bf16 v[228:231], v[76:79], v[88:91], v[228:231]
    v_mfma_f32_16x16x32_bf16 v[232:235], v[76:79], v[92:95], v[232:235]
    v_mfma_f32_16x16x32_bf16 v[236:239], v[76:79], v[96:99], v[236:239]
    v_mfma_f32_16x16x32_bf16 v[240:243], v[80:83], v[84:87], v[240:243]
    v_mfma_f32_16x16x32_bf16 v[244:247], v[80:83], v[88:91], v[244:247]
    v_mfma_f32_16x16x32_bf16 v[248:251], v[80:83], v[92:95], v[248:251]
    v_mfma_f32_16x16x32_bf16 v[252:255], v[80:83], v[96:99], v[252:255]
    s_waitcnt lgkmcnt(0)
    s_barrier
    v_mfma_f32_16x16x32_bf16 v[144:147], v[100:103], v[128:131], v[144:147]
    ds_read_b64_tr_b16 v[56:57], v10 offset:0
    v_mfma_f32_16x16x32_bf16 v[148:151], v[100:103], v[132:135], v[148:151]
    ds_read_b64_tr_b16 v[58:59], v10 offset:1792
    v_mfma_f32_16x16x32_bf16 v[152:155], v[100:103], v[136:139], v[152:155]
    ds_read_b128 v[84:87], v8 offset:0
    v_mfma_f32_16x16x32_bf16 v[156:159], v[100:103], v[140:143], v[156:159]
    ds_read_b128 v[88:91], v8 offset:2048
    v_mfma_f32_16x16x32_bf16 v[160:163], v[104:107], v[128:131], v[160:163]
    ds_read_b128 v[92:95], v8 offset:4096
    v_mfma_f32_16x16x32_bf16 v[164:167], v[104:107], v[132:135], v[164:167]
    ds_read_b128 v[96:99], v8 offset:6144
    v_mfma_f32_16x16x32_bf16 v[168:171], v[104:107], v[136:139], v[168:171]
    ds_read_b64_tr_b16 v[60:61], v11 offset:32
    v_mfma_f32_16x16x32_bf16 v[172:175], v[104:107], v[140:143], v[172:175]
    ds_read_b64_tr_b16 v[62:63], v11 offset:1824
    v_mfma_f32_16x16x32_bf16 v[176:179], v[108:111], v[128:131], v[176:179]
    ds_read_b64_tr_b16 v[64:65], v10 offset:64
    v_mfma_f32_16x16x32_bf16 v[180:183], v[108:111], v[132:135], v[180:183]
    ds_read_b64_tr_b16 v[66:67], v10 offset:1856
    v_mfma_f32_16x16x32_bf16 v[184:187], v[108:111], v[136:139], v[184:187]
    ds_read_b64_tr_b16 v[68:69], v11 offset:96
    v_mfma_f32_16x16x32_bf16 v[188:191], v[108:111], v[140:143], v[188:191]
    ds_read_b64_tr_b16 v[70:71], v11 offset:1888
    v_mfma_f32_16x16x32_bf16 v[192:195], v[112:115], v[128:131], v[192:195]
    ds_read_b64_tr_b16 v[72:73], v10 offset:128
    v_mfma_f32_16x16x32_bf16 v[196:199], v[112:115], v[132:135], v[196:199]
    ds_read_b64_tr_b16 v[74:75], v10 offset:1920
    v_mfma_f32_16x16x32_bf16 v[200:203], v[112:115], v[136:139], v[200:203]
    ds_read_b64_tr_b16 v[76:77], v11 offset:160
    v_mfma_f32_16x16x32_bf16 v[204:207], v[112:115], v[140:143], v[204:207]
    ds_read_b64_tr_b16 v[78:79], v11 offset:1952
    v_mfma_f32_16x16x32_bf16 v[208:211], v[116:119], v[128:131], v[208:211]
    ds_read_b64_tr_b16 v[80:81], v10 offset:192
    v_mfma_f32_16x16x32_bf16 v[212:215], v[116:119], v[132:135], v[212:215]
    ds_read_b64_tr_b16 v[82:83], v10 offset:1984
    v_mfma_f32_16x16x32_bf16 v[216:219], v[116:119], v[136:139], v[216:219]
    s_sub_u32 s45, s45, 1
    v_mfma_f32_16x16x32_bf16 v[220:223], v[116:119], v[140:143], v[220:223]
    s_cmp_lg_u32 s45, 0
    v_mfma_f32_16x16x32_bf16 v[224:227], v[120:123], v[128:131], v[224:227]
    v_mfma_f32_16x16x32_bf16 v[228:231], v[120:123], v[132:135], v[228:231]
    v_mfma_f32_16x16x32_bf16 v[232:235], v[120:123], v[136:139], v[232:235]
    v_mfma_f32_16x16x32_bf16 v[236:239], v[120:123], v[140:143], v[236:239]
    v_mfma_f32_16x16x32_bf16 v[240:243], v[124:127], v[128:131], v[240:243]
    v_mfma_f32_16x16x32_bf16 v[244:247], v[124:127], v[132:135], v[244:247]
    v_mfma_f32_16x16x32_bf16 v[248:251], v[124:127], v[136:139], v[248:251]
    v_mfma_f32_16x16x32_bf16 v[252:255], v[124:127], v[140:143], v[252:255]
    s_cbranch_scc1 L_g1loop
    s_waitcnt lgkmcnt(0)
    v_mfma_f32_16x16x32_bf16 v[144:147], v[56:59], v[84:87], v[144:147]
    ds_read_b64_tr_b16 v[100:101], v10 offset:14336
    v_mfma_f32_16x16x32_bf16 v[148:151], v[56:59], v[88:91], v[148:151]
    ds_read_b64_tr_b16 v[102:103], v10 offset:16128
    v_mfma_f32_16x16x32_bf16 v[152:155], v[56:59], v[92:95], v[152:155]
    ds_read_b128 v[128:131], v9 offset:0
    v_mfma_f32_16x16x32_bf16 v[156:159], v[56:59], v[96:99], v[156:159]
    ds_read_b128 v[132:135], v9 offset:2048
    v_mfma_f32_16x16x32_bf16 v[160:163], v[60:63], v[84:87], v[160:163]
    ds_read_b128 v[136:139], v9 offset:4096
    v_mfma_f32_16x16x32_bf16 v[164:167], v[60:63], v[88:91], v[164:167]
    ds_read_b128 v[140:143], v9 offset:6144
    v_mfma_f32_16x16x32_bf16 v[168:171], v[60:63], v[92:95], v[168:171]
    ds_read_b64_tr_b16 v[104:105], v11 offset:14368
    v_mfma_f32_16x16x32_bf16 v[172:175], v[60:63], v[96:99], v[172:175]
    ds_read_b64_tr_b16 v[106:107], v11 offset:16160
    v_mfma_f32_16x16x32_bf16 v[176:179], v[64:67], v[84:87], v[176:179]
    ds_read_b64_tr_b16 v[108:109], v10 offset:14400
    v_mfma_f32_16x16x32_bf16 v[180:183], v[64:67], v[88:91], v[180:183]
    ds_read_b64_tr_b16 v[110:111], v10 offset:16192
    v_mfma_f32_16x16x32_bf16 v[184:187], v[64:67], v[92:95], v[184:187]
    ds_read_b64_tr_b16 v[112:113], v11 offset:14432
    v_mfma_f32_16x16x32_bf16 v[188:191], v[64:67], v[96:99], v[188:191]
    ds_read_b64_tr_b16 v[114:115], v11 offset:16224
    v_mfma_f32_16x16x32_bf16 v[192:195], v[68:71], v[84:87], v[192:195]
    ds_read_b64_tr_b16 v[116:117], v10 offset:14464
    v_mfma_f32_16x16x32_bf16 v[196:199], v[68:71], v[88:91], v[196:199]
    ds_read_b64_tr_b16 v[118:119], v10 offset:16256
    v_mfma_f32_16x16x32_bf16 v[200:203], v[68:71], v[92:95], v[200:203]
    ds_read_b64_tr_b16 v[120:121], v11 offset:14496
    v_mfma_f32_16x16x32_bf16 v[204:207], v[68:71], v[96:99], v[204:207]
    ds_read_b64_tr_b16 v[122:123], v11 offset:16288
    v_mfma_f32_16x16x32_bf16 v[208:211], v[72:75], v[84:87], v[208:211]
    ds_read_b64_tr_b16 v[124:125], v10 offset:14528
    v_mfma_f32_16x16x32_bf16 v[212:215], v[72:75], v[88:91], v[212:215]
    ds_read_b64_tr_b16 v[126:127], v10 offset:16320
    v_mfma_f32_16x16x32_bf16 v[216:219], v[72:75], v[92:95], v[216:219]
    v_mfma_f32_16x16x32_bf16 v[220:223], v[72:75], v[96:99], v[220:223]
    v_mfma_f32_16x16x32_bf16 v[224:227], v[76:79], v[84:87], v[224:227]
    v_mfma_f32_16x16x32_bf16 v[228:231], v[76:79], v[88:91], v[228:231]
    v_mfma_f32_16x16x32_bf16 v[232:235], v[76:79], v[92:95], v[232:235]
    v_mfma_f32_16x16x32_bf16 v[236:239], v[76:79], v[96:99], v[236:239]
    v_mfma_f32_16x16x32_bf16 v[240:243], v[80:83], v[84:87], v[240:243]
    v_mfma_f32_16x16x32_bf16 v[244:247], v[80:83], v[88:91], v[244:247]
    v_mfma_f32_16x16x32_bf16 v[248:251], v[80:83], v[92:95], v[248:251]
    v_mfma_f32_16x16x32_bf16 v[252:255], v[80:83], v[96:99], v[252:255]
    s_waitcnt lgkmcnt(0)
    v_mfma_f32_16x16x32_bf16 v[144:147], v[100:103], v[128:131], v[144:147]
    v_and_b32 v2, 15, v0
    v_mfma_f32_16x16x32_bf16 v[148:151], v[100:103], v[132:135], v[148:151]
    v_lshrrev_b32 v3, 4, v0
    v_mfma_f32_16x16x32_bf16 v[152:155], v[100:103], v[136:139], v[152:155]
    s_mul_i32 s42, s41, 448
    s_add_u32 s42, s42, 135808
    v_mfma_f32_16x16x32_bf16 v[156:159], v[100:103], v[140:143], v[156:159]
    v_lshlrev_b32 v4, 4, v3
    v_mfma_f32_16x16x32_bf16 v[160:163], v[104:107], v[128:131], v[160:163]
    v_add_u32 v4, s42, v4
    v_mfma_f32_16x16x32_bf16 v[164:167], v[104:107], v[132:135], v[164:167]
    ds_read_b128 v[56:59], v4 offset:0
    v_mfma_f32_16x16x32_bf16 v[168:171], v[104:107], v[136:139], v[168:171]
    ds_read_b128 v[60:63], v4 offset:64
    v_mfma_f32_16x16x32_bf16 v[172:175], v[104:107], v[140:143], v[172:175]
    ds_read_b128 v[64:67], v4 offset:128
    v_mfma_f32_16x16x32_bf16 v[176:179], v[108:111], v[128:131], v[176:179]
    ds_read_b128 v[68:71], v4 offset:192
    v_mfma_f32_16x16x32_bf16 v[180:183], v[108:111], v[132:135], v[180:183]
    ds_read_b128 v[72:75], v4 offset:256
    v_mfma_f32_16x16x32_bf16 v[184:187], v[108:111], v[136:139], v[184:187]
    ds_read_b128 v[76:79], v4 offset:320
    v_mfma_f32_16x16x32_bf16 v[188:191], v[108:111], v[140:143], v[188:191]
    ds_read_b128 v[80:83], v4 offset:384
    v_mfma_f32_16x16x32_bf16 v[192:195], v[112:115], v[128:131], v[192:195]
    s_lshl_b32 s42, s40, 8
    s_add_u32 s42, s42, 136832
    v_mfma_f32_16x16x32_bf16 v[196:199], v[112:115], v[132:135], v[196:199]
    v_lshlrev_b32 v5, 2, v2
    v_mfma_f32_16x16x32_bf16 v[200:203], v[112:115], v[136:139], v[200:203]
    v_add_u32 v5, s42, v5
    v_mfma_f32_16x16x32_bf16 v[204:207], v[112:115], v[140:143], v[204:207]
    ds_read_b32 v84, v5 offset:0
    v_mfma_f32_16x16x32_bf16 v[208:211], v[116:119], v[128:131], v[208:211]
    ds_read_b32 v86, v5 offset:64
    v_mfma_f32_16x16x32_bf16 v[212:215], v[116:119], v[132:135], v[212:215]
    ds_read_b32 v88, v5 offset:128
    v_mfma_f32_16x16x32_bf16 v[216:219], v[116:119], v[136:139], v[216:219]
    ds_read_b32 v90, v5 offset:192
    v_mfma_f32_16x16x32_bf16 v[220:223], v[116:119], v[140:143], v[220:223]
    s_lshl_b32 s48, s14, 3
    s_lshl_b32 s49, s40, 2
    s_add_u32 s48, s48, s49
    v_mfma_f32_16x16x32_bf16 v[224:227], v[120:123], v[128:131], v[224:227]
    s_mul_i32 s48, s48, 112
    s_mul_i32 s49, s15, 7
    s_add_u32 s48, s48, s49
    v_mfma_f32_16x16x32_bf16 v[228:231], v[120:123], v[132:135], v[228:231]
    s_lshl_b32 s49, s41, 2
    s_add_u32 s48, s48, s49
    s_lshl_b32 s48, s48, 10
    v_mfma_f32_16x16x32_bf16 v[232:235], v[120:123], v[136:139], v[232:235]
    v_lshlrev_b32 v38, 4, v0
    v_mfma_f32_16x16x32_bf16 v[236:239], v[120:123], v[140:143], v[236:239]
    s_cmp_eq_u32 s41, 0
    s_cselect_b32 s50, 0, 0x7fff0000
    v_mfma_f32_16x16x32_bf16 v[240:243], v[124:127], v[128:131], v[240:243]
    v_add_u32 v39, s50, v38
    v_mfma_f32_16x16x32_bf16 v[244:247], v[124:127], v[132:135], v[244:247]
    s_add_u32 s51, s48, 3072
    s_lshl_b32 s50, s40, 11
    s_add_u32 s50, s50, 49152
    v_mfma_f32_16x16x32_bf16 v[248:251], v[124:127], v[136:139], v[248:251]
    v_mfma_f32_16x16x32_bf16 v[252:255], v[124:127], v[140:143], v[252:255]
    s_nop 7
    s_waitcnt lgkmcnt(0)
    s_cmp_eq_u32 s41, 0
    s_cbranch_scc0 L_g1epi_fh1
    v_pk_fma_f32 v[144:145], v[56:57], v[84:85], v[144:145] op_sel_hi:[1,0,1]
    v_pk_fma_f32 v[146:147], v[58:59], v[84:85], v[146:147] op_sel_hi:[1,0,1]
    v_cvt_pk_bf16_f32 v92, v144, v145
    v_cvt_pk_bf16_f32 v93, v146, v147
    v_pk_fma_f32 v[160:161], v[60:61], v[84:85], v[160:161] op_sel_hi:[1,0,1]
    v_pk_fma_f32 v[162:163], v[62:63], v[84:85], v[162:163] op_sel_hi:[1,0,1]
    v_cvt_pk_bf16_f32 v94, v160, v161
    v_cvt_pk_bf16_f32 v95, v162, v163
    v_pk_max_i16 v92, v92, 0
    v_pk_max_i16 v93, v93, 0
    v_pk_max_i16 v94, v94, 0
    v_pk_max_i16 v95, v95, 0
    s_add_u32 s49, s48, 0
    buffer_store_dwordx4 v[92:95], v38, s[28:31], s49 offen offset:0 sc1
    v_pk_fma_f32 v[176:177], v[64:65], v[84:85], v[176:177] op_sel_hi:[1,0,1]
    v_pk_fma_f32 v[178:179], v[66:67], v[84:85], v[178:179] op_sel_hi:[1,0,1]
    v_cvt_pk_bf16_f32 v96, v176, v177
    v_cvt_pk_bf16_f32 v97, v178, v179
    v_pk_fma_f32 v[192:193], v[68:69], v[84:85], v[192:193] op_sel_hi:[1,0,1]
    v_pk_fma_f32 v[194:195], v[70:71], v[84:85], v[194:195] op_sel_hi:[1,0,1]
    v_cvt_pk_bf16_f32 v98, v192, v193
    v_cvt_pk_bf16_f32 v99, v194, v195
    v_pk_max_i16 v96, v96, 0
    v_pk_max_i16 v97, v97, 0
    v_pk_max_i16 v98, v98, 0
    v_pk_max_i16 v99, v99, 0
    buffer_store_dwordx4 v[96:99], v38, s[28:31], s49 offen offset:1024 sc1
    v_pk_fma_f32 v[208:209], v[72:73], v[84:85], v[208:209] op_sel_hi:[1,0,1]
    v_pk_fma_f32 v[210:211], v[74:75], v[84:85], v[210:211] op_sel_hi:[1,0,1]
    v_cvt_pk_bf16_f32 v100, v208, v209
    v_cvt_pk_bf16_f32 v101, v210, v211
    v_pk_fma_f32 v[224:225], v[76:77], v[84:85], v[224:225] op_sel_hi:[1,0,1]
    v_pk_fma_f32 v[226:227], v[78:79], v[84:85], v[226:227] op_sel_hi:[1,0,1]
    v_cvt_pk_bf16_f32 v102, v224, v225
    v_cvt_pk_bf16_f32 v103, v226, v227
    v_pk_max_i16 v100, v100, 0
    v_pk_max_i16 v101, v101, 0
    v_pk_max_i16 v102, v102, 0
    v_pk_max_i16 v103, v103, 0
    buffer_store_dwordx4 v[100:103], v38, s[28:31], s49 offen offset:2048 sc1
    v_pk_fma_f32 v[240:241], v[80:81], v[84:85], v[240:241] op_sel_hi:[1,0,1]
    v_pk_fma_f32 v[242:243], v[82:83], v[84:85], v[242:243] op_sel_hi:[1,0,1]
    v_cvt_pk_bf16_f32 v104, v240, v241
    v_cvt_pk_bf16_f32 v105, v242, v243
    v_pk_fma_f32 v[148:149], v[56:57], v[86:87], v[148:149] op_sel_hi:[1,0,1]
    v_pk_fma_f32 v[150:151], v[58:59], v[86:87], v[150:151] op_sel_hi:[1,0,1]
    v_cvt_pk_bf16_f32 v106, v148, v149
    v_cvt_pk_bf16_f32 v107, v150, v151
    v_pk_fma_f32 v[164:165], v[60:61], v[86:87], v[164:165] op_sel_hi:[1,0,1]
    v_pk_fma_f32 v[166:167], v[62:63], v[86:87], v[166:167] op_sel_hi:[1,0,1]
    v_cvt_pk_bf16_f32 v108, v164, v165
    v_cvt_pk_bf16_f32 v109, v166, v167
    v_pk_max_i16 v106, v106, 0
    v_pk_max_i16 v107, v107, 0
    v_pk_max_i16 v108, v108, 0
    v_pk_max_i16 v109, v109, 0
    s_add_u32 s49, s48, 114688
    buffer_store_dwordx4 v[106:109], v38, s[28:31], s49 offen offset:0 sc1
    v_pk_fma_f32 v[180:181], v[64:65], v[86:87], v[180:181] op_sel_hi:[1,0,1]
    v_pk_fma_f32 v[182:183], v[66:67], v[86:87], v[182:183] op_sel_hi:[1,0,1]
    v_cvt_pk_bf16_f32 v110, v180, v181
    v_cvt_pk_bf16_f32 v111, v182, v183
    v_pk_fma_f32 v[196:197], v[68:69], v[86:87], v[196:197] op_sel_hi:[1,0,1]
    v_pk_fma_f32 v[198:199], v[70:71], v[86:87], v[198:199] op_sel_hi:[1,0,1]
    v_cvt_pk_bf16_f32 v112, v196, v197
    v_cvt_pk_bf16_f32 v113, v198, v199
    v_pk_max_i16 v110, v110, 0
    v_pk_max_i16 v111, v111, 0
    v_pk_max_i16 v112, v112, 0
    v_pk_max_i16 v113, v113, 0
    buffer_store_dwordx4 v[110:113], v38, s[28:31], s49 offen offset:1024 sc1
    v_pk_fma_f32 v[212:213], v[72:73], v[86:87], v[212:213] op_sel_hi:[1,0,1]
    v_pk_fma_f32 v[214:215], v[74:75], v[86:87], v[214:215] op_sel_hi:[1,0,1]
    v_cvt_pk_bf16_f32 v114, v212, v213
    v_cvt_pk_bf16_f32 v115, v214, v215
    v_pk_fma_f32 v[228:229], v[76:77], v[86:87], v[228:229] op_sel_hi:[1,0,1]
    v_pk_fma_f32 v[230:231], v[78:79], v[86:87], v[230:231] op_sel_hi:[1,0,1]
    v_cvt_pk_bf16_f32 v116, v228, v229
    v_cvt_pk_bf16_f32 v117, v230, v231
    v_pk_max_i16 v114, v114, 0
    v_pk_max_i16 v115, v115, 0
    v_pk_max_i16 v116, v116, 0
    v_pk_max_i16 v117, v117, 0
    buffer_store_dwordx4 v[114:117], v38, s[28:31], s49 offen offset:2048 sc1
    v_pk_fma_f32 v[244:245], v[80:81], v[86:87], v[244:245] op_sel_hi:[1,0,1]
    v_pk_fma_f32 v[246:247], v[82:83], v[86:87], v[246:247] op_sel_hi:[1,0,1]
    v_cvt_pk_bf16_f32 v118, v244, v245
    v_cvt_pk_bf16_f32 v119, v246, v247
    v_pk_fma_f32 v[152:153], v[56:57], v[88:89], v[152:153] op_sel_hi:[1,0,1]
    v_pk_fma_f32 v[154:155], v[58:59], v[88:89], v[154:155] op_sel_hi:[1,0,1]
    v_cvt_pk_bf16_f32 v120, v152, v153
    v_cvt_pk_bf16_f32 v121, v154, v155
    v_pk_fma_f32 v[168:169], v[60:61], v[88:89], v[168:169] op_sel_hi:[1,0,1]
    v_pk_fma_f32 v[170:171], v[62:63], v[88:89], v[170:171] op_sel_hi:[1,0,1]
    v_cvt_pk_bf16_f32 v122, v168, v169
    v_cvt_pk_bf16_f32 v123, v170, v171
    v_pk_fma_f32 v[184:185], v[64:65], v[88:89], v[184:185] op_sel_hi:[1,0,1]
    v_pk_fma_f32 v[186:187], v[66:67], v[88:89], v[186:187] op_sel_hi:[1,0,1]
    v_cvt_pk_bf16_f32 v124, v184, v185
    v_cvt_pk_bf16_f32 v125, v186, v187
    v_pk_fma_f32 v[200:201], v[68:69], v[88:89], v[200:201] op_sel_hi:[1,0,1]
    v_pk_fma_f32 v[202:203], v[70:71], v[88:89], v[202:203] op_sel_hi:[1,0,1]
    v_cvt_pk_bf16_f32 v126, v200, v201
    v_cvt_pk_bf16_f32 v127, v202, v203
    v_pk_fma_f32 v[216:217], v[72:73], v[88:89], v[216:217] op_sel_hi:[1,0,1]
    v_pk_fma_f32 v[218:219], v[74:75], v[88:89], v[218:219] op_sel_hi:[1,0,1]
    v_cvt_pk_bf16_f32 v128, v216, v217
    v_cvt_pk_bf16_f32 v129, v218, v219
    v_pk_fma_f32 v[232:233], v[76:77], v[88:89], v[232:233] op_sel_hi:[1,0,1]
    v_pk_fma_f32 v[234:235], v[78:79], v[88:89], v[234:235] op_sel_hi:[1,0,1]
    v_cvt_pk_bf16_f32 v130, v232, v233
    v_cvt_pk_bf16_f32 v131, v234, v235
    v_pk_fma_f32 v[248:249], v[80:81], v[88:89], v[248:249] op_sel_hi:[1,0,1]
    v_pk_fma_f32 v[250:251], v[82:83], v[88:89], v[250:251] op_sel_hi:[1,0,1]
    v_cvt_pk_bf16_f32 v132, v248, v249
    v_cvt_pk_bf16_f32 v133, v250, v251
    v_pk_fma_f32 v[156:157], v[56:57], v[90:91], v[156:157] op_sel_hi:[1,0,1]
    v_pk_fma_f32 v[158:159], v[58:59], v[90:91], v[158:159] op_sel_hi:[1,0,1]
    v_cvt_pk_bf16_f32 v134, v156, v157
    v_cvt_pk_bf16_f32 v135, v158, v159
    v_pk_fma_f32 v[172:173], v[60:61], v[90:91], v[172:173] op_sel_hi:[1,0,1]
    v_pk_fma_f32 v[174:175], v[62:63], v[90:91], v[174:175] op_sel_hi:[1,0,1]
    v_cvt_pk_bf16_f32 v136, v172, v173
    v_cvt_pk_bf16_f32 v137, v174, v175
    v_pk_fma_f32 v[188:189], v[64:65], v[90:91], v[188:189] op_sel_hi:[1,0,1]
    v_pk_fma_f32 v[190:191], v[66:67], v[90:91], v[190:191] op_sel_hi:[1,0,1]
    v_cvt_pk_bf16_f32 v138, v188, v189
    v_cvt_pk_bf16_f32 v139, v190, v191
    v_pk_fma_f32 v[204:205], v[68:69], v[90:91], v[204:205] op_sel_hi:[1,0,1]
    v_pk_fma_f32 v[206:207], v[70:71], v[90:91], v[206:207] op_sel_hi:[1,0,1]
    v_cvt_pk_bf16_f32 v140, v204, v205
    v_cvt_pk_bf16_f32 v141, v206, v207
    v_pk_fma_f32 v[220:221], v[72:73], v[90:91], v[220:221] op_sel_hi:[1,0,1]
    v_pk_fma_f32 v[222:223], v[74:75], v[90:91], v[222:223] op_sel_hi:[1,0,1]
    v_cvt_pk_bf16_f32 v142, v220, v221
    v_cvt_pk_bf16_f32 v143, v222, v223
    v_pk_fma_f32 v[236:237], v[76:77], v[90:91], v[236:237] op_sel_hi:[1,0,1]
    v_pk_fma_f32 v[238:239], v[78:79], v[90:91], v[238:239] op_sel_hi:[1,0,1]
    v_cvt_pk_bf16_f32 v8, v236, v237
    v_cvt_pk_bf16_f32 v9, v238, v239
    v_pk_fma_f32 v[252:253], v[80:81], v[90:91], v[252:253] op_sel_hi:[1,0,1]
    v_pk_fma_f32 v[254:255], v[82:83], v[90:91], v[254:255] op_sel_hi:[1,0,1]
    v_cvt_pk_bf16_f32 v10, v252, v253
    v_cvt_pk_bf16_f32 v11, v254, v255
    v_pk_max_i16 v180, v104, 0
    v_pk_max_i16 v181, v105, 0
    v_pk_max_i16 v196, v118, 0
    v_pk_max_i16 v197, v119, 0
    v_pk_max_i16 v200, v120, 0
    v_pk_max_i16 v201, v121, 0
    v_pk_max_i16 v202, v122, 0
    v_pk_max_i16 v203, v123, 0
    v_pk_max_i16 v204, v124, 0
    v_pk_max_i16 v205, v125, 0
    v_pk_max_i16 v206, v126, 0
    v_pk_max_i16 v207, v127, 0
    v_pk_max_i16 v208, v128, 0
    v_pk_max_i16 v209, v129, 0
    v_pk_max_i16 v210, v130, 0
    v_pk_max_i16 v211, v131, 0
    v_pk_max_i16 v212, v132, 0
    v_pk_max_i16 v213, v133, 0
    v_pk_max_i16 v216, v134, 0
    v_pk_max_i16 v217, v135, 0
    v_pk_max_i16 v218, v136, 0
    v_pk_max_i16 v219, v137, 0
    v_pk_max_i16 v220, v138, 0
    v_pk_max_i16 v221, v139, 0
    v_pk_max_i16 v222, v140, 0
    v_pk_max_i16 v223, v141, 0
    v_pk_max_i16 v224, v142, 0
    v_pk_max_i16 v225, v143, 0
    v_pk_max_i16 v226, v8, 0
    v_pk_max_i16 v227, v9, 0
    v_pk_max_i16 v228, v10, 0
    v_pk_max_i16 v229, v11, 0
    v_lshlrev_b32 v240, 3, v0
    v_add_u32 v240, s50, v240
    s_branch L_g1epi_done
L_g1epi_fh1:
    v_pk_fma_f32 v[160:161], v[60:61], v[84:85], v[160:161] op_sel_hi:[1,0,1]
    v_pk_fma_f32 v[162:163], v[62:63], v[84:85], v[162:163] op_sel_hi:[1,0,1]
    v_cvt_pk_bf16_f32 v92, v160, v161
    v_cvt_pk_bf16_f32 v93, v162, v163
    v_pk_fma_f32 v[176:177], v[64:65], v[84:85], v[176:177] op_sel_hi:[1,0,1]
    v_pk_fma_f32 v[178:179], v[66:67], v[84:85], v[178:179] op_sel_hi:[1,0,1]
    v_cvt_pk_bf16_f32 v94, v176, v177
    v_cvt_pk_bf16_f32 v95, v178, v179
    v_pk_max_i16 v92, v92, 0
    v_pk_max_i16 v93, v93, 0
    v_pk_max_i16 v94, v94, 0
    v_pk_max_i16 v95, v95, 0
    s_add_u32 s49, s48, 0
    buffer_store_dwordx4 v[92:95], v38, s[28:31], s49 offen offset:0 sc1
    v_pk_fma_f32 v[192:193], v[68:69], v[84:85], v[192:193] op_sel_hi:[1,0,1]
    v_pk_fma_f32 v[194:195], v[70:71], v[84:85], v[194:195] op_sel_hi:[1,0,1]
    v_cvt_pk_bf16_f32 v96, v192, v193
    v_cvt_pk_bf16_f32 v97, v194, v195
    v_pk_fma_f32 v[208:209], v[72:73], v[84:85], v[208:209] op_sel_hi:[1,0,1]
    v_pk_fma_f32 v[210:211], v[74:75], v[84:85], v[210:211] op_sel_hi:[1,0,1]
    v_cvt_pk_bf16_f32 v98, v208, v209
    v_cvt_pk_bf16_f32 v99, v210, v211
    v_pk_max_i16 v96, v96, 0
    v_pk_max_i16 v97, v97, 0
    v_pk_max_i16 v98, v98, 0
    v_pk_max_i16 v99, v99, 0
    buffer_store_dwordx4 v[96:99], v38, s[28:31], s49 offen offset:1024 sc1
    v_pk_fma_f32 v[224:225], v[76:77], v[84:85], v[224:225] op_sel_hi:[1,0,1]
    v_pk_fma_f32 v[226:227], v[78:79], v[84:85], v[226:227] op_sel_hi:[1,0,1]
    v_cvt_pk_bf16_f32 v100, v224, v225
    v_cvt_pk_bf16_f32 v101, v226, v227
    v_pk_fma_f32 v[240:241], v[80:81], v[84:85], v[240:241] op_sel_hi:[1,0,1]
    v_pk_fma_f32 v[242:243], v[82:83], v[84:85], v[242:243] op_sel_hi:[1,0,1]
    v_cvt_pk_bf16_f32 v102, v240, v241
    v_cvt_pk_bf16_f32 v103, v242, v243
    v_pk_max_i16 v100, v100, 0
    v_pk_max_i16 v101, v101, 0
    v_pk_max_i16 v102, v102, 0
    v_pk_max_i16 v103, v103, 0
    buffer_store_dwordx4 v[100:103], v38, s[28:31], s49 offen offset:2048 sc1
    v_pk_fma_f32 v[144:145], v[56:57], v[84:85], v[144:145] op_sel_hi:[1,0,1]
    v_pk_fma_f32 v[146:147], v[58:59], v[84:85], v[146:147] op_sel_hi:[1,0,1]
    v_cvt_pk_bf16_f32 v104, v144, v145
    v_cvt_pk_bf16_f32 v105, v146, v147
    v_pk_fma_f32 v[164:165], v[60:61], v[86:87], v[164:165] op_sel_hi:[1,0,1]
    v_pk_fma_f32 v[166:167], v[62:63], v[86:87], v[166:167] op_sel_hi:[1,0,1]
    v_cvt_pk_bf16_f32 v106, v164, v165
    v_cvt_pk_bf16_f32 v107, v166, v167
    v_pk_fma_f32 v[180:181], v[64:65], v[86:87], v[180:181] op_sel_hi:[1,0,1]
    v_pk_fma_f32 v[182:183], v[66:67], v[86:87], v[182:183] op_sel_hi:[1,0,1]
    v_cvt_pk_bf16_f32 v108, v180, v181
    v_cvt_pk_bf16_f32 v109, v182, v183
    v_pk_max_i16 v106, v106, 0
    v_pk_max_i16 v107, v107, 0
    v_pk_max_i16 v108, v108, 0
    v_pk_max_i16 v109, v109, 0
    s_add_u32 s49, s48, 114688
    buffer_store_dwordx4 v[106:109], v38, s[28:31], s49 offen offset:0 sc1
    v_pk_fma_f32 v[196:197], v[68:69], v[86:87], v[196:197] op_sel_hi:[1,0,1]
    v_pk_fma_f32 v[198:199], v[70:71], v[86:87], v[198:199] op_sel_hi:[1,0,1]
    v_cvt_pk_bf16_f32 v110, v196, v197
    v_cvt_pk_bf16_f32 v111, v198, v199
    v_pk_fma_f32 v[212:213], v[72:73], v[86:87], v[212:213] op_sel_hi:[1,0,1]
    v_pk_fma_f32 v[214:215], v[74:75], v[86:87], v[214:215] op_sel_hi:[1,0,1]
    v_cvt_pk_bf16_f32 v112, v212, v213
    v_cvt_pk_bf16_f32 v113, v214, v215
    v_pk_max_i16 v110, v110, 0
    v_pk_max_i16 v111, v111, 0
    v_pk_max_i16 v112, v112, 0
    v_pk_max_i16 v113, v113, 0
    buffer_store_dwordx4 v[110:113], v38, s[28:31], s49 offen offset:1024 sc1
    v_pk_fma_f32 v[228:229], v[76:77], v[86:87], v[228:229] op_sel_hi:[1,0,1]
    v_pk_fma_f32 v[230:231], v[78:79], v[86:87], v[230:231] op_sel_hi:[1,0,1]
    v_cvt_pk_bf16_f32 v114, v228, v229
    v_cvt_pk_bf16_f32 v115, v230, v231
    v_pk_fma_f32 v[244:245], v[80:81], v[86:87], v[244:245] op_sel_hi:[1,0,1]
    v_pk_fma_f32 v[246:247], v[82:83], v[86:87], v[246:247] op_sel_hi:[1,0,1]
    v_cvt_pk_bf16_f32 v116, v244, v245
    v_cvt_pk_bf16_f32 v117, v246, v247
    v_pk_max_i16 v114, v114, 0
    v_pk_max_i16 v115, v115, 0
    v_pk_max_i16 v116, v116, 0
    v_pk_max_i16 v117, v117, 0
    buffer_store_dwordx4 v[114:117], v38, s[28:31], s49 offen offset:2048 sc1
    v_pk_fma_f32 v[148:149], v[56:57], v[86:87], v[148:149] op_sel_hi:[1,0,1]
    v_pk_fma_f32 v[150:151], v[58:59], v[86:87], v[150:151] op_sel_hi:[1,0,1]
    v_cvt_pk_bf16_f32 v118, v148, v149
    v_cvt_pk_bf16_f32 v119, v150, v151
    v_pk_fma_f32 v[168:169], v[60:61], v[88:89], v[168:169] op_sel_hi:[1,0,1]
    v_pk_fma_f32 v[170:171], v[62:63], v[88:89], v[170:171] op_sel_hi:[1,0,1]
    v_cvt_pk_bf16_f32 v120, v168, v169
    v_cvt_pk_bf16_f32 v121, v170, v171
    v_pk_fma_f32 v[184:185], v[64:65], v[88:89], v[184:185] op_sel_hi:[1,0,1]
    v_pk_fma_f32 v[186:187], v[66:67], v[88:89], v[186:187] op_sel_hi:[1,0,1]
    v_cvt_pk_bf16_f32 v122, v184, v185
    v_cvt_pk_bf16_f32 v123, v186, v187
    v_pk_fma_f32 v[200:201], v[68:69], v[88:89], v[200:201] op_sel_hi:[1,0,1]
    v_pk_fma_f32 v[202:203], v[70:71], v[88:89], v[202:203] op_sel_hi:[1,0,1]
    v_cvt_pk_bf16_f32 v124, v200, v201
    v_cvt_pk_bf16_f32 v125, v202, v203
    v_pk_fma_f32 v[216:217], v[72:73], v[88:89], v[216:217] op_sel_hi:[1,0,1]
    v_pk_fma_f32 v[218:219], v[74:75], v[88:89], v[218:219] op_sel_hi:[1,0,1]
    v_cvt_pk_bf16_f32 v126, v216, v217
    v_cvt_pk_bf16_f32 v127, v218, v219
    v_pk_fma_f32 v[232:233], v[76:77], v[88:89], v[232:233] op_sel_hi:[1,0,1]
    v_pk_fma_f32 v[234:235], v[78:79], v[88:89], v[234:235] op_sel_hi:[1,0,1]
    v_cvt_pk_bf16_f32 v128, v232, v233
    v_cvt_pk_bf16_f32 v129, v234, v235
    v_pk_fma_f32 v[248:249], v[80:81], v[88:89], v[248:249] op_sel_hi:[1,0,1]
    v_pk_fma_f32 v[250:251], v[82:83], v[88:89], v[250:251] op_sel_hi:[1,0,1]
    v_cvt_pk_bf16_f32 v130, v248, v249
    v_cvt_pk_bf16_f32 v131, v250, v251
    v_pk_fma_f32 v[152:153], v[56:57], v[88:89], v[152:153] op_sel_hi:[1,0,1]
    v_pk_fma_f32 v[154:155], v[58:59], v[88:89], v[154:155] op_sel_hi:[1,0,1]
    v_cvt_pk_bf16_f32 v132, v152, v153
    v_cvt_pk_bf16_f32 v133, v154, v155
    v_pk_fma_f32 v[172:173], v[60:61], v[90:91], v[172:173] op_sel_hi:[1,0,1]
    v_pk_fma_f32 v[174:175], v[62:63], v[90:91], v[174:175] op_sel_hi:[1,0,1]
    v_cvt_pk_bf16_f32 v134, v172, v173
    v_cvt_pk_bf16_f32 v135, v174, v175
    v_pk_fma_f32 v[188:189], v[64:65], v[90:91], v[188:189] op_sel_hi:[1,0,1]
    v_pk_fma_f32 v[190:191], v[66:67], v[90:91], v[190:191] op_sel_hi:[1,0,1]
    v_cvt_pk_bf16_f32 v136, v188, v189
    v_cvt_pk_bf16_f32 v137, v190, v191
    v_pk_fma_f32 v[204:205], v[68:69], v[90:91], v[204:205] op_sel_hi:[1,0,1]
    v_pk_fma_f32 v[206:207], v[70:71], v[90:91], v[206:207] op_sel_hi:[1,0,1]
    v_cvt_pk_bf16_f32 v138, v204, v205
    v_cvt_pk_bf16_f32 v139, v206, v207
    v_pk_fma_f32 v[220:221], v[72:73], v[90:91], v[220:221] op_sel_hi:[1,0,1]
    v_pk_fma_f32 v[222:223], v[74:75], v[90:91], v[222:223] op_sel_hi:[1,0,1]
    v_cvt_pk_bf16_f32 v140, v220, v221
    v_cvt_pk_bf16_f32 v141, v222, v223
    v_pk_fma_f32 v[236:237], v[76:77], v[90:91], v[236:237] op_sel_hi:[1,0,1]
    v_pk_fma_f32 v[238:239], v[78:79], v[90:91], v[238:239] op_sel_hi:[1,0,1]
    v_cvt_pk_bf16_f32 v142, v236, v237
    v_cvt_pk_bf16_f32 v143, v238, v239
    v_pk_fma_f32 v[252:253], v[80:81], v[90:91], v[252:253] op_sel_hi:[1,0,1]
    v_pk_fma_f32 v[254:255], v[82:83], v[90:91], v[254:255] op_sel_hi:[1,0,1]
    v_cvt_pk_bf16_f32 v8, v252, v253
    v_cvt_pk_bf16_f32 v9, v254, v255
    v_pk_fma_f32 v[156:157], v[56:57], v[90:91], v[156:157] op_sel_hi:[1,0,1]
    v_pk_fma_f32 v[158:159], v[58:59], v[90:91], v[158:159] op_sel_hi:[1,0,1]
    v_cvt_pk_bf16_f32 v10, v156, v157
    v_cvt_pk_bf16_f32 v11, v158, v159
    v_pk_max_i16 v180, v104, 0
    v_pk_max_i16 v181, v105, 0
    v_pk_max_i16 v196, v118, 0
    v_pk_max_i16 v197, v119, 0
    v_pk_max_i16 v200, v120, 0
    v_pk_max_i16 v201, v121, 0
    v_pk_max_i16 v202, v122, 0
    v_pk_max_i16 v203, v123, 0
    v_pk_max_i16 v204, v124, 0
    v_pk_max_i16 v205, v125, 0
    v_pk_max_i16 v206, v126, 0
    v_pk_max_i16 v207, v127, 0
    v_pk_max_i16 v208, v128, 0
    v_pk_max_i16 v209, v129, 0
    v_pk_max_i16 v210, v130, 0
    v_pk_max_i16 v211, v131, 0
    v_pk_max_i16 v212, v132, 0
    v_pk_max_i16 v213, v133, 0
    v_pk_max_i16 v216, v134, 0
    v_pk_max_i16 v217, v135, 0
    v_pk_max_i16 v218, v136, 0
    v_pk_max_i16 v219, v137, 0
    v_pk_max_i16 v220, v138, 0
    v_pk_max_i16 v221, v139, 0
    v_pk_max_i16 v222, v140, 0
    v_pk_max_i16 v223, v141, 0
    v_pk_max_i16 v224, v142, 0
    v_pk_max_i16 v225, v143, 0
    v_pk_max_i16 v226, v8, 0
    v_pk_max_i16 v227, v9, 0
    v_pk_max_i16 v228, v10, 0
    v_pk_max_i16 v229, v11, 0
    v_lshlrev_b32 v240, 3, v0
    v_add_u32 v240, s50, v240
    ds_write_b64 v240, v[180:181] offset:0
    ds_write_b64 v240, v[196:197] offset:512
    ds_write_b64 v240, v[212:213] offset:1024
    ds_write_b64 v240, v[228:229] offset:1536
    s_waitcnt lgkmcnt(0)
L_g1epi_done:
    s_lshl_b32 s42, s2, 2
    s_add_u32 s42, s42, s3
    s_mov_b32 s44, s53
    s_mul_i32 s56, s3, 22848
    s_add_u32 s56, s56, 67264
    s_cmp_eq_u32 s3, 3
    s_cselect_b32 s56, 140992, s56
    v_and_b32 v2, 15, v0
    v_lshrrev_b32 v3, 4, v0
    v_and_b32 v4, 3, v2
    v_mul_u32_u24 v4, 4160, v4
    v_and_b32 v5, 12, v2
    v_lshlrev_b32 v5, 1, v5
    v_add_u32 v4, v4, v5
    v_lshlrev_b32 v5, 4, v3
    v_add_u32 v4, v4, v5
    v_add_u32 v56, s56, v4
    v_mul_u32_u24 v4, 96, v2
    v_sub_u32 v4, v5, v4
    s_add_u32 s57, s56, 18080
    v_add_u32 v57, s57, v4
    s_add_u32 s55, s56, 22784
    v_lshlrev_b32 v4, 3, v3
    v_add_u32 v4, v4, v2
    s_and_b32 s43, s42, 1
    s_lshl_b32 s43, s43, 4
    s_lshr_b32 s44, s44, s43
    s_and_b32 s44, s44, 0xffff
    s_lshl_b32 s43, s44, 16
    s_or_b32 s44, s44, s43
    v_sub_u32 v5, 31, v4
    v_cmp_eq_u32 vcc, 0, v5
    v_mov_b32 v7, 0xffff
    s_nop 0
    v_cndmask_b32 v6, 0, v7, vcc
    v_cmp_eq_u32 vcc, 1, v5
    v_mov_b32 v7, 0xffff0000
    s_nop 0
    v_cndmask_b32 v6, v6, v7, vcc
    v_and_b32 v232, s44, v6
    v_cmp_eq_u32 vcc, 2, v5
    v_mov_b32 v7, 0xffff
    s_nop 0
    v_cndmask_b32 v6, 0, v7, vcc
    v_cmp_eq_u32 vcc, 3, v5
    v_mov_b32 v7, 0xffff0000
    s_nop 0
    v_cndmask_b32 v6, v6, v7, vcc
    v_and_b32 v233, s44, v6
    v_cmp_eq_u32 vcc, 4, v5
    v_mov_b32 v7, 0xffff
    s_nop 0
    v_cndmask_b32 v6, 0, v7, vcc
    v_cmp_eq_u32 vcc, 5, v5
    v_mov_b32 v7, 0xffff0000
    s_nop 0
    v_cndmask_b32 v6, v6, v7, vcc
    v_and_b32 v234, s44, v6
    v_cmp_eq_u32 vcc, 6, v5
    v_mov_b32 v7, 0xffff
    s_nop 0
    v_cndmask_b32 v6, 0, v7, vcc
    v_cmp_eq_u32 vcc, 7, v5
    v_mov_b32 v7, 0xffff0000
    s_nop 0
    v_cndmask_b32 v6, v6, v7, vcc
    v_and_b32 v235, s44, v6
    v_sub_u32 v5, 15, v4
    v_cmp_eq_u32 vcc, 0, v5
    v_mov_b32 v7, 0xffff
    s_nop 0
    v_cndmask_b32 v6, 0, v7, vcc
    v_cmp_eq_u32 vcc, 1, v5
    v_mov_b32 v7, 0xffff0000
    s_nop 0
    v_cndmask_b32 v6, v6, v7, vcc
    v_and_b32 v236, s44, v6
    v_cmp_eq_u32 vcc, 2, v5
    v_mov_b32 v7, 0xffff
    s_nop 0
    v_cndmask_b32 v6, 0, v7, vcc
    v_cmp_eq_u32 vcc, 3, v5
    v_mov_b32 v7, 0xffff0000
    s_nop 0
    v_cndmask_b32 v6, v6, v7, vcc
    v_and_b32 v237, s44, v6
    v_cmp_eq_u32 vcc, 4, v5
    v_mov_b32 v7, 0xffff
    s_nop 0
    v_cndmask_b32 v6, 0, v7, vcc
    v_cmp_eq_u32 vcc, 5, v5
    v_mov_b32 v7, 0xffff0000
    s_nop 0
    v_cndmask_b32 v6, v6, v7, vcc
    v_and_b32 v238, s44, v6
    v_cmp_eq_u32 vcc, 6, v5
    v_mov_b32 v7, 0xffff
    s_nop 0
    v_cndmask_b32 v6, 0, v7, vcc
    v_cmp_eq_u32 vcc, 7, v5
    v_mov_b32 v7, 0xffff0000
    s_nop 0
    v_cndmask_b32 v6, v6, v7, vcc
    v_and_b32 v239, s44, v6
    v_and_b32 v2, 15, v0
    v_lshrrev_b32 v3, 4, v0
    s_lshl_b32 s42, s17, 7
    s_lshl_b32 s43, s40, 6
    s_add_u32 s42, s42, s43
    s_lshl_b32 s43, s16, 5
    s_add_u32 s42, s42, s43
    v_add_u32 v4, s42, v2
    v_lshlrev_b32 v5, 2, v4
    v_lshlrev_b32 v55, 4, v0
    s_lshl_b32 s44, s2, 14
    s_lshl_b32 s46, s3, 12
    s_add_u32 s44, s44, s46
    s_xor_b32 s47, s2, 4
    s_lshl_b32 s47, s47, 14
    s_add_u32 s47, s47, s46
    s_lshl_b32 s42, s40, 5
    v_add_u32 v11, s42, v2
    v_lshlrev_b32 v11, 8, v11
    v_add_u32 v11, 98304, v11
    v_and_b32 v12, 1, v3
    v_lshlrev_b32 v12, 3, v12
    v_add_u32 v11, v11, v12
    v_lshrrev_b32 v12, 1, v3
    s_lshl_b32 s42, s41, 3
    v_add_u32 v12, s42, v12
    v_add_u32 v13, 0, v12
    v_xor_b32 v13, v13, v2
    v_lshlrev_b32 v13, 4, v13
    v_add_u32 v48, v11, v13
    v_add_u32 v13, 2, v12
    v_xor_b32 v13, v13, v2
    v_lshlrev_b32 v13, 4, v13
    v_add_u32 v49, v11, v13
    v_add_u32 v13, 4, v12
    v_xor_b32 v13, v13, v2
    v_lshlrev_b32 v13, 4, v13
    v_add_u32 v50, v11, v13
    v_add_u32 v13, 6, v12
    v_xor_b32 v13, v13, v2
    v_lshlrev_b32 v13, 4, v13
    v_add_u32 v51, v11, v13
    v_lshrrev_b32 v11, 2, v2
    v_and_b32 v12, 3, v2
    v_lshlrev_b32 v13, 2, v3
    v_add_u32 v13, v13, v11
    v_lshrrev_b32 v14, 1, v13
    v_and_b32 v14, 3, v14
    v_lshlrev_b32 v14, 1, v14
    s_lshl_b32 s42, s41, 6
    v_add_u32 v13, s42, v13
    v_lshlrev_b32 v13, 7, v13
    v_add_u32 v13, 114688, v13
    v_and_b32 v15, 1, v12
    v_lshlrev_b32 v15, 3, v15
    v_add_u32 v13, v13, v15
    v_lshrrev_b32 v12, 1, v12
    s_lshl_b32 s42, s40, 2
    v_add_u32 v12, s42, v12
    v_add_u32 v15, 0, v12
    v_xor_b32 v15, v15, v14
    v_lshlrev_b32 v15, 4, v15
    v_add_u32 v52, v13, v15
    v_add_u32 v15, 2, v12
    v_xor_b32 v15, v15, v14
    v_lshlrev_b32 v15, 4, v15
    v_add_u32 v53, v13, v15
    v_and_b32 v11, 1, v3
    v_lshlrev_b32 v11, 5, v11
    v_lshrrev_b32 v12, 1, v3
    v_lshlrev_b32 v12, 4, v12
    v_add_u32 v11, v11, v12
    v_lshlrev_b32 v12, 11, v4
    v_add_u32 v11, v11, v12
    s_lshl_b32 s42, s18, 8
    s_lshl_b32 s43, s41, 7
    s_add_u32 s42, s42, s43
    v_add_u32 v54, s42, v11
    v_lshlrev_b32 v1, 4, v0
    s_lshl_b32 s42, s40, 13
    v_add_u32 v1, s42, v1
    s_lshl_b32 s42, s16, 12
    v_add_u32 v8, s42, v1
    s_xor_b32 s42, s42, 4096
    v_add_u32 v9, s42, v1
    v_and_b32 v2, 15, v0
    v_lshrrev_b32 v3, 4, v0
    v_lshrrev_b32 v6, 2, v2
    v_and_b32 v7, 3, v2
    v_lshlrev_b32 v1, 2, v3
    v_add_u32 v1, v1, v6
    v_and_b32 v4, 7, v1
    v_lshlrev_b32 v1, 8, v1
    v_add_u32 v1, 16384, v1
    v_lshlrev_b32 v7, 3, v7
    v_add_u32 v1, v1, v7
    s_lshl_b32 s42, s41, 2
    s_add_u32 s42, s42, 0
    v_xor_b32 v5, s42, v4
    v_lshlrev_b32 v5, 5, v5
    v_add_u32 v10, v1, v5
    s_lshl_b32 s42, s41, 2
    s_add_u32 s42, s42, 1
    v_xor_b32 v5, s42, v4
    v_lshlrev_b32 v5, 5, v5
    v_add_u32 v11, v1, v5
    s_lshl_b32 s42, s41, 2
    s_add_u32 s42, s42, 2
    v_xor_b32 v5, s42, v4
    v_lshlrev_b32 v5, 5, v5
    v_add_u32 v12, v1, v5
    s_lshl_b32 s42, s41, 2
    s_add_u32 s42, s42, 3
    v_xor_b32 v5, s42, v4
    v_lshlrev_b32 v5, 5, v5
    v_add_u32 v13, v1, v5
    v_add_u32 v14, 32768, v8
    v_add_u32 v15, 32768, v9
    v_add_u32 v16, 32768, v10
    v_add_u32 v17, 32768, v11
    v_add_u32 v18, 32768, v12
    v_add_u32 v19, 32768, v13
    v_add_u32 v20, 65536, v8
    v_add_u32 v21, 65536, v9
    v_add_u32 v22, 65536, v10
    v_add_u32 v23, 65536, v11
    v_add_u32 v24, 65536, v12
    v_add_u32 v25, 65536, v13
    v_add_u32 v26, 98304, v8
    v_add_u32 v27, 98304, v9
    v_add_u32 v28, 98304, v10
    v_add_u32 v29, 98304, v11
    v_add_u32 v30, 98304, v12
    v_add_u32 v31, 98304, v13
    v_add_u32 v32, 131072, v8
    v_add_u32 v33, 131072, v9
    v_add_u32 v34, 131072, v10
    v_add_u32 v35, 131072, v11
    v_add_u32 v36, 131072, v12
    v_add_u32 v37, 131072, v13
    s_add_u32 s32, s98, 0x2500000
    s_addc_u32 s33, s99, 0
    s_mov_b32 s34, 0x4000
    s_mov_b32 s35, 0x20000
    v_and_b32 v2, 15, v0
    v_lshrrev_b32 v3, 4, v0
    s_lshl_b32 s42, s17, 7
    s_lshl_b32 s43, s40, 6
    s_add_u32 s42, s42, s43
    s_lshl_b32 s43, s16, 5
    s_add_u32 s42, s42, s43
    v_add_u32 v4, s42, v2
    v_lshlrev_b32 v5, 2, v4
    v_add_u32 v6, 8192, v5
    buffer_load_dword v40, v5, s[32:35], 0 offen sc1
    buffer_load_dword v41, v5, s[32:35], 0 offen offset:64 sc1
    buffer_load_dword v42, v6, s[32:35], 0 offen sc1
    buffer_load_dword v44, v6, s[32:35], 0 offen offset:64 sc1
    s_add_u32 s20, s98, 0x800000
    s_addc_u32 s21, s99, 0
    s_mov_b32 s22, 0x400000
    s_mov_b32 s23, 0x20000
    s_barrier
    ds_read_b64 v[182:183], v240 offset:0
    ds_read_b64 v[198:199], v240 offset:512
    ds_read_b64 v[214:215], v240 offset:1024
    ds_read_b64 v[230:231], v240 offset:1536
    s_waitcnt lgkmcnt(0)
    ds_read_b64 v[64:65], v56 offset:0
    ds_read_b64 v[66:67], v56 offset:8
    ds_read_b64 v[68:69], v56 offset:32
    ds_read_b64 v[70:71], v56 offset:40
    ds_read_b128 v[124:127], v57 offset:0
    ds_read_b128 v[112:115], v57 offset:1536
    ds_read_b128 v[100:103], v57 offset:3072
    ds_read_b128 v[88:91], v57 offset:4608
    ds_read_b64 v[72:73], v56 offset:64
    ds_read_b64 v[74:75], v56 offset:72
    ds_read_b64 v[76:77], v56 offset:96
    ds_read_b64 v[78:79], v56 offset:104
    ds_read_b128 v[128:131], v57 offset:96
    ds_read_b128 v[116:119], v57 offset:1632
    ds_read_b128 v[104:107], v57 offset:3168
    v_add_u32 v58, 4704, v57
    v_min_u32 v58, s55, v58
    ds_read_b128 v[92:95], v58
    s_waitcnt lgkmcnt(8)
    v_mfma_f32_16x16x32_bf16 v[160:163], v[64:67], v[124:127], 0
    ds_read_b64 v[80:81], v56 offset:128
    v_mfma_f32_16x16x32_bf16 v[164:167], v[68:71], v[124:127], 0
    ds_read_b64 v[82:83], v56 offset:136
    v_mfma_f32_16x16x32_bf16 v[152:155], v[64:67], v[112:115], 0
    ds_read_b64 v[84:85], v56 offset:160
    v_mfma_f32_16x16x32_bf16 v[156:159], v[68:71], v[112:115], 0
    ds_read_b64 v[86:87], v56 offset:168
    v_mfma_f32_16x16x32_bf16 v[144:147], v[64:67], v[100:103], 0
    ds_read_b128 v[132:135], v57 offset:192
    v_mfma_f32_16x16x32_bf16 v[148:151], v[68:71], v[100:103], 0
    ds_read_b128 v[120:123], v57 offset:1728
    v_mfma_f32_16x16x32_bf16 v[136:139], v[64:67], v[88:91], 0
    ds_read_b128 v[108:111], v57 offset:3264
    v_mfma_f32_16x16x32_bf16 v[140:143], v[68:71], v[88:91], 0
    v_add_u32 v58, 4800, v57
    v_mfma_f32_16x16x32_bf16 v[160:163], v[232:235], v[124:127], v[160:163]
    v_min_u32 v58, s55, v58
    v_mfma_f32_16x16x32_bf16 v[164:167], v[236:239], v[124:127], v[164:167]
    ds_read_b128 v[96:99], v58
    v_mfma_f32_16x16x32_bf16 v[152:155], v[232:235], v[112:115], v[152:155]
    s_add_u32 s49, s48, 229376
    v_mfma_f32_16x16x32_bf16 v[156:159], v[236:239], v[112:115], v[156:159]
    buffer_store_dwordx4 v[200:203], v38, s[28:31], s49 offen offset:0 sc1
    v_mfma_f32_16x16x32_bf16 v[144:147], v[232:235], v[100:103], v[144:147]
    v_mfma_f32_16x16x32_bf16 v[148:151], v[236:239], v[100:103], v[148:151]
    v_mfma_f32_16x16x32_bf16 v[136:139], v[232:235], v[88:91], v[136:139]
    v_mfma_f32_16x16x32_bf16 v[140:143], v[236:239], v[88:91], v[140:143]
    s_waitcnt lgkmcnt(8)
    v_mfma_f32_16x16x32_bf16 v[160:163], v[72:75], v[128:131], v[160:163]
    ds_read_b64 v[64:65], v56 offset:192
    ds_read_b64 v[66:67], v56 offset:200
    v_mfma_f32_16x16x32_bf16 v[164:167], v[76:79], v[128:131], v[164:167]
    ds_read_b64 v[68:69], v56 offset:224
    ds_read_b64 v[70:71], v56 offset:232
    v_mfma_f32_16x16x32_bf16 v[152:155], v[72:75], v[116:119], v[152:155]
    ds_read_b128 v[124:127], v57 offset:288
    ds_read_b128 v[112:115], v57 offset:1824
    v_mfma_f32_16x16x32_bf16 v[156:159], v[76:79], v[116:119], v[156:159]
    ds_read_b128 v[100:103], v57 offset:3360
    v_mfma_f32_16x16x32_bf16 v[144:147], v[72:75], v[104:107], v[144:147]
    v_add_u32 v58, 4896, v57
    v_mfma_f32_16x16x32_bf16 v[148:151], v[76:79], v[104:107], v[148:151]
    v_min_u32 v58, s55, v58
    v_mfma_f32_16x16x32_bf16 v[136:139], v[72:75], v[92:95], v[136:139]
    ds_read_b128 v[88:91], v58
    v_mfma_f32_16x16x32_bf16 v[140:143], v[76:79], v[92:95], v[140:143]
    buffer_store_dwordx4 v[204:207], v38, s[28:31], s49 offen offset:1024 sc1
    s_waitcnt lgkmcnt(8)
    v_mfma_f32_16x16x32_bf16 v[160:163], v[80:83], v[132:135], v[160:163]
    ds_read_b64 v[72:73], v56 offset:256
    ds_read_b64 v[74:75], v56 offset:264
    v_mfma_f32_16x16x32_bf16 v[164:167], v[84:87], v[132:135], v[164:167]
    ds_read_b64 v[76:77], v56 offset:288
    ds_read_b64 v[78:79], v56 offset:296
    v_mfma_f32_16x16x32_bf16 v[152:155], v[80:83], v[120:123], v[152:155]
    ds_read_b128 v[128:131], v57 offset:384
    ds_read_b128 v[116:119], v57 offset:1920
    v_mfma_f32_16x16x32_bf16 v[156:159], v[84:87], v[120:123], v[156:159]
    ds_read_b128 v[104:107], v57 offset:3456
    v_mfma_f32_16x16x32_bf16 v[144:147], v[80:83], v[108:111], v[144:147]
    v_add_u32 v58, 4992, v57
    v_mfma_f32_16x16x32_bf16 v[148:151], v[84:87], v[108:111], v[148:151]
    v_min_u32 v58, s55, v58
    v_mfma_f32_16x16x32_bf16 v[136:139], v[80:83], v[96:99], v[136:139]
    ds_read_b128 v[92:95], v58
    v_mfma_f32_16x16x32_bf16 v[140:143], v[84:87], v[96:99], v[140:143]
    buffer_store_dwordx4 v[208:211], v38, s[28:31], s49 offen offset:2048 sc1
    s_waitcnt lgkmcnt(8)
    v_mfma_f32_16x16x32_bf16 v[160:163], v[64:67], v[124:127], v[160:163]
    ds_read_b64 v[80:81], v56 offset:320
    ds_read_b64 v[82:83], v56 offset:328
    v_mfma_f32_16x16x32_bf16 v[164:167], v[68:71], v[124:127], v[164:167]
    ds_read_b64 v[84:85], v56 offset:352
    ds_read_b64 v[86:87], v56 offset:360
    v_mfma_f32_16x16x32_bf16 v[152:155], v[64:67], v[112:115], v[152:155]
    ds_read_b128 v[132:135], v57 offset:480
    ds_read_b128 v[120:123], v57 offset:2016
    v_mfma_f32_16x16x32_bf16 v[156:159], v[68:71], v[112:115], v[156:159]
    ds_read_b128 v[108:111], v57 offset:3552
    v_add_u32 v58, 5088, v57
    v_mfma_f32_16x16x32_bf16 v[144:147], v[64:67], v[100:103], v[144:147]
    v_min_u32 v58, s55, v58
    v_mfma_f32_16x16x32_bf16 v[148:151], v[68:71], v[100:103], v[148:151]
    ds_read_b128 v[96:99], v58
    v_mfma_f32_16x16x32_bf16 v[136:139], v[64:67], v[88:91], v[136:139]
    s_add_u32 s49, s48, 344064
    v_mfma_f32_16x16x32_bf16 v[140:143], v[68:71], v[88:91], v[140:143]
    buffer_store_dwordx4 v[216:219], v38, s[28:31], s49 offen offset:0 sc1
    s_waitcnt lgkmcnt(8)
    v_mfma_f32_16x16x32_bf16 v[160:163], v[72:75], v[128:131], v[160:163]
    ds_read_b64 v[64:65], v56 offset:384
    ds_read_b64 v[66:67], v56 offset:392
    v_mfma_f32_16x16x32_bf16 v[164:167], v[76:79], v[128:131], v[164:167]
    ds_read_b64 v[68:69], v56 offset:416
    ds_read_b64 v[70:71], v56 offset:424
    v_mfma_f32_16x16x32_bf16 v[152:155], v[72:75], v[116:119], v[152:155]
    ds_read_b128 v[124:127], v57 offset:576
    ds_read_b128 v[112:115], v57 offset:2112
    v_mfma_f32_16x16x32_bf16 v[156:159], v[76:79], v[116:119], v[156:159]
    ds_read_b128 v[100:103], v57 offset:3648
    v_mfma_f32_16x16x32_bf16 v[144:147], v[72:75], v[104:107], v[144:147]
    v_add_u32 v58, 5184, v57
    v_mfma_f32_16x16x32_bf16 v[148:151], v[76:79], v[104:107], v[148:151]
    v_min_u32 v58, s55, v58
    v_mfma_f32_16x16x32_bf16 v[136:139], v[72:75], v[92:95], v[136:139]
    ds_read_b128 v[88:91], v58
    v_mfma_f32_16x16x32_bf16 v[140:143], v[76:79], v[92:95], v[140:143]
    buffer_store_dwordx4 v[220:223], v38, s[28:31], s49 offen offset:1024 sc1
    s_waitcnt lgkmcnt(8)
    v_mfma_f32_16x16x32_bf16 v[160:163], v[80:83], v[132:135], v[160:163]
    ds_read_b64 v[72:73], v56 offset:448
    ds_read_b64 v[74:75], v56 offset:456
    v_mfma_f32_16x16x32_bf16 v[164:167], v[84:87], v[132:135], v[164:167]
    ds_read_b64 v[76:77], v56 offset:480
    ds_read_b64 v[78:79], v56 offset:488
    v_mfma_f32_16x16x32_bf16 v[152:155], v[80:83], v[120:123], v[152:155]
    ds_read_b128 v[128:131], v57 offset:672
    ds_read_b128 v[116:119], v57 offset:2208
    v_mfma_f32_16x16x32_bf16 v[156:159], v[84:87], v[120:123], v[156:159]
    ds_read_b128 v[104:107], v57 offset:3744
    v_mfma_f32_16x16x32_bf16 v[144:147], v[80:83], v[108:111], v[144:147]
    v_add_u32 v58, 5280, v57
    v_mfma_f32_16x16x32_bf16 v[148:151], v[84:87], v[108:111], v[148:151]
    v_min_u32 v58, s55, v58
    v_mfma_f32_16x16x32_bf16 v[136:139], v[80:83], v[96:99], v[136:139]
    ds_read_b128 v[92:95], v58
    v_mfma_f32_16x16x32_bf16 v[140:143], v[84:87], v[96:99], v[140:143]
    buffer_store_dwordx4 v[224:227], v38, s[28:31], s49 offen offset:2048 sc1
    s_waitcnt lgkmcnt(8)
    v_mfma_f32_16x16x32_bf16 v[160:163], v[64:67], v[124:127], v[160:163]
    ds_read_b64 v[80:81], v56 offset:512
    ds_read_b64 v[82:83], v56 offset:520
    v_mfma_f32_16x16x32_bf16 v[164:167], v[68:71], v[124:127], v[164:167]
    ds_read_b64 v[84:85], v56 offset:544
    ds_read_b64 v[86:87], v56 offset:552
    v_mfma_f32_16x16x32_bf16 v[152:155], v[64:67], v[112:115], v[152:155]
    ds_read_b128 v[132:135], v57 offset:768
    ds_read_b128 v[120:123], v57 offset:2304
    v_mfma_f32_16x16x32_bf16 v[156:159], v[68:71], v[112:115], v[156:159]
    ds_read_b128 v[108:111], v57 offset:3840
    v_add_u32 v58, 5376, v57
    v_mfma_f32_16x16x32_bf16 v[144:147], v[64:67], v[100:103], v[144:147]
    v_min_u32 v58, s55, v58
    v_mfma_f32_16x16x32_bf16 v[148:151], v[68:71], v[100:103], v[148:151]
    ds_read_b128 v[96:99], v58
    v_mfma_f32_16x16x32_bf16 v[136:139], v[64:67], v[88:91], v[136:139]
    s_add_u32 s49, s51, 0
    v_mfma_f32_16x16x32_bf16 v[140:143], v[68:71], v[88:91], v[140:143]
    buffer_store_dwordx4 v[180:183], v39, s[28:31], s49 offen sc1
    s_waitcnt lgkmcnt(8)
    v_mfma_f32_16x16x32_bf16 v[160:163], v[72:75], v[128:131], v[160:163]
    ds_read_b64 v[64:65], v56 offset:576
    ds_read_b64 v[66:67], v56 offset:584
    v_mfma_f32_16x16x32_bf16 v[164:167], v[76:79], v[128:131], v[164:167]
    ds_read_b64 v[68:69], v56 offset:608
    ds_read_b64 v[70:71], v56 offset:616
    v_mfma_f32_16x16x32_bf16 v[152:155], v[72:75], v[116:119], v[152:155]
    ds_read_b128 v[124:127], v57 offset:864
    ds_read_b128 v[112:115], v57 offset:2400
    v_mfma_f32_16x16x32_bf16 v[156:159], v[76:79], v[116:119], v[156:159]
    ds_read_b128 v[100:103], v57 offset:3936
    v_add_u32 v58, 5472, v57
    v_mfma_f32_16x16x32_bf16 v[144:147], v[72:75], v[104:107], v[144:147]
    v_min_u32 v58, s55, v58
    v_mfma_f32_16x16x32_bf16 v[148:151], v[76:79], v[104:107], v[148:151]
    ds_read_b128 v[88:91], v58
    v_mfma_f32_16x16x32_bf16 v[136:139], v[72:75], v[92:95], v[136:139]
    s_add_u32 s49, s51, 114688
    v_mfma_f32_16x16x32_bf16 v[140:143], v[76:79], v[92:95], v[140:143]
    buffer_store_dwordx4 v[196:199], v39, s[28:31], s49 offen sc1
    s_waitcnt lgkmcnt(8)
    v_mfma_f32_16x16x32_bf16 v[160:163], v[80:83], v[132:135], v[160:163]
    ds_read_b64 v[72:73], v56 offset:640
    ds_read_b64 v[74:75], v56 offset:648
    v_mfma_f32_16x16x32_bf16 v[164:167], v[84:87], v[132:135], v[164:167]
    ds_read_b64 v[76:77], v56 offset:672
    ds_read_b64 v[78:79], v56 offset:680
    v_mfma_f32_16x16x32_bf16 v[152:155], v[80:83], v[120:123], v[152:155]
    ds_read_b128 v[128:131], v57 offset:960
    ds_read_b128 v[116:119], v57 offset:2496
    v_mfma_f32_16x16x32_bf16 v[156:159], v[84:87], v[120:123], v[156:159]
    ds_read_b128 v[104:107], v57 offset:4032
    v_add_u32 v58, 5568, v57
    v_mfma_f32_16x16x32_bf16 v[144:147], v[80:83], v[108:111], v[144:147]
    v_min_u32 v58, s55, v58
    v_mfma_f32_16x16x32_bf16 v[148:151], v[84:87], v[108:111], v[148:151]
    ds_read_b128 v[92:95], v58
    v_mfma_f32_16x16x32_bf16 v[136:139], v[80:83], v[96:99], v[136:139]
    s_add_u32 s49, s51, 229376
    v_mfma_f32_16x16x32_bf16 v[140:143], v[84:87], v[96:99], v[140:143]
    buffer_store_dwordx4 v[212:215], v39, s[28:31], s49 offen sc1
    s_waitcnt lgkmcnt(8)
    v_mfma_f32_16x16x32_bf16 v[160:163], v[64:67], v[124:127], v[160:163]
    ds_read_b64 v[80:81], v56 offset:704
    ds_read_b64 v[82:83], v56 offset:712
    v_mfma_f32_16x16x32_bf16 v[164:167], v[68:71], v[124:127], v[164:167]
    ds_read_b64 v[84:85], v56 offset:736
    ds_read_b64 v[86:87], v56 offset:744
    v_mfma_f32_16x16x32_bf16 v[152:155], v[64:67], v[112:115], v[152:155]
    ds_read_b128 v[132:135], v57 offset:1056
    ds_read_b128 v[120:123], v57 offset:2592
    v_mfma_f32_16x16x32_bf16 v[156:159], v[68:71], v[112:115], v[156:159]
    ds_read_b128 v[108:111], v57 offset:4128
    v_add_u32 v58, 5664, v57
    v_mfma_f32_16x16x32_bf16 v[144:147], v[64:67], v[100:103], v[144:147]
    v_min_u32 v58, s55, v58
    v_mfma_f32_16x16x32_bf16 v[148:151], v[68:71], v[100:103], v[148:151]
    ds_read_b128 v[96:99], v58
    v_mfma_f32_16x16x32_bf16 v[136:139], v[64:67], v[88:91], v[136:139]
    s_add_u32 s49, s51, 344064
    v_mfma_f32_16x16x32_bf16 v[140:143], v[68:71], v[88:91], v[140:143]
    buffer_store_dwordx4 v[228:231], v39, s[28:31], s49 offen sc1
    s_waitcnt lgkmcnt(8)
    v_mfma_f32_16x16x32_bf16 v[160:163], v[72:75], v[128:131], v[160:163]
    ds_read_b64 v[64:65], v56 offset:768
    ds_read_b64 v[66:67], v56 offset:776
    v_mfma_f32_16x16x32_bf16 v[164:167], v[76:79], v[128:131], v[164:167]
    ds_read_b64 v[68:69], v56 offset:800
    ds_read_b64 v[70:71], v56 offset:808
    v_mfma_f32_16x16x32_bf16 v[152:155], v[72:75], v[116:119], v[152:155]
    ds_read_b128 v[124:127], v57 offset:1152
    v_mfma_f32_16x16x32_bf16 v[156:159], v[76:79], v[116:119], v[156:159]
    ds_read_b128 v[112:115], v57 offset:2688
    v_mfma_f32_16x16x32_bf16 v[144:147], v[72:75], v[104:107], v[144:147]
    ds_read_b128 v[100:103], v57 offset:4224
    v_mfma_f32_16x16x32_bf16 v[148:151], v[76:79], v[104:107], v[148:151]
    v_add_u32 v58, 5760, v57
    v_mfma_f32_16x16x32_bf16 v[136:139], v[72:75], v[92:95], v[136:139]
    v_min_u32 v58, s55, v58
    v_mfma_f32_16x16x32_bf16 v[140:143], v[76:79], v[92:95], v[140:143]
    ds_read_b128 v[88:91], v58
    s_waitcnt lgkmcnt(8)
    v_mfma_f32_16x16x32_bf16 v[160:163], v[80:83], v[132:135], v[160:163]
    ds_read_b64 v[72:73], v56 offset:832
    ds_read_b64 v[74:75], v56 offset:840
    v_mfma_f32_16x16x32_bf16 v[164:167], v[84:87], v[132:135], v[164:167]
    ds_read_b64 v[76:77], v56 offset:864
    ds_read_b64 v[78:79], v56 offset:872
    v_mfma_f32_16x16x32_bf16 v[152:155], v[80:83], v[120:123], v[152:155]
    ds_read_b128 v[128:131], v57 offset:1248
    v_mfma_f32_16x16x32_bf16 v[156:159], v[84:87], v[120:123], v[156:159]
    ds_read_b128 v[116:119], v57 offset:2784
    v_mfma_f32_16x16x32_bf16 v[144:147], v[80:83], v[108:111], v[144:147]
    ds_read_b128 v[104:107], v57 offset:4320
    v_mfma_f32_16x16x32_bf16 v[148:151], v[84:87], v[108:111], v[148:151]
    v_add_u32 v58, 5856, v57
    v_mfma_f32_16x16x32_bf16 v[136:139], v[80:83], v[96:99], v[136:139]
    v_min_u32 v58, s55, v58
    v_mfma_f32_16x16x32_bf16 v[140:143], v[84:87], v[96:99], v[140:143]
    ds_read_b128 v[92:95], v58
    s_waitcnt lgkmcnt(8)
    v_mfma_f32_16x16x32_bf16 v[160:163], v[64:67], v[124:127], v[160:163]
    ds_read_b64 v[80:81], v56 offset:896
    ds_read_b64 v[82:83], v56 offset:904
    v_mfma_f32_16x16x32_bf16 v[164:167], v[68:71], v[124:127], v[164:167]
    ds_read_b64 v[84:85], v56 offset:928
    ds_read_b64 v[86:87], v56 offset:936
    v_mfma_f32_16x16x32_bf16 v[152:155], v[64:67], v[112:115], v[152:155]
    ds_read_b128 v[132:135], v57 offset:1344
    v_mfma_f32_16x16x32_bf16 v[156:159], v[68:71], v[112:115], v[156:159]
    ds_read_b128 v[120:123], v57 offset:2880
    v_mfma_f32_16x16x32_bf16 v[144:147], v[64:67], v[100:103], v[144:147]
    ds_read_b128 v[108:111], v57 offset:4416
    v_mfma_f32_16x16x32_bf16 v[148:151], v[68:71], v[100:103], v[148:151]
    v_add_u32 v58, 5952, v57
    v_mfma_f32_16x16x32_bf16 v[136:139], v[64:67], v[88:91], v[136:139]
    v_min_u32 v58, s55, v58
    v_mfma_f32_16x16x32_bf16 v[140:143], v[68:71], v[88:91], v[140:143]
    ds_read_b128 v[96:99], v58
    s_waitcnt lgkmcnt(8)
    v_mfma_f32_16x16x32_bf16 v[160:163], v[72:75], v[128:131], v[160:163]
    ds_read_b64 v[64:65], v56 offset:960
    ds_read_b64 v[66:67], v56 offset:968
    v_mfma_f32_16x16x32_bf16 v[164:167], v[76:79], v[128:131], v[164:167]
    ds_read_b64 v[68:69], v56 offset:992
    ds_read_b64 v[70:71], v56 offset:1000
    v_mfma_f32_16x16x32_bf16 v[152:155], v[72:75], v[116:119], v[152:155]
    ds_read_b128 v[124:127], v57 offset:1440
    v_mfma_f32_16x16x32_bf16 v[156:159], v[76:79], v[116:119], v[156:159]
    ds_read_b128 v[112:115], v57 offset:2976
    v_mfma_f32_16x16x32_bf16 v[144:147], v[72:75], v[104:107], v[144:147]
    ds_read_b128 v[100:103], v57 offset:4512
    v_mfma_f32_16x16x32_bf16 v[148:151], v[76:79], v[104:107], v[148:151]
    v_add_u32 v58, 6048, v57
    v_mfma_f32_16x16x32_bf16 v[136:139], v[72:75], v[92:95], v[136:139]
    v_min_u32 v58, s55, v58
    v_mfma_f32_16x16x32_bf16 v[140:143], v[76:79], v[92:95], v[140:143]
    ds_read_b128 v[88:91], v58
    s_waitcnt lgkmcnt(8)
    v_mfma_f32_16x16x32_bf16 v[160:163], v[80:83], v[132:135], v[160:163]
    ds_read_b64 v[72:73], v56 offset:1024
    v_mfma_f32_16x16x32_bf16 v[164:167], v[84:87], v[132:135], v[164:167]
    ds_read_b64 v[74:75], v56 offset:1032
    v_mfma_f32_16x16x32_bf16 v[152:155], v[80:83], v[120:123], v[152:155]
    ds_read_b64 v[76:77], v56 offset:1056
    v_mfma_f32_16x16x32_bf16 v[156:159], v[84:87], v[120:123], v[156:159]
    ds_read_b64 v[78:79], v56 offset:1064
    v_mfma_f32_16x16x32_bf16 v[144:147], v[80:83], v[108:111], v[144:147]
    ds_read_b128 v[128:131], v57 offset:1536
    v_mfma_f32_16x16x32_bf16 v[148:151], v[84:87], v[108:111], v[148:151]
    ds_read_b128 v[116:119], v57 offset:3072
    v_mfma_f32_16x16x32_bf16 v[136:139], v[80:83], v[96:99], v[136:139]
    ds_read_b128 v[104:107], v57 offset:4608
    v_mfma_f32_16x16x32_bf16 v[140:143], v[84:87], v[96:99], v[140:143]
    s_waitcnt lgkmcnt(7)
    v_mfma_f32_16x16x32_bf16 v[160:163], v[64:67], v[124:127], v[160:163]
    ds_read_b64 v[80:81], v56 offset:1088
    ds_read_b64 v[82:83], v56 offset:1096
    v_mfma_f32_16x16x32_bf16 v[164:167], v[68:71], v[124:127], v[164:167]
    ds_read_b64 v[84:85], v56 offset:1120
    v_mfma_f32_16x16x32_bf16 v[152:155], v[64:67], v[112:115], v[152:155]
    ds_read_b64 v[86:87], v56 offset:1128
    v_mfma_f32_16x16x32_bf16 v[156:159], v[68:71], v[112:115], v[156:159]
    ds_read_b128 v[132:135], v57 offset:1632
    v_mfma_f32_16x16x32_bf16 v[144:147], v[64:67], v[100:103], v[144:147]
    ds_read_b128 v[120:123], v57 offset:3168
    v_mfma_f32_16x16x32_bf16 v[148:151], v[68:71], v[100:103], v[148:151]
    v_add_u32 v58, 4704, v57
    v_mfma_f32_16x16x32_bf16 v[136:139], v[64:67], v[88:91], v[136:139]
    v_min_u32 v58, s55, v58
    v_mfma_f32_16x16x32_bf16 v[140:143], v[68:71], v[88:91], v[140:143]
    ds_read_b128 v[108:111], v58
    s_lshl_b32 s58, s14, 4
    s_add_u32 s58, s58, s15
    s_lshl_b32 s58, s58, 2
    s_add_u32 s58, s58, s3
    s_lshl_b32 s58, s58, 2
    s_add_u32 s58, s58, 12288
    v_mov_b32 v62, s58
    v_mov_b32 v63, 1
    s_waitcnt lgkmcnt(7)
    v_mfma_f32_16x16x32_bf16 v[160:163], v[72:75], v[128:131], v[160:163]
    ds_read_b64 v[64:65], v56 offset:1152
    ds_read_b64 v[66:67], v56 offset:1160
    v_mfma_f32_16x16x32_bf16 v[164:167], v[76:79], v[128:131], v[164:167]
    ds_read_b64 v[68:69], v56 offset:1184
    ds_read_b64 v[70:71], v56 offset:1192
    v_mfma_f32_16x16x32_bf16 v[152:155], v[72:75], v[116:119], v[152:155]
    ds_read_b128 v[124:127], v57 offset:1728
    ds_read_b128 v[112:115], v57 offset:3264
    v_mfma_f32_16x16x32_bf16 v[156:159], v[76:79], v[116:119], v[156:159]
    v_add_u32 v58, 4800, v57
    v_min_u32 v58, s55, v58
    v_mfma_f32_16x16x32_bf16 v[144:147], v[72:75], v[104:107], v[144:147]
    ds_read_b128 v[100:103], v58
    s_waitcnt vmcnt(0)
    v_mfma_f32_16x16x32_bf16 v[148:151], v[76:79], v[104:107], v[148:151]
    buffer_store_dword v63, v62, s[24:27], 0 offen sc1
    s_waitcnt lgkmcnt(7)
    v_mfma_f32_16x16x32_bf16 v[160:163], v[80:83], v[132:135], v[160:163]
    ds_read_b64 v[72:73], v56 offset:1216
    ds_read_b64 v[74:75], v56 offset:1224
    v_mfma_f32_16x16x32_bf16 v[164:167], v[84:87], v[132:135], v[164:167]
    ds_read_b64 v[76:77], v56 offset:1248
    ds_read_b64 v[78:79], v56 offset:1256
    v_mfma_f32_16x16x32_bf16 v[152:155], v[80:83], v[120:123], v[152:155]
    ds_read_b128 v[128:131], v57 offset:1824
    ds_read_b128 v[116:119], v57 offset:3360
    v_mfma_f32_16x16x32_bf16 v[156:159], v[84:87], v[120:123], v[156:159]
    v_add_u32 v58, 4896, v57
    v_mfma_f32_16x16x32_bf16 v[144:147], v[80:83], v[108:111], v[144:147]
    v_min_u32 v58, s55, v58
    v_mfma_f32_16x16x32_bf16 v[148:151], v[84:87], v[108:111], v[148:151]
    ds_read_b128 v[104:107], v58
    s_waitcnt lgkmcnt(7)
    v_mfma_f32_16x16x32_bf16 v[160:163], v[64:67], v[124:127], v[160:163]
    ds_read_b64 v[80:81], v56 offset:1280
    ds_read_b64 v[82:83], v56 offset:1288
    v_mfma_f32_16x16x32_bf16 v[164:167], v[68:71], v[124:127], v[164:167]
    ds_read_b64 v[84:85], v56 offset:1312
    ds_read_b64 v[86:87], v56 offset:1320
    v_mfma_f32_16x16x32_bf16 v[152:155], v[64:67], v[112:115], v[152:155]
    ds_read_b128 v[132:135], v57 offset:1920
    ds_read_b128 v[120:123], v57 offset:3456
    v_mfma_f32_16x16x32_bf16 v[156:159], v[68:71], v[112:115], v[156:159]
    v_add_u32 v58, 4992, v57
    v_mfma_f32_16x16x32_bf16 v[144:147], v[64:67], v[100:103], v[144:147]
    v_min_u32 v58, s55, v58
    v_mfma_f32_16x16x32_bf16 v[148:151], v[68:71], v[100:103], v[148:151]
    ds_read_b128 v[108:111], v58
    s_waitcnt lgkmcnt(7)
    v_mfma_f32_16x16x32_bf16 v[160:163], v[72:75], v[128:131], v[160:163]
    ds_read_b64 v[64:65], v56 offset:1344
    ds_read_b64 v[66:67], v56 offset:1352
    v_mfma_f32_16x16x32_bf16 v[164:167], v[76:79], v[128:131], v[164:167]
    ds_read_b64 v[68:69], v56 offset:1376
    ds_read_b64 v[70:71], v56 offset:1384
    v_mfma_f32_16x16x32_bf16 v[152:155], v[72:75], v[116:119], v[152:155]
    ds_read_b128 v[124:127], v57 offset:2016
    ds_read_b128 v[112:115], v57 offset:3552
    v_mfma_f32_16x16x32_bf16 v[156:159], v[76:79], v[116:119], v[156:159]
    v_add_u32 v58, 5088, v57
    v_min_u32 v58, s55, v58
    v_mfma_f32_16x16x32_bf16 v[144:147], v[72:75], v[104:107], v[144:147]
    ds_read_b128 v[100:103], v58
    v_mfma_f32_16x16x32_bf16 v[148:151], v[76:79], v[104:107], v[148:151]
    s_barrier
    s_waitcnt lgkmcnt(7)
    v_mfma_f32_16x16x32_bf16 v[160:163], v[80:83], v[132:135], v[160:163]
    ds_read_b64 v[72:73], v56 offset:1408
    ds_read_b64 v[74:75], v56 offset:1416
    v_mfma_f32_16x16x32_bf16 v[164:167], v[84:87], v[132:135], v[164:167]
    ds_read_b64 v[76:77], v56 offset:1440
    ds_read_b64 v[78:79], v56 offset:1448
    v_mfma_f32_16x16x32_bf16 v[152:155], v[80:83], v[120:123], v[152:155]
    ds_read_b128 v[128:131], v57 offset:2112
    ds_read_b128 v[116:119], v57 offset:3648
    v_mfma_f32_16x16x32_bf16 v[156:159], v[84:87], v[120:123], v[156:159]
    v_add_u32 v58, 5184, v57
    v_mfma_f32_16x16x32_bf16 v[144:147], v[80:83], v[108:111], v[144:147]
    v_min_u32 v58, s55, v58
    v_mfma_f32_16x16x32_bf16 v[148:151], v[84:87], v[108:111], v[148:151]
    ds_read_b128 v[104:107], v58
    s_waitcnt lgkmcnt(7)
    v_mfma_f32_16x16x32_bf16 v[160:163], v[64:67], v[124:127], v[160:163]
    ds_read_b64 v[80:81], v56 offset:1472
    ds_read_b64 v[82:83], v56 offset:1480
    v_mfma_f32_16x16x32_bf16 v[164:167], v[68:71], v[124:127], v[164:167]
    ds_read_b64 v[84:85], v56 offset:1504
    ds_read_b64 v[86:87], v56 offset:1512
    v_mfma_f32_16x16x32_bf16 v[152:155], v[64:67], v[112:115], v[152:155]
    ds_read_b128 v[132:135], v57 offset:2208
    ds_read_b128 v[120:123], v57 offset:3744
    v_mfma_f32_16x16x32_bf16 v[156:159], v[68:71], v[112:115], v[156:159]
    v_add_u32 v58, 5280, v57
    v_mfma_f32_16x16x32_bf16 v[144:147], v[64:67], v[100:103], v[144:147]
    v_min_u32 v58, s55, v58
    v_mfma_f32_16x16x32_bf16 v[148:151], v[68:71], v[100:103], v[148:151]
    ds_read_b128 v[108:111], v58
    s_waitcnt lgkmcnt(7)
    v_mfma_f32_16x16x32_bf16 v[160:163], v[72:75], v[128:131], v[160:163]
    ds_read_b64 v[64:65], v56 offset:1536
    ds_read_b64 v[66:67], v56 offset:1544
    v_mfma_f32_16x16x32_bf16 v[164:167], v[76:79], v[128:131], v[164:167]
    ds_read_b64 v[68:69], v56 offset:1568
    ds_read_b64 v[70:71], v56 offset:1576
    v_mfma_f32_16x16x32_bf16 v[152:155], v[72:75], v[116:119], v[152:155]
    ds_read_b128 v[124:127], v57 offset:2304
    ds_read_b128 v[112:115], v57 offset:3840
    v_mfma_f32_16x16x32_bf16 v[156:159], v[76:79], v[116:119], v[156:159]
    v_add_u32 v58, 5376, v57
    v_mfma_f32_16x16x32_bf16 v[144:147], v[72:75], v[104:107], v[144:147]
    v_min_u32 v58, s55, v58
    v_mfma_f32_16x16x32_bf16 v[148:151], v[76:79], v[104:107], v[148:151]
    ds_read_b128 v[100:103], v58
    s_waitcnt lgkmcnt(7)
    v_mfma_f32_16x16x32_bf16 v[160:163], v[80:83], v[132:135], v[160:163]
    ds_read_b64 v[72:73], v56 offset:1600
    ds_read_b64 v[74:75], v56 offset:1608
    v_mfma_f32_16x16x32_bf16 v[164:167], v[84:87], v[132:135], v[164:167]
    ds_read_b64 v[76:77], v56 offset:1632
    ds_read_b64 v[78:79], v56 offset:1640
    v_mfma_f32_16x16x32_bf16 v[152:155], v[80:83], v[120:123], v[152:155]
    ds_read_b128 v[128:131], v57 offset:2400
    ds_read_b128 v[116:119], v57 offset:3936
    v_mfma_f32_16x16x32_bf16 v[156:159], v[84:87], v[120:123], v[156:159]
    v_add_u32 v58, 5472, v57
    v_mfma_f32_16x16x32_bf16 v[144:147], v[80:83], v[108:111], v[144:147]
    v_min_u32 v58, s55, v58
    v_mfma_f32_16x16x32_bf16 v[148:151], v[84:87], v[108:111], v[148:151]
    ds_read_b128 v[104:107], v58
    s_waitcnt lgkmcnt(7)
    v_mfma_f32_16x16x32_bf16 v[160:163], v[64:67], v[124:127], v[160:163]
    ds_read_b64 v[80:81], v56 offset:1664
    ds_read_b64 v[82:83], v56 offset:1672
    v_mfma_f32_16x16x32_bf16 v[164:167], v[68:71], v[124:127], v[164:167]
    ds_read_b64 v[84:85], v56 offset:1696
    ds_read_b64 v[86:87], v56 offset:1704
    v_mfma_f32_16x16x32_bf16 v[152:155], v[64:67], v[112:115], v[152:155]
    ds_read_b128 v[132:135], v57 offset:2496
    ds_read_b128 v[120:123], v57 offset:4032
    v_mfma_f32_16x16x32_bf16 v[156:159], v[68:71], v[112:115], v[156:159]
    v_add_u32 v58, 5568, v57
    v_mfma_f32_16x16x32_bf16 v[144:147], v[64:67], v[100:103], v[144:147]
    v_min_u32 v58, s55, v58
    v_mfma_f32_16x16x32_bf16 v[148:151], v[68:71], v[100:103], v[148:151]
    ds_read_b128 v[108:111], v58
    s_waitcnt lgkmcnt(7)
    v_mfma_f32_16x16x32_bf16 v[160:163], v[72:75], v[128:131], v[160:163]
    ds_read_b64 v[64:65], v56 offset:1728
    ds_read_b64 v[66:67], v56 offset:1736
    v_mfma_f32_16x16x32_bf16 v[164:167], v[76:79], v[128:131], v[164:167]
    ds_read_b64 v[68:69], v56 offset:1760
    ds_read_b64 v[70:71], v56 offset:1768
    v_mfma_f32_16x16x32_bf16 v[152:155], v[72:75], v[116:119], v[152:155]
    ds_read_b128 v[124:127], v57 offset:2592
    ds_read_b128 v[112:115], v57 offset:4128
    v_mfma_f32_16x16x32_bf16 v[156:159], v[76:79], v[116:119], v[156:159]
    v_add_u32 v58, 5664, v57
    v_mfma_f32_16x16x32_bf16 v[144:147], v[72:75], v[104:107], v[144:147]
    v_min_u32 v58, s55, v58
    v_mfma_f32_16x16x32_bf16 v[148:151], v[76:79], v[104:107], v[148:151]
    ds_read_b128 v[100:103], v58
    s_waitcnt lgkmcnt(7)
    v_mfma_f32_16x16x32_bf16 v[160:163], v[80:83], v[132:135], v[160:163]
    ds_read_b64 v[72:73], v56 offset:1792
    ds_read_b64 v[74:75], v56 offset:1800
    v_mfma_f32_16x16x32_bf16 v[164:167], v[84:87], v[132:135], v[164:167]
    ds_read_b64 v[76:77], v56 offset:1824
    ds_read_b64 v[78:79], v56 offset:1832
    v_mfma_f32_16x16x32_bf16 v[152:155], v[80:83], v[120:123], v[152:155]
    ds_read_b128 v[128:131], v57 offset:2688
    ds_read_b128 v[116:119], v57 offset:4224
    v_mfma_f32_16x16x32_bf16 v[156:159], v[84:87], v[120:123], v[156:159]
    v_add_u32 v58, 5760, v57
    v_mfma_f32_16x16x32_bf16 v[144:147], v[80:83], v[108:111], v[144:147]
    v_min_u32 v58, s55, v58
    v_mfma_f32_16x16x32_bf16 v[148:151], v[84:87], v[108:111], v[148:151]
    ds_read_b128 v[104:107], v58
    s_waitcnt lgkmcnt(7)
    v_mfma_f32_16x16x32_bf16 v[160:163], v[64:67], v[124:127], v[160:163]
    ds_read_b64 v[80:81], v56 offset:1856
    ds_read_b64 v[82:83], v56 offset:1864
    v_mfma_f32_16x16x32_bf16 v[164:167], v[68:71], v[124:127], v[164:167]
    ds_read_b64 v[84:85], v56 offset:1888
    ds_read_b64 v[86:87], v56 offset:1896
    v_mfma_f32_16x16x32_bf16 v[152:155], v[64:67], v[112:115], v[152:155]
    ds_read_b128 v[132:135], v57 offset:2784
    ds_read_b128 v[120:123], v57 offset:4320
    v_mfma_f32_16x16x32_bf16 v[156:159], v[68:71], v[112:115], v[156:159]
    v_add_u32 v58, 5856, v57
    v_mfma_f32_16x16x32_bf16 v[144:147], v[64:67], v[100:103], v[144:147]
    v_min_u32 v58, s55, v58
    v_mfma_f32_16x16x32_bf16 v[148:151], v[68:71], v[100:103], v[148:151]
    ds_read_b128 v[108:111], v58
    s_waitcnt lgkmcnt(7)
    v_mfma_f32_16x16x32_bf16 v[160:163], v[72:75], v[128:131], v[160:163]
    ds_read_b64 v[64:65], v56 offset:1920
    ds_read_b64 v[66:67], v56 offset:1928
    v_mfma_f32_16x16x32_bf16 v[164:167], v[76:79], v[128:131], v[164:167]
    ds_read_b64 v[68:69], v56 offset:1952
    ds_read_b64 v[70:71], v56 offset:1960
    v_mfma_f32_16x16x32_bf16 v[152:155], v[72:75], v[116:119], v[152:155]
    ds_read_b128 v[124:127], v57 offset:2880
    ds_read_b128 v[112:115], v57 offset:4416
    v_mfma_f32_16x16x32_bf16 v[156:159], v[76:79], v[116:119], v[156:159]
    v_add_u32 v58, 5952, v57
    v_mfma_f32_16x16x32_bf16 v[144:147], v[72:75], v[104:107], v[144:147]
    v_min_u32 v58, s55, v58
    v_mfma_f32_16x16x32_bf16 v[148:151], v[76:79], v[104:107], v[148:151]
    ds_read_b128 v[100:103], v58
    s_waitcnt lgkmcnt(7)
    v_mfma_f32_16x16x32_bf16 v[160:163], v[80:83], v[132:135], v[160:163]
    ds_read_b64 v[72:73], v56 offset:1984
    ds_read_b64 v[74:75], v56 offset:1992
    v_mfma_f32_16x16x32_bf16 v[164:167], v[84:87], v[132:135], v[164:167]
    ds_read_b64 v[76:77], v56 offset:2016
    ds_read_b64 v[78:79], v56 offset:2024
    v_mfma_f32_16x16x32_bf16 v[152:155], v[80:83], v[120:123], v[152:155]
    ds_read_b128 v[128:131], v57 offset:2976
    ds_read_b128 v[116:119], v57 offset:4512
    v_mfma_f32_16x16x32_bf16 v[156:159], v[84:87], v[120:123], v[156:159]
    v_add_u32 v58, 6048, v57
    v_mfma_f32_16x16x32_bf16 v[144:147], v[80:83], v[108:111], v[144:147]
    v_min_u32 v58, s55, v58
    v_mfma_f32_16x16x32_bf16 v[148:151], v[84:87], v[108:111], v[148:151]
    ds_read_b128 v[104:107], v58
    s_waitcnt lgkmcnt(7)
    v_mfma_f32_16x16x32_bf16 v[160:163], v[64:67], v[124:127], v[160:163]
    ds_read_b64 v[80:81], v56 offset:2048
    v_mfma_f32_16x16x32_bf16 v[164:167], v[68:71], v[124:127], v[164:167]
    ds_read_b64 v[82:83], v56 offset:2056
    v_mfma_f32_16x16x32_bf16 v[152:155], v[64:67], v[112:115], v[152:155]
    ds_read_b64 v[84:85], v56 offset:2080
    v_mfma_f32_16x16x32_bf16 v[156:159], v[68:71], v[112:115], v[156:159]
    ds_read_b64 v[86:87], v56 offset:2088
    v_mfma_f32_16x16x32_bf16 v[144:147], v[64:67], v[100:103], v[144:147]
    ds_read_b128 v[132:135], v57 offset:3072
    v_mfma_f32_16x16x32_bf16 v[148:151], v[68:71], v[100:103], v[148:151]
    ds_read_b128 v[120:123], v57 offset:4608
    s_waitcnt lgkmcnt(6)
    v_mfma_f32_16x16x32_bf16 v[160:163], v[72:75], v[128:131], v[160:163]
    ds_read_b64 v[64:65], v56 offset:2112
    ds_read_b64 v[66:67], v56 offset:2120
    v_mfma_f32_16x16x32_bf16 v[164:167], v[76:79], v[128:131], v[164:167]
    ds_read_b64 v[68:69], v56 offset:2144
    ds_read_b64 v[70:71], v56 offset:2152
    v_mfma_f32_16x16x32_bf16 v[152:155], v[72:75], v[116:119], v[152:155]
    ds_read_b128 v[124:127], v57 offset:3168
    v_mfma_f32_16x16x32_bf16 v[156:159], v[76:79], v[116:119], v[156:159]
    v_add_u32 v58, 4704, v57
    v_mfma_f32_16x16x32_bf16 v[144:147], v[72:75], v[104:107], v[144:147]
    v_min_u32 v58, s55, v58
    v_mfma_f32_16x16x32_bf16 v[148:151], v[76:79], v[104:107], v[148:151]
    ds_read_b128 v[112:115], v58
    s_waitcnt lgkmcnt(6)
    v_mfma_f32_16x16x32_bf16 v[160:163], v[80:83], v[132:135], v[160:163]
    ds_read_b64 v[72:73], v56 offset:2176
    ds_read_b64 v[74:75], v56 offset:2184
    v_mfma_f32_16x16x32_bf16 v[164:167], v[84:87], v[132:135], v[164:167]
    ds_read_b64 v[76:77], v56 offset:2208
    ds_read_b64 v[78:79], v56 offset:2216
    v_mfma_f32_16x16x32_bf16 v[152:155], v[80:83], v[120:123], v[152:155]
    ds_read_b128 v[128:131], v57 offset:3264
    v_add_u32 v58, 4800, v57
    v_mfma_f32_16x16x32_bf16 v[156:159], v[84:87], v[120:123], v[156:159]
    v_min_u32 v58, s55, v58
    ds_read_b128 v[116:119], v58
    s_waitcnt lgkmcnt(6)
    v_mfma_f32_16x16x32_bf16 v[160:163], v[64:67], v[124:127], v[160:163]
    ds_read_b64 v[80:81], v56 offset:2240
    ds_read_b64 v[82:83], v56 offset:2248
    v_mfma_f32_16x16x32_bf16 v[164:167], v[68:71], v[124:127], v[164:167]
    ds_read_b64 v[84:85], v56 offset:2272
    ds_read_b64 v[86:87], v56 offset:2280
    v_mfma_f32_16x16x32_bf16 v[152:155], v[64:67], v[112:115], v[152:155]
    ds_read_b128 v[132:135], v57 offset:3360
    v_add_u32 v58, 4896, v57
    v_mfma_f32_16x16x32_bf16 v[156:159], v[68:71], v[112:115], v[156:159]
    v_min_u32 v58, s55, v58
    ds_read_b128 v[120:123], v58
    s_waitcnt lgkmcnt(6)
    v_mfma_f32_16x16x32_bf16 v[160:163], v[72:75], v[128:131], v[160:163]
    ds_read_b64 v[64:65], v56 offset:2304
    ds_read_b64 v[66:67], v56 offset:2312
    v_mfma_f32_16x16x32_bf16 v[164:167], v[76:79], v[128:131], v[164:167]
    ds_read_b64 v[68:69], v56 offset:2336
    ds_read_b64 v[70:71], v56 offset:2344
    v_mfma_f32_16x16x32_bf16 v[152:155], v[72:75], v[116:119], v[152:155]
    ds_read_b128 v[124:127], v57 offset:3456
    v_add_u32 v58, 4992, v57
    v_mfma_f32_16x16x32_bf16 v[156:159], v[76:79], v[116:119], v[156:159]
    v_min_u32 v58, s55, v58
    ds_read_b128 v[112:115], v58
    s_waitcnt lgkmcnt(6)
    v_mfma_f32_16x16x32_bf16 v[160:163], v[80:83], v[132:135], v[160:163]
    ds_read_b64 v[72:73], v56 offset:2368
    ds_read_b64 v[74:75], v56 offset:2376
    v_mfma_f32_16x16x32_bf16 v[164:167], v[84:87], v[132:135], v[164:167]
    ds_read_b64 v[76:77], v56 offset:2400
    ds_read_b64 v[78:79], v56 offset:2408
    v_mfma_f32_16x16x32_bf16 v[152:155], v[80:83], v[120:123], v[152:155]
    ds_read_b128 v[128:131], v57 offset:3552
    v_add_u32 v58, 5088, v57
    v_mfma_f32_16x16x32_bf16 v[156:159], v[84:87], v[120:123], v[156:159]
    v_min_u32 v58, s55, v58
    ds_read_b128 v[116:119], v58
    s_waitcnt lgkmcnt(6)
    v_mfma_f32_16x16x32_bf16 v[160:163], v[64:67], v[124:127], v[160:163]
    ds_read_b64 v[80:81], v56 offset:2432
    ds_read_b64 v[82:83], v56 offset:2440
    v_mfma_f32_16x16x32_bf16 v[164:167], v[68:71], v[124:127], v[164:167]
    ds_read_b64 v[84:85], v56 offset:2464
    ds_read_b64 v[86:87], v56 offset:2472
    v_mfma_f32_16x16x32_bf16 v[152:155], v[64:67], v[112:115], v[152:155]
    ds_read_b128 v[132:135], v57 offset:3648
    v_add_u32 v58, 5184, v57
    v_mfma_f32_16x16x32_bf16 v[156:159], v[68:71], v[112:115], v[156:159]
    v_min_u32 v58, s55, v58
    ds_read_b128 v[120:123], v58
    s_waitcnt lgkmcnt(6)
    v_mfma_f32_16x16x32_bf16 v[160:163], v[72:75], v[128:131], v[160:163]
    ds_read_b64 v[64:65], v56 offset:2496
    ds_read_b64 v[66:67], v56 offset:2504
    v_mfma_f32_16x16x32_bf16 v[164:167], v[76:79], v[128:131], v[164:167]
    ds_read_b64 v[68:69], v56 offset:2528
    ds_read_b64 v[70:71], v56 offset:2536
    v_mfma_f32_16x16x32_bf16 v[152:155], v[72:75], v[116:119], v[152:155]
    ds_read_b128 v[124:127], v57 offset:3744
    v_add_u32 v58, 5280, v57
    v_mfma_f32_16x16x32_bf16 v[156:159], v[76:79], v[116:119], v[156:159]
    v_min_u32 v58, s55, v58
    ds_read_b128 v[112:115], v58
    s_waitcnt lgkmcnt(6)
    v_mfma_f32_16x16x32_bf16 v[160:163], v[80:83], v[132:135], v[160:163]
    ds_read_b64 v[72:73], v56 offset:2560
    ds_read_b64 v[74:75], v56 offset:2568
    v_mfma_f32_16x16x32_bf16 v[164:167], v[84:87], v[132:135], v[164:167]
    ds_read_b64 v[76:77], v56 offset:2592
    ds_read_b64 v[78:79], v56 offset:2600
    v_mfma_f32_16x16x32_bf16 v[152:155], v[80:83], v[120:123], v[152:155]
    ds_read_b128 v[128:131], v57 offset:3840
    v_add_u32 v58, 5376, v57
    v_mfma_f32_16x16x32_bf16 v[156:159], v[84:87], v[120:123], v[156:159]
    v_min_u32 v58, s55, v58
    ds_read_b128 v[116:119], v58
    s_waitcnt lgkmcnt(6)
    v_mfma_f32_16x16x32_bf16 v[160:163], v[64:67], v[124:127], v[160:163]
    ds_read_b64 v[80:81], v56 offset:2624
    ds_read_b64 v[82:83], v56 offset:2632
    v_mfma_f32_16x16x32_bf16 v[164:167], v[68:71], v[124:127], v[164:167]
    ds_read_b64 v[84:85], v56 offset:2656
    ds_read_b64 v[86:87], v56 offset:2664
    v_mfma_f32_16x16x32_bf16 v[152:155], v[64:67], v[112:115], v[152:155]
    ds_read_b128 v[132:135], v57 offset:3936
    v_add_u32 v58, 5472, v57
    v_mfma_f32_16x16x32_bf16 v[156:159], v[68:71], v[112:115], v[156:159]
    v_min_u32 v58, s55, v58
    ds_read_b128 v[120:123], v58
    s_waitcnt lgkmcnt(6)
    v_mfma_f32_16x16x32_bf16 v[160:163], v[72:75], v[128:131], v[160:163]
    ds_read_b64 v[64:65], v56 offset:2688
    ds_read_b64 v[66:67], v56 offset:2696
    v_mfma_f32_16x16x32_bf16 v[164:167], v[76:79], v[128:131], v[164:167]
    ds_read_b64 v[68:69], v56 offset:2720
    ds_read_b64 v[70:71], v56 offset:2728
    v_mfma_f32_16x16x32_bf16 v[152:155], v[72:75], v[116:119], v[152:155]
    ds_read_b128 v[124:127], v57 offset:4032
    v_add_u32 v58, 5568, v57
    v_mfma_f32_16x16x32_bf16 v[156:159], v[76:79], v[116:119], v[156:159]
    v_min_u32 v58, s55, v58
    ds_read_b128 v[112:115], v58
    s_waitcnt lgkmcnt(6)
    v_mfma_f32_16x16x32_bf16 v[160:163], v[80:83], v[132:135], v[160:163]
    ds_read_b64 v[72:73], v56 offset:2752
    ds_read_b64 v[74:75], v56 offset:2760
    v_mfma_f32_16x16x32_bf16 v[164:167], v[84:87], v[132:135], v[164:167]
    ds_read_b64 v[76:77], v56 offset:2784
    ds_read_b64 v[78:79], v56 offset:2792
    v_mfma_f32_16x16x32_bf16 v[152:155], v[80:83], v[120:123], v[152:155]
    ds_read_b128 v[128:131], v57 offset:4128
    v_add_u32 v58, 5664, v57
    v_mfma_f32_16x16x32_bf16 v[156:159], v[84:87], v[120:123], v[156:159]
    v_min_u32 v58, s55, v58
    ds_read_b128 v[116:119], v58
    s_waitcnt lgkmcnt(6)
    v_mfma_f32_16x16x32_bf16 v[160:163], v[64:67], v[124:127], v[160:163]
    ds_read_b64 v[80:81], v56 offset:2816
    ds_read_b64 v[82:83], v56 offset:2824
    v_mfma_f32_16x16x32_bf16 v[164:167], v[68:71], v[124:127], v[164:167]
    ds_read_b64 v[84:85], v56 offset:2848
    ds_read_b64 v[86:87], v56 offset:2856
    v_mfma_f32_16x16x32_bf16 v[152:155], v[64:67], v[112:115], v[152:155]
    ds_read_b128 v[132:135], v57 offset:4224
    v_add_u32 v58, 5760, v57
    v_mfma_f32_16x16x32_bf16 v[156:159], v[68:71], v[112:115], v[156:159]
    v_min_u32 v58, s55, v58
    ds_read_b128 v[120:123], v58
    s_waitcnt lgkmcnt(6)
    v_mfma_f32_16x16x32_bf16 v[160:163], v[72:75], v[128:131], v[160:163]
    ds_read_b64 v[64:65], v56 offset:2880
    ds_read_b64 v[66:67], v56 offset:2888
    v_mfma_f32_16x16x32_bf16 v[164:167], v[76:79], v[128:131], v[164:167]
    ds_read_b64 v[68:69], v56 offset:2912
    ds_read_b64 v[70:71], v56 offset:2920
    v_mfma_f32_16x16x32_bf16 v[152:155], v[72:75], v[116:119], v[152:155]
    ds_read_b128 v[124:127], v57 offset:4320
    v_add_u32 v58, 5856, v57
    v_mfma_f32_16x16x32_bf16 v[156:159], v[76:79], v[116:119], v[156:159]
    v_min_u32 v58, s55, v58
    ds_read_b128 v[112:115], v58
    s_waitcnt lgkmcnt(6)
    v_mfma_f32_16x16x32_bf16 v[160:163], v[80:83], v[132:135], v[160:163]
    ds_read_b64 v[72:73], v56 offset:2944
    ds_read_b64 v[74:75], v56 offset:2952
    v_mfma_f32_16x16x32_bf16 v[164:167], v[84:87], v[132:135], v[164:167]
    ds_read_b64 v[76:77], v56 offset:2976
    ds_read_b64 v[78:79], v56 offset:2984
    v_mfma_f32_16x16x32_bf16 v[152:155], v[80:83], v[120:123], v[152:155]
    ds_read_b128 v[128:131], v57 offset:4416
    v_add_u32 v58, 5952, v57
    v_mfma_f32_16x16x32_bf16 v[156:159], v[84:87], v[120:123], v[156:159]
    v_min_u32 v58, s55, v58
    ds_read_b128 v[116:119], v58
    s_waitcnt lgkmcnt(6)
    v_mfma_f32_16x16x32_bf16 v[160:163], v[64:67], v[124:127], v[160:163]
    ds_read_b64 v[80:81], v56 offset:3008
    ds_read_b64 v[82:83], v56 offset:3016
    v_mfma_f32_16x16x32_bf16 v[164:167], v[68:71], v[124:127], v[164:167]
    ds_read_b64 v[84:85], v56 offset:3040
    ds_read_b64 v[86:87], v56 offset:3048
    v_mfma_f32_16x16x32_bf16 v[152:155], v[64:67], v[112:115], v[152:155]
    ds_read_b128 v[132:135], v57 offset:4512
    v_add_u32 v58, 6048, v57
    v_mfma_f32_16x16x32_bf16 v[156:159], v[68:71], v[112:115], v[156:159]
    v_min_u32 v58, s55, v58
    ds_read_b128 v[120:123], v58
    s_waitcnt lgkmcnt(6)
    v_mfma_f32_16x16x32_bf16 v[160:163], v[72:75], v[128:131], v[160:163]
    ds_read_b64 v[64:65], v56 offset:3072
    ds_read_b64 v[66:67], v56 offset:3080
    v_mfma_f32_16x16x32_bf16 v[164:167], v[76:79], v[128:131], v[164:167]
    ds_read_b64 v[68:69], v56 offset:3104
    v_mfma_f32_16x16x32_bf16 v[152:155], v[72:75], v[116:119], v[152:155]
    ds_read_b64 v[70:71], v56 offset:3112
    v_mfma_f32_16x16x32_bf16 v[156:159], v[76:79], v[116:119], v[156:159]
    ds_read_b128 v[124:127], v57 offset:4608
    s_waitcnt lgkmcnt(5)
    v_mfma_f32_16x16x32_bf16 v[160:163], v[80:83], v[132:135], v[160:163]
    ds_read_b64 v[72:73], v56 offset:3136
    ds_read_b64 v[74:75], v56 offset:3144
    v_mfma_f32_16x16x32_bf16 v[164:167], v[84:87], v[132:135], v[164:167]
    ds_read_b64 v[76:77], v56 offset:3168
    ds_read_b64 v[78:79], v56 offset:3176
    v_mfma_f32_16x16x32_bf16 v[152:155], v[80:83], v[120:123], v[152:155]
    v_add_u32 v58, 4704, v57
    v_min_u32 v58, s55, v58
    v_mfma_f32_16x16x32_bf16 v[156:159], v[84:87], v[120:123], v[156:159]
    ds_read_b128 v[128:131], v58
    s_waitcnt lgkmcnt(5)
    v_mfma_f32_16x16x32_bf16 v[160:163], v[64:67], v[124:127], v[160:163]
    ds_read_b64 v[80:81], v56 offset:3200
    ds_read_b64 v[82:83], v56 offset:3208
    ds_read_b64 v[84:85], v56 offset:3232
    ds_read_b64 v[86:87], v56 offset:3240
    v_mfma_f32_16x16x32_bf16 v[164:167], v[68:71], v[124:127], v[164:167]
    v_add_u32 v58, 4800, v57
    v_min_u32 v58, s55, v58
    ds_read_b128 v[132:135], v58
    s_waitcnt lgkmcnt(5)
    v_mfma_f32_16x16x32_bf16 v[160:163], v[72:75], v[128:131], v[160:163]
    ds_read_b64 v[64:65], v56 offset:3264
    ds_read_b64 v[66:67], v56 offset:3272
    ds_read_b64 v[68:69], v56 offset:3296
    ds_read_b64 v[70:71], v56 offset:3304
    v_mfma_f32_16x16x32_bf16 v[164:167], v[76:79], v[128:131], v[164:167]
    v_add_u32 v58, 4896, v57
    v_min_u32 v58, s55, v58
    ds_read_b128 v[124:127], v58
    s_waitcnt lgkmcnt(5)
    v_mfma_f32_16x16x32_bf16 v[160:163], v[80:83], v[132:135], v[160:163]
    ds_read_b64 v[72:73], v56 offset:3328
    ds_read_b64 v[74:75], v56 offset:3336
    ds_read_b64 v[76:77], v56 offset:3360
    ds_read_b64 v[78:79], v56 offset:3368
    v_mfma_f32_16x16x32_bf16 v[164:167], v[84:87], v[132:135], v[164:167]
    v_add_u32 v58, 4992, v57
    v_min_u32 v58, s55, v58
    ds_read_b128 v[128:131], v58
    s_waitcnt lgkmcnt(5)
    v_mfma_f32_16x16x32_bf16 v[160:163], v[64:67], v[124:127], v[160:163]
    ds_read_b64 v[80:81], v56 offset:3392
    ds_read_b64 v[82:83], v56 offset:3400
    ds_read_b64 v[84:85], v56 offset:3424
    ds_read_b64 v[86:87], v56 offset:3432
    v_mfma_f32_16x16x32_bf16 v[164:167], v[68:71], v[124:127], v[164:167]
    v_add_u32 v58, 5088, v57
    v_min_u32 v58, s55, v58
    ds_read_b128 v[132:135], v58
    s_waitcnt lgkmcnt(5)
    v_mfma_f32_16x16x32_bf16 v[160:163], v[72:75], v[128:131], v[160:163]
    ds_read_b64 v[64:65], v56 offset:3456
    ds_read_b64 v[66:67], v56 offset:3464
    ds_read_b64 v[68:69], v56 offset:3488
    ds_read_b64 v[70:71], v56 offset:3496
    v_mfma_f32_16x16x32_bf16 v[164:167], v[76:79], v[128:131], v[164:167]
    v_add_u32 v58, 5184, v57
    v_min_u32 v58, s55, v58
    ds_read_b128 v[124:127], v58
    s_waitcnt lgkmcnt(5)
    v_mfma_f32_16x16x32_bf16 v[160:163], v[80:83], v[132:135], v[160:163]
    ds_read_b64 v[72:73], v56 offset:3520
    ds_read_b64 v[74:75], v56 offset:3528
    ds_read_b64 v[76:77], v56 offset:3552
    ds_read_b64 v[78:79], v56 offset:3560
    v_mfma_f32_16x16x32_bf16 v[164:167], v[84:87], v[132:135], v[164:167]
    v_add_u32 v58, 5280, v57
    v_min_u32 v58, s55, v58
    ds_read_b128 v[128:131], v58
    s_waitcnt lgkmcnt(5)
    v_mfma_f32_16x16x32_bf16 v[160:163], v[64:67], v[124:127], v[160:163]
    ds_read_b64 v[80:81], v56 offset:3584
    ds_read_b64 v[82:83], v56 offset:3592
    ds_read_b64 v[84:85], v56 offset:3616
    ds_read_b64 v[86:87], v56 offset:3624
    v_mfma_f32_16x16x32_bf16 v[164:167], v[68:71], v[124:127], v[164:167]
    v_add_u32 v58, 5376, v57
    v_min_u32 v58, s55, v58
    ds_read_b128 v[132:135], v58
    s_waitcnt lgkmcnt(5)
    v_mfma_f32_16x16x32_bf16 v[160:163], v[72:75], v[128:131], v[160:163]
    ds_read_b64 v[64:65], v56 offset:3648
    ds_read_b64 v[66:67], v56 offset:3656
    ds_read_b64 v[68:69], v56 offset:3680
    ds_read_b64 v[70:71], v56 offset:3688
    v_mfma_f32_16x16x32_bf16 v[164:167], v[76:79], v[128:131], v[164:167]
    v_add_u32 v58, 5472, v57
    v_min_u32 v58, s55, v58
    ds_read_b128 v[124:127], v58
    s_waitcnt lgkmcnt(5)
    v_mfma_f32_16x16x32_bf16 v[160:163], v[80:83], v[132:135], v[160:163]
    ds_read_b64 v[72:73], v56 offset:3712
    ds_read_b64 v[74:75], v56 offset:3720
    ds_read_b64 v[76:77], v56 offset:3744
    ds_read_b64 v[78:79], v56 offset:3752
    v_mfma_f32_16x16x32_bf16 v[164:167], v[84:87], v[132:135], v[164:167]
    v_add_u32 v58, 5568, v57
    v_min_u32 v58, s55, v58
    ds_read_b128 v[128:131], v58
    s_waitcnt lgkmcnt(5)
    v_mfma_f32_16x16x32_bf16 v[160:163], v[64:67], v[124:127], v[160:163]
    ds_read_b64 v[80:81], v56 offset:3776
    ds_read_b64 v[82:83], v56 offset:3784
    ds_read_b64 v[84:85], v56 offset:3808
    ds_read_b64 v[86:87], v56 offset:3816
    v_mfma_f32_16x16x32_bf16 v[164:167], v[68:71], v[124:127], v[164:167]
    v_add_u32 v58, 5664, v57
    v_min_u32 v58, s55, v58
    ds_read_b128 v[132:135], v58
    s_waitcnt lgkmcnt(5)
    v_mfma_f32_16x16x32_bf16 v[160:163], v[72:75], v[128:131], v[160:163]
    ds_read_b64 v[64:65], v56 offset:3840
    ds_read_b64 v[66:67], v56 offset:3848
    ds_read_b64 v[68:69], v56 offset:3872
    ds_read_b64 v[70:71], v56 offset:3880
    v_mfma_f32_16x16x32_bf16 v[164:167], v[76:79], v[128:131], v[164:167]
    v_add_u32 v58, 5760, v57
    v_min_u32 v58, s55, v58
    ds_read_b128 v[124:127], v58
    s_waitcnt lgkmcnt(5)
    v_mfma_f32_16x16x32_bf16 v[160:163], v[80:83], v[132:135], v[160:163]
    ds_read_b64 v[72:73], v56 offset:3904
    ds_read_b64 v[74:75], v56 offset:3912
    ds_read_b64 v[76:77], v56 offset:3936
    ds_read_b64 v[78:79], v56 offset:3944
    v_mfma_f32_16x16x32_bf16 v[164:167], v[84:87], v[132:135], v[164:167]
    v_add_u32 v58, 5856, v57
    v_min_u32 v58, s55, v58
    ds_read_b128 v[128:131], v58
    s_waitcnt lgkmcnt(5)
    v_mfma_f32_16x16x32_bf16 v[160:163], v[64:67], v[124:127], v[160:163]
    ds_read_b64 v[80:81], v56 offset:3968
    ds_read_b64 v[82:83], v56 offset:3976
    ds_read_b64 v[84:85], v56 offset:4000
    ds_read_b64 v[86:87], v56 offset:4008
    v_mfma_f32_16x16x32_bf16 v[164:167], v[68:71], v[124:127], v[164:167]
    v_add_u32 v58, 5952, v57
    v_min_u32 v58, s55, v58
    ds_read_b128 v[132:135], v58
    s_waitcnt lgkmcnt(5)
    v_mfma_f32_16x16x32_bf16 v[160:163], v[72:75], v[128:131], v[160:163]
    ds_read_b64 v[64:65], v56 offset:4032
    ds_read_b64 v[66:67], v56 offset:4040
    ds_read_b64 v[68:69], v56 offset:4064
    ds_read_b64 v[70:71], v56 offset:4072
    v_mfma_f32_16x16x32_bf16 v[164:167], v[76:79], v[128:131], v[164:167]
    v_add_u32 v58, 6048, v57
    v_min_u32 v58, s55, v58
    ds_read_b128 v[124:127], v58
    s_waitcnt lgkmcnt(5)
    v_mfma_f32_16x16x32_bf16 v[160:163], v[80:83], v[132:135], v[160:163]
    v_mfma_f32_16x16x32_bf16 v[164:167], v[84:87], v[132:135], v[164:167]
    s_waitcnt lgkmcnt(0)
    v_mfma_f32_16x16x32_bf16 v[160:163], v[64:67], v[124:127], v[160:163]
    v_mfma_f32_16x16x32_bf16 v[164:167], v[68:71], v[124:127], v[164:167]
    v_mul_u32_u24 v4, 80, v2
    v_lshlrev_b32 v5, 3, v3
    v_add_u32 v4, v4, v5
    v_add_u32 v4, s56, v4
    s_nop 4
    v_cvt_pk_bf16_f32 v56, v136, v137
    v_cvt_pk_bf16_f32 v57, v138, v139
    ds_write_b64 v4, v[56:57] offset:0
    v_cvt_pk_bf16_f32 v58, v140, v141
    v_cvt_pk_bf16_f32 v59, v142, v143
    ds_write_b64 v4, v[58:59] offset:32
    v_cvt_pk_bf16_f32 v60, v144, v145
    v_cvt_pk_bf16_f32 v61, v146, v147
    ds_write_b64 v4, v[60:61] offset:1280
    v_cvt_pk_bf16_f32 v62, v148, v149
    v_cvt_pk_bf16_f32 v63, v150, v151
    ds_write_b64 v4, v[62:63] offset:1312
    v_cvt_pk_bf16_f32 v56, v152, v153
    v_cvt_pk_bf16_f32 v57, v154, v155
    ds_write_b64 v4, v[56:57] offset:2560
    v_cvt_pk_bf16_f32 v58, v156, v157
    v_cvt_pk_bf16_f32 v59, v158, v159
    ds_write_b64 v4, v[58:59] offset:2592
    v_cvt_pk_bf16_f32 v60, v160, v161
    v_cvt_pk_bf16_f32 v61, v162, v163
    ds_write_b64 v4, v[60:61] offset:3840
    v_cvt_pk_bf16_f32 v62, v164, v165
    v_cvt_pk_bf16_f32 v63, v166, v167
    ds_write_b64 v4, v[62:63] offset:3872
    v_lshrrev_b32 v5, 2, v0
    v_mul_u32_u24 v5, 80, v5
    v_and_b32 v6, 3, v0
    v_lshlrev_b32 v6, 4, v6
    v_add_u32 v5, v5, v6
    v_add_u32 v5, s56, v5
    v_lshlrev_b32 v6, 4, v0
    s_lshl_b32 s57, s2, 2
    s_add_u32 s57, s57, s3
    s_lshl_b32 s57, s57, 12
    s_waitcnt lgkmcnt(0)
    ds_read_b128 v[64:67], v5 offset:0
    ds_read_b128 v[68:71], v5 offset:1280
    ds_read_b128 v[72:75], v5 offset:2560
    ds_read_b128 v[76:79], v5 offset:3840
    s_waitcnt lgkmcnt(3)
    buffer_store_dwordx4 v[64:67], v6, s[20:23], s57 offen offset:0 sc1
    s_waitcnt lgkmcnt(2)
    buffer_store_dwordx4 v[68:71], v6, s[20:23], s57 offen offset:1024 sc1
    s_waitcnt lgkmcnt(1)
    buffer_store_dwordx4 v[72:75], v6, s[20:23], s57 offen offset:2048 sc1
    s_waitcnt lgkmcnt(0)
    buffer_store_dwordx4 v[76:79], v6, s[20:23], s57 offen offset:3072 sc1
    s_add_u32 s20, s98, 0x400000
    s_addc_u32 s21, s99, 0
    s_mov_b32 s22, 0x400000
    s_mov_b32 s23, 0x20000
    s_mov_b32 s32, s94
    s_mov_b32 s33, s95
    s_mov_b32 s34, 0x400000
    s_mov_b32 s35, 0x20000
    v_mul_f32 v46, v40, v42
    v_mul_f32 v47, v41, v44
    v_sub_f32 v46, 0, v46
    v_sub_f32 v47, 0, v47
    s_barrier
    ds_read_b64_tr_b16 v[128:129], v10 offset:0
    ds_read_b64_tr_b16 v[130:131], v10 offset:4096
    ds_read_b128 v[144:147], v8 offset:0
    ds_read_b128 v[148:151], v8 offset:2048
    ds_read_b64_tr_b16 v[132:133], v11 offset:0
    ds_read_b64_tr_b16 v[134:135], v11 offset:4096
    ds_read_b128 v[152:155], v9 offset:0
    ds_read_b128 v[156:159], v9 offset:2048
    ds_read_b64_tr_b16 v[136:137], v12 offset:0
    ds_read_b64_tr_b16 v[138:139], v12 offset:4096
    ds_read_b64_tr_b16 v[140:141], v13 offset:0
    ds_read_b64_tr_b16 v[142:143], v13 offset:4096
    s_waitcnt lgkmcnt(4)
    v_mfma_f32_16x16x32_bf16 v[192:195], v[128:131], v[144:147], 0
    ds_read_b64_tr_b16 v[160:161], v10 offset:8192
    v_mfma_f32_16x16x32_bf16 v[196:199], v[128:131], v[148:151], 0
    ds_read_b64_tr_b16 v[162:163], v10 offset:12288
    v_mfma_f32_16x16x32_bf16 v[208:211], v[132:135], v[144:147], 0
    ds_read_b128 v[176:179], v8 offset:1024
    v_mfma_f32_16x16x32_bf16 v[212:215], v[132:135], v[148:151], 0
    ds_read_b128 v[180:183], v8 offset:3072
    v_mfma_f32_16x16x32_bf16 v[200:203], v[128:131], v[152:155], 0
    ds_read_b64_tr_b16 v[164:165], v11 offset:8192
    v_mfma_f32_16x16x32_bf16 v[204:207], v[128:131], v[156:159], 0
    ds_read_b64_tr_b16 v[166:167], v11 offset:12288
    v_mfma_f32_16x16x32_bf16 v[216:219], v[132:135], v[152:155], 0
    ds_read_b128 v[184:187], v9 offset:1024
    v_mfma_f32_16x16x32_bf16 v[220:223], v[132:135], v[156:159], 0
    ds_read_b128 v[188:191], v9 offset:3072
    s_waitcnt lgkmcnt(8)
    v_mfma_f32_16x16x32_bf16 v[224:227], v[136:139], v[144:147], 0
    ds_read_b64_tr_b16 v[168:169], v12 offset:8192
    v_mfma_f32_16x16x32_bf16 v[228:231], v[136:139], v[148:151], 0
    ds_read_b64_tr_b16 v[170:171], v12 offset:12288
    v_mfma_f32_16x16x32_bf16 v[232:235], v[136:139], v[152:155], 0
    ds_read_b64_tr_b16 v[172:173], v13 offset:8192
    v_mfma_f32_16x16x32_bf16 v[236:239], v[136:139], v[156:159], 0
    ds_read_b64_tr_b16 v[174:175], v13 offset:12288
    v_mfma_f32_16x16x32_bf16 v[240:243], v[140:143], v[144:147], 0
    v_mfma_f32_16x16x32_bf16 v[244:247], v[140:143], v[148:151], 0
    v_mfma_f32_16x16x32_bf16 v[248:251], v[140:143], v[152:155], 0
    v_mfma_f32_16x16x32_bf16 v[252:255], v[140:143], v[156:159], 0
    s_barrier
    s_waitcnt lgkmcnt(4)
    v_mfma_f32_16x16x32_bf16 v[192:195], v[160:163], v[176:179], v[192:195]
    ds_read_b64_tr_b16 v[128:129], v16 offset:0
    v_mfma_f32_16x16x32_bf16 v[196:199], v[160:163], v[180:183], v[196:199]
    ds_read_b64_tr_b16 v[130:131], v16 offset:4096
    v_mfma_f32_16x16x32_bf16 v[208:211], v[164:167], v[176:179], v[208:211]
    ds_read_b128 v[144:147], v14 offset:0
    v_mfma_f32_16x16x32_bf16 v[212:215], v[164:167], v[180:183], v[212:215]
    ds_read_b128 v[148:151], v14 offset:2048
    v_mfma_f32_16x16x32_bf16 v[200:203], v[160:163], v[184:187], v[200:203]
    ds_read_b64_tr_b16 v[132:133], v17 offset:0
    v_mfma_f32_16x16x32_bf16 v[204:207], v[160:163], v[188:191], v[204:207]
    ds_read_b64_tr_b16 v[134:135], v17 offset:4096
    v_mfma_f32_16x16x32_bf16 v[216:219], v[164:167], v[184:187], v[216:219]
    ds_read_b128 v[152:155], v15 offset:0
    v_mfma_f32_16x16x32_bf16 v[220:223], v[164:167], v[188:191], v[220:223]
    ds_read_b128 v[156:159], v15 offset:2048
    s_waitcnt lgkmcnt(8)
    v_mfma_f32_16x16x32_bf16 v[224:227], v[168:171], v[176:179], v[224:227]
    ds_read_b64_tr_b16 v[136:137], v18 offset:0
    v_mfma_f32_16x16x32_bf16 v[228:231], v[168:171], v[180:183], v[228:231]
    ds_read_b64_tr_b16 v[138:139], v18 offset:4096
    v_mfma_f32_16x16x32_bf16 v[232:235], v[168:171], v[184:187], v[232:235]
    ds_read_b64_tr_b16 v[140:141], v19 offset:0
    v_mfma_f32_16x16x32_bf16 v[236:239], v[168:171], v[188:191], v[236:239]
    ds_read_b64_tr_b16 v[142:143], v19 offset:4096
    v_mfma_f32_16x16x32_bf16 v[240:243], v[172:175], v[176:179], v[240:243]
    v_mfma_f32_16x16x32_bf16 v[244:247], v[172:175], v[180:183], v[244:247]
    v_mfma_f32_16x16x32_bf16 v[248:251], v[172:175], v[184:187], v[248:251]
    v_mfma_f32_16x16x32_bf16 v[252:255], v[172:175], v[188:191], v[252:255]
    s_waitcnt lgkmcnt(4)
    v_mfma_f32_16x16x32_bf16 v[192:195], v[128:131], v[144:147], v[192:195]
    ds_read_b64_tr_b16 v[160:161], v16 offset:8192
    v_mfma_f32_16x16x32_bf16 v[196:199], v[128:131], v[148:151], v[196:199]
    ds_read_b64_tr_b16 v[162:163], v16 offset:12288
    v_mfma_f32_16x16x32_bf16 v[208:211], v[132:135], v[144:147], v[208:211]
    ds_read_b128 v[176:179], v14 offset:1024
    v_mfma_f32_16x16x32_bf16 v[212:215], v[132:135], v[148:151], v[212:215]
    ds_read_b128 v[180:183], v14 offset:3072
    v_mfma_f32_16x16x32_bf16 v[200:203], v[128:131], v[152:155], v[200:203]
    ds_read_b64_tr_b16 v[164:165], v17 offset:8192
    v_mfma_f32_16x16x32_bf16 v[204:207], v[128:131], v[156:159], v[204:207]
    ds_read_b64_tr_b16 v[166:167], v17 offset:12288
    v_mfma_f32_16x16x32_bf16 v[216:219], v[132:135], v[152:155], v[216:219]
    ds_read_b128 v[184:187], v15 offset:1024
    v_mfma_f32_16x16x32_bf16 v[220:223], v[132:135], v[156:159], v[220:223]
    ds_read_b128 v[188:191], v15 offset:3072
    s_waitcnt lgkmcnt(8)
    v_mfma_f32_16x16x32_bf16 v[224:227], v[136:139], v[144:147], v[224:227]
    ds_read_b64_tr_b16 v[168:169], v18 offset:8192
    v_mfma_f32_16x16x32_bf16 v[228:231], v[136:139], v[148:151], v[228:231]
    ds_read_b64_tr_b16 v[170:171], v18 offset:12288
    v_mfma_f32_16x16x32_bf16 v[232:235], v[136:139], v[152:155], v[232:235]
    ds_read_b64_tr_b16 v[172:173], v19 offset:8192
    v_mfma_f32_16x16x32_bf16 v[236:239], v[136:139], v[156:159], v[236:239]
    ds_read_b64_tr_b16 v[174:175], v19 offset:12288
    v_mfma_f32_16x16x32_bf16 v[240:243], v[140:143], v[144:147], v[240:243]
    v_mfma_f32_16x16x32_bf16 v[244:247], v[140:143], v[148:151], v[244:247]
    v_mfma_f32_16x16x32_bf16 v[248:251], v[140:143], v[152:155], v[248:251]
    v_mfma_f32_16x16x32_bf16 v[252:255], v[140:143], v[156:159], v[252:255]
    s_barrier
    s_waitcnt lgkmcnt(4)
    v_mfma_f32_16x16x32_bf16 v[192:195], v[160:163], v[176:179], v[192:195]
    ds_read_b64_tr_b16 v[128:129], v22 offset:0
    v_mfma_f32_16x16x32_bf16 v[196:199], v[160:163], v[180:183], v[196:199]
    ds_read_b64_tr_b16 v[130:131], v22 offset:4096
    v_mfma_f32_16x16x32_bf16 v[208:211], v[164:167], v[176:179], v[208:211]
    ds_read_b128 v[144:147], v20 offset:0
    v_mfma_f32_16x16x32_bf16 v[212:215], v[164:167], v[180:183], v[212:215]
    ds_read_b128 v[148:151], v20 offset:2048
    v_mfma_f32_16x16x32_bf16 v[200:203], v[160:163], v[184:187], v[200:203]
    ds_read_b64_tr_b16 v[132:133], v23 offset:0
    v_mfma_f32_16x16x32_bf16 v[204:207], v[160:163], v[188:191], v[204:207]
    ds_read_b64_tr_b16 v[134:135], v23 offset:4096
    v_mfma_f32_16x16x32_bf16 v[216:219], v[164:167], v[184:187], v[216:219]
    ds_read_b128 v[152:155], v21 offset:0
    v_mfma_f32_16x16x32_bf16 v[220:223], v[164:167], v[188:191], v[220:223]
    ds_read_b128 v[156:159], v21 offset:2048
    s_waitcnt lgkmcnt(8)
    v_mfma_f32_16x16x32_bf16 v[224:227], v[168:171], v[176:179], v[224:227]
    ds_read_b64_tr_b16 v[136:137], v24 offset:0
    v_mfma_f32_16x16x32_bf16 v[228:231], v[168:171], v[180:183], v[228:231]
    ds_read_b64_tr_b16 v[138:139], v24 offset:4096
    v_mfma_f32_16x16x32_bf16 v[232:235], v[168:171], v[184:187], v[232:235]
    ds_read_b64_tr_b16 v[140:141], v25 offset:0
    v_mfma_f32_16x16x32_bf16 v[236:239], v[168:171], v[188:191], v[236:239]
    ds_read_b64_tr_b16 v[142:143], v25 offset:4096
    v_mfma_f32_16x16x32_bf16 v[240:243], v[172:175], v[176:179], v[240:243]
    v_mfma_f32_16x16x32_bf16 v[244:247], v[172:175], v[180:183], v[244:247]
    v_mfma_f32_16x16x32_bf16 v[248:251], v[172:175], v[184:187], v[248:251]
    v_mfma_f32_16x16x32_bf16 v[252:255], v[172:175], v[188:191], v[252:255]
    s_waitcnt lgkmcnt(4)
    v_mfma_f32_16x16x32_bf16 v[192:195], v[128:131], v[144:147], v[192:195]
    ds_read_b64_tr_b16 v[160:161], v22 offset:8192
    v_mfma_f32_16x16x32_bf16 v[196:199], v[128:131], v[148:151], v[196:199]
    ds_read_b64_tr_b16 v[162:163], v22 offset:12288
    v_mfma_f32_16x16x32_bf16 v[208:211], v[132:135], v[144:147], v[208:211]
    ds_read_b128 v[176:179], v20 offset:1024
    v_mfma_f32_16x16x32_bf16 v[212:215], v[132:135], v[148:151], v[212:215]
    ds_read_b128 v[180:183], v20 offset:3072
    v_mfma_f32_16x16x32_bf16 v[200:203], v[128:131], v[152:155], v[200:203]
    ds_read_b64_tr_b16 v[164:165], v23 offset:8192
    v_mfma_f32_16x16x32_bf16 v[204:207], v[128:131], v[156:159], v[204:207]
    ds_read_b64_tr_b16 v[166:167], v23 offset:12288
    v_mfma_f32_16x16x32_bf16 v[216:219], v[132:135], v[152:155], v[216:219]
    ds_read_b128 v[184:187], v21 offset:1024
    v_mfma_f32_16x16x32_bf16 v[220:223], v[132:135], v[156:159], v[220:223]
    ds_read_b128 v[188:191], v21 offset:3072
    s_waitcnt lgkmcnt(8)
    v_mfma_f32_16x16x32_bf16 v[224:227], v[136:139], v[144:147], v[224:227]
    ds_read_b64_tr_b16 v[168:169], v24 offset:8192
    v_mfma_f32_16x16x32_bf16 v[228:231], v[136:139], v[148:151], v[228:231]
    ds_read_b64_tr_b16 v[170:171], v24 offset:12288
    v_mfma_f32_16x16x32_bf16 v[232:235], v[136:139], v[152:155], v[232:235]
    ds_read_b64_tr_b16 v[172:173], v25 offset:8192
    v_mfma_f32_16x16x32_bf16 v[236:239], v[136:139], v[156:159], v[236:239]
    ds_read_b64_tr_b16 v[174:175], v25 offset:12288
    v_mfma_f32_16x16x32_bf16 v[240:243], v[140:143], v[144:147], v[240:243]
    v_mfma_f32_16x16x32_bf16 v[244:247], v[140:143], v[148:151], v[244:247]
    v_mfma_f32_16x16x32_bf16 v[248:251], v[140:143], v[152:155], v[248:251]
    v_mfma_f32_16x16x32_bf16 v[252:255], v[140:143], v[156:159], v[252:255]
    s_barrier
    s_waitcnt lgkmcnt(4)
    v_mfma_f32_16x16x32_bf16 v[192:195], v[160:163], v[176:179], v[192:195]
    ds_read_b64_tr_b16 v[128:129], v28 offset:0
    v_mfma_f32_16x16x32_bf16 v[196:199], v[160:163], v[180:183], v[196:199]
    ds_read_b64_tr_b16 v[130:131], v28 offset:4096
    v_mfma_f32_16x16x32_bf16 v[208:211], v[164:167], v[176:179], v[208:211]
    ds_read_b128 v[144:147], v26 offset:0
    v_mfma_f32_16x16x32_bf16 v[212:215], v[164:167], v[180:183], v[212:215]
    ds_read_b128 v[148:151], v26 offset:2048
    v_mfma_f32_16x16x32_bf16 v[200:203], v[160:163], v[184:187], v[200:203]
    ds_read_b64_tr_b16 v[132:133], v29 offset:0
    v_mfma_f32_16x16x32_bf16 v[204:207], v[160:163], v[188:191], v[204:207]
    ds_read_b64_tr_b16 v[134:135], v29 offset:4096
    v_mfma_f32_16x16x32_bf16 v[216:219], v[164:167], v[184:187], v[216:219]
    ds_read_b128 v[152:155], v27 offset:0
    v_mfma_f32_16x16x32_bf16 v[220:223], v[164:167], v[188:191], v[220:223]
    ds_read_b128 v[156:159], v27 offset:2048
    s_waitcnt lgkmcnt(8)
    v_mfma_f32_16x16x32_bf16 v[224:227], v[168:171], v[176:179], v[224:227]
    ds_read_b64_tr_b16 v[136:137], v30 offset:0
    v_mfma_f32_16x16x32_bf16 v[228:231], v[168:171], v[180:183], v[228:231]
    ds_read_b64_tr_b16 v[138:139], v30 offset:4096
    v_mfma_f32_16x16x32_bf16 v[232:235], v[168:171], v[184:187], v[232:235]
    ds_read_b64_tr_b16 v[140:141], v31 offset:0
    v_mfma_f32_16x16x32_bf16 v[236:239], v[168:171], v[188:191], v[236:239]
    ds_read_b64_tr_b16 v[142:143], v31 offset:4096
    v_mfma_f32_16x16x32_bf16 v[240:243], v[172:175], v[176:179], v[240:243]
    v_mfma_f32_16x16x32_bf16 v[244:247], v[172:175], v[180:183], v[244:247]
    v_mfma_f32_16x16x32_bf16 v[248:251], v[172:175], v[184:187], v[248:251]
    v_mfma_f32_16x16x32_bf16 v[252:255], v[172:175], v[188:191], v[252:255]
    s_waitcnt lgkmcnt(4)
    v_mfma_f32_16x16x32_bf16 v[192:195], v[128:131], v[144:147], v[192:195]
    ds_read_b64_tr_b16 v[160:161], v28 offset:8192
    v_mfma_f32_16x16x32_bf16 v[196:199], v[128:131], v[148:151], v[196:199]
    ds_read_b64_tr_b16 v[162:163], v28 offset:12288
    v_mfma_f32_16x16x32_bf16 v[208:211], v[132:135], v[144:147], v[208:211]
    ds_read_b128 v[176:179], v26 offset:1024
    v_mfma_f32_16x16x32_bf16 v[212:215], v[132:135], v[148:151], v[212:215]
    ds_read_b128 v[180:183], v26 offset:3072
    v_mfma_f32_16x16x32_bf16 v[200:203], v[128:131], v[152:155], v[200:203]
    ds_read_b64_tr_b16 v[164:165], v29 offset:8192
    v_mfma_f32_16x16x32_bf16 v[204:207], v[128:131], v[156:159], v[204:207]
    ds_read_b64_tr_b16 v[166:167], v29 offset:12288
    v_mfma_f32_16x16x32_bf16 v[216:219], v[132:135], v[152:155], v[216:219]
    ds_read_b128 v[184:187], v27 offset:1024
    v_mfma_f32_16x16x32_bf16 v[220:223], v[132:135], v[156:159], v[220:223]
    ds_read_b128 v[188:191], v27 offset:3072
    s_waitcnt lgkmcnt(8)
    v_mfma_f32_16x16x32_bf16 v[224:227], v[136:139], v[144:147], v[224:227]
    ds_read_b64_tr_b16 v[168:169], v30 offset:8192
    v_mfma_f32_16x16x32_bf16 v[228:231], v[136:139], v[148:151], v[228:231]
    ds_read_b64_tr_b16 v[170:171], v30 offset:12288
    v_mfma_f32_16x16x32_bf16 v[232:235], v[136:139], v[152:155], v[232:235]
    ds_read_b64_tr_b16 v[172:173], v31 offset:8192
    v_mfma_f32_16x16x32_bf16 v[236:239], v[136:139], v[156:159], v[236:239]
    ds_read_b64_tr_b16 v[174:175], v31 offset:12288
    v_mfma_f32_16x16x32_bf16 v[240:243], v[140:143], v[144:147], v[240:243]
    v_mfma_f32_16x16x32_bf16 v[244:247], v[140:143], v[148:151], v[244:247]
    v_mfma_f32_16x16x32_bf16 v[248:251], v[140:143], v[152:155], v[248:251]
    v_mfma_f32_16x16x32_bf16 v[252:255], v[140:143], v[156:159], v[252:255]
    s_barrier
    s_waitcnt lgkmcnt(4)
    v_mfma_f32_16x16x32_bf16 v[192:195], v[160:163], v[176:179], v[192:195]
    ds_read_b64_tr_b16 v[128:129], v34 offset:0
    v_mfma_f32_16x16x32_bf16 v[196:199], v[160:163], v[180:183], v[196:199]
    ds_read_b64_tr_b16 v[130:131], v34 offset:4096
    v_mfma_f32_16x16x32_bf16 v[208:211], v[164:167], v[176:179], v[208:211]
    ds_read_b128 v[144:147], v32 offset:0
    v_mfma_f32_16x16x32_bf16 v[212:215], v[164:167], v[180:183], v[212:215]
    ds_read_b128 v[148:151], v32 offset:2048
    v_mfma_f32_16x16x32_bf16 v[200:203], v[160:163], v[184:187], v[200:203]
    ds_read_b64_tr_b16 v[132:133], v35 offset:0
    v_mfma_f32_16x16x32_bf16 v[204:207], v[160:163], v[188:191], v[204:207]
    ds_read_b64_tr_b16 v[134:135], v35 offset:4096
    v_mfma_f32_16x16x32_bf16 v[216:219], v[164:167], v[184:187], v[216:219]
    ds_read_b128 v[152:155], v33 offset:0
    v_mfma_f32_16x16x32_bf16 v[220:223], v[164:167], v[188:191], v[220:223]
    ds_read_b128 v[156:159], v33 offset:2048
    s_waitcnt lgkmcnt(8)
    v_mfma_f32_16x16x32_bf16 v[224:227], v[168:171], v[176:179], v[224:227]
    ds_read_b64_tr_b16 v[136:137], v36 offset:0
    v_mfma_f32_16x16x32_bf16 v[228:231], v[168:171], v[180:183], v[228:231]
    ds_read_b64_tr_b16 v[138:139], v36 offset:4096
    v_mfma_f32_16x16x32_bf16 v[232:235], v[168:171], v[184:187], v[232:235]
    ds_read_b64_tr_b16 v[140:141], v37 offset:0
    v_mfma_f32_16x16x32_bf16 v[236:239], v[168:171], v[188:191], v[236:239]
    ds_read_b64_tr_b16 v[142:143], v37 offset:4096
    v_mfma_f32_16x16x32_bf16 v[240:243], v[172:175], v[176:179], v[240:243]
    v_mfma_f32_16x16x32_bf16 v[244:247], v[172:175], v[180:183], v[244:247]
    v_mfma_f32_16x16x32_bf16 v[248:251], v[172:175], v[184:187], v[248:251]
    v_mfma_f32_16x16x32_bf16 v[252:255], v[172:175], v[188:191], v[252:255]
    s_waitcnt lgkmcnt(4)
    v_mfma_f32_16x16x32_bf16 v[192:195], v[128:131], v[144:147], v[192:195]
    ds_read_b64_tr_b16 v[160:161], v34 offset:8192
    v_mfma_f32_16x16x32_bf16 v[196:199], v[128:131], v[148:151], v[196:199]
    ds_read_b64_tr_b16 v[162:163], v34 offset:12288
    v_mfma_f32_16x16x32_bf16 v[208:211], v[132:135], v[144:147], v[208:211]
    ds_read_b128 v[176:179], v32 offset:1024
    v_mfma_f32_16x16x32_bf16 v[212:215], v[132:135], v[148:151], v[212:215]
    ds_read_b128 v[180:183], v32 offset:3072
    v_mfma_f32_16x16x32_bf16 v[200:203], v[128:131], v[152:155], v[200:203]
    ds_read_b64_tr_b16 v[164:165], v35 offset:8192
    v_mfma_f32_16x16x32_bf16 v[204:207], v[128:131], v[156:159], v[204:207]
    ds_read_b64_tr_b16 v[166:167], v35 offset:12288
    v_mfma_f32_16x16x32_bf16 v[216:219], v[132:135], v[152:155], v[216:219]
    ds_read_b128 v[184:187], v33 offset:1024
    v_mfma_f32_16x16x32_bf16 v[220:223], v[132:135], v[156:159], v[220:223]
    ds_read_b128 v[188:191], v33 offset:3072
    s_waitcnt lgkmcnt(8)
    v_mfma_f32_16x16x32_bf16 v[224:227], v[136:139], v[144:147], v[224:227]
    ds_read_b64_tr_b16 v[168:169], v36 offset:8192
    v_mfma_f32_16x16x32_bf16 v[228:231], v[136:139], v[148:151], v[228:231]
    ds_read_b64_tr_b16 v[170:171], v36 offset:12288
    v_mfma_f32_16x16x32_bf16 v[232:235], v[136:139], v[152:155], v[232:235]
    ds_read_b64_tr_b16 v[172:173], v37 offset:8192
    v_mfma_f32_16x16x32_bf16 v[236:239], v[136:139], v[156:159], v[236:239]
    ds_read_b64_tr_b16 v[174:175], v37 offset:12288
    v_mfma_f32_16x16x32_bf16 v[240:243], v[140:143], v[144:147], v[240:243]
    s_waitcnt vmcnt(0)
    v_mfma_f32_16x16x32_bf16 v[244:247], v[140:143], v[148:151], v[244:247]
    v_mfma_f32_16x16x32_bf16 v[248:251], v[140:143], v[152:155], v[248:251]
    v_mfma_f32_16x16x32_bf16 v[252:255], v[140:143], v[156:159], v[252:255]
    s_barrier
    s_waitcnt lgkmcnt(4)
    v_mfma_f32_16x16x32_bf16 v[192:195], v[160:163], v[176:179], v[192:195]
    ds_read_b64_tr_b16 v[128:129], v10 offset:0
    v_mfma_f32_16x16x32_bf16 v[196:199], v[160:163], v[180:183], v[196:199]
    ds_read_b64_tr_b16 v[130:131], v10 offset:4096
    v_mfma_f32_16x16x32_bf16 v[208:211], v[164:167], v[176:179], v[208:211]
    ds_read_b128 v[144:147], v8 offset:0
    v_mfma_f32_16x16x32_bf16 v[212:215], v[164:167], v[180:183], v[212:215]
    ds_read_b128 v[148:151], v8 offset:2048
    v_mfma_f32_16x16x32_bf16 v[200:203], v[160:163], v[184:187], v[200:203]
    ds_read_b64_tr_b16 v[132:133], v11 offset:0
    v_mfma_f32_16x16x32_bf16 v[204:207], v[160:163], v[188:191], v[204:207]
    ds_read_b64_tr_b16 v[134:135], v11 offset:4096
    v_mfma_f32_16x16x32_bf16 v[216:219], v[164:167], v[184:187], v[216:219]
    ds_read_b128 v[152:155], v9 offset:0
    v_mfma_f32_16x16x32_bf16 v[220:223], v[164:167], v[188:191], v[220:223]
    ds_read_b128 v[156:159], v9 offset:2048
    s_waitcnt lgkmcnt(8)
    v_mfma_f32_16x16x32_bf16 v[224:227], v[168:171], v[176:179], v[224:227]
    ds_read_b64_tr_b16 v[136:137], v12 offset:0
    v_mfma_f32_16x16x32_bf16 v[228:231], v[168:171], v[180:183], v[228:231]
    ds_read_b64_tr_b16 v[138:139], v12 offset:4096
    v_mfma_f32_16x16x32_bf16 v[232:235], v[168:171], v[184:187], v[232:235]
    ds_read_b64_tr_b16 v[140:141], v13 offset:0
    v_mfma_f32_16x16x32_bf16 v[236:239], v[168:171], v[188:191], v[236:239]
    ds_read_b64_tr_b16 v[142:143], v13 offset:4096
    v_mfma_f32_16x16x32_bf16 v[240:243], v[172:175], v[176:179], v[240:243]
    v_mfma_f32_16x16x32_bf16 v[244:247], v[172:175], v[180:183], v[244:247]
    v_mfma_f32_16x16x32_bf16 v[248:251], v[172:175], v[184:187], v[248:251]
    v_mfma_f32_16x16x32_bf16 v[252:255], v[172:175], v[188:191], v[252:255]
    s_mov_b32 s45, 4
L_g2loop:
    s_waitcnt lgkmcnt(4)
    v_mfma_f32_16x16x32_bf16 v[192:195], v[128:131], v[144:147], v[192:195]
    ds_read_b64_tr_b16 v[160:161], v10 offset:8192
    v_mfma_f32_16x16x32_bf16 v[196:199], v[128:131], v[148:151], v[196:199]
    ds_read_b64_tr_b16 v[162:163], v10 offset:12288
    v_mfma_f32_16x16x32_bf16 v[208:211], v[132:135], v[144:147], v[208:211]
    ds_read_b128 v[176:179], v8 offset:1024
    v_mfma_f32_16x16x32_bf16 v[212:215], v[132:135], v[148:151], v[212:215]
    ds_read_b128 v[180:183], v8 offset:3072
    v_mfma_f32_16x16x32_bf16 v[200:203], v[128:131], v[152:155], v[200:203]
    ds_read_b64_tr_b16 v[164:165], v11 offset:8192
    v_mfma_f32_16x16x32_bf16 v[204:207], v[128:131], v[156:159], v[204:207]
    ds_read_b64_tr_b16 v[166:167], v11 offset:12288
    v_mfma_f32_16x16x32_bf16 v[216:219], v[132:135], v[152:155], v[216:219]
    ds_read_b128 v[184:187], v9 offset:1024
    v_mfma_f32_16x16x32_bf16 v[220:223], v[132:135], v[156:159], v[220:223]
    ds_read_b128 v[188:191], v9 offset:3072
    s_waitcnt lgkmcnt(8)
    v_mfma_f32_16x16x32_bf16 v[224:227], v[136:139], v[144:147], v[224:227]
    ds_read_b64_tr_b16 v[168:169], v12 offset:8192
    v_mfma_f32_16x16x32_bf16 v[228:231], v[136:139], v[148:151], v[228:231]
    ds_read_b64_tr_b16 v[170:171], v12 offset:12288
    v_mfma_f32_16x16x32_bf16 v[232:235], v[136:139], v[152:155], v[232:235]
    ds_read_b64_tr_b16 v[172:173], v13 offset:8192
    v_mfma_f32_16x16x32_bf16 v[236:239], v[136:139], v[156:159], v[236:239]
    ds_read_b64_tr_b16 v[174:175], v13 offset:12288
    v_mfma_f32_16x16x32_bf16 v[240:243], v[140:143], v[144:147], v[240:243]
    v_mfma_f32_16x16x32_bf16 v[244:247], v[140:143], v[148:151], v[244:247]
    v_mfma_f32_16x16x32_bf16 v[248:251], v[140:143], v[152:155], v[248:251]
    v_mfma_f32_16x16x32_bf16 v[252:255], v[140:143], v[156:159], v[252:255]
    s_barrier
    s_waitcnt lgkmcnt(4)
    v_mfma_f32_16x16x32_bf16 v[192:195], v[160:163], v[176:179], v[192:195]
    ds_read_b64_tr_b16 v[128:129], v16 offset:0
    v_mfma_f32_16x16x32_bf16 v[196:199], v[160:163], v[180:183], v[196:199]
    ds_read_b64_tr_b16 v[130:131], v16 offset:4096
    v_mfma_f32_16x16x32_bf16 v[208:211], v[164:167], v[176:179], v[208:211]
    ds_read_b128 v[144:147], v14 offset:0
    v_mfma_f32_16x16x32_bf16 v[212:215], v[164:167], v[180:183], v[212:215]
    ds_read_b128 v[148:151], v14 offset:2048
    v_mfma_f32_16x16x32_bf16 v[200:203], v[160:163], v[184:187], v[200:203]
    ds_read_b64_tr_b16 v[132:133], v17 offset:0
    v_mfma_f32_16x16x32_bf16 v[204:207], v[160:163], v[188:191], v[204:207]
    ds_read_b64_tr_b16 v[134:135], v17 offset:4096
    v_mfma_f32_16x16x32_bf16 v[216:219], v[164:167], v[184:187], v[216:219]
    ds_read_b128 v[152:155], v15 offset:0
    v_mfma_f32_16x16x32_bf16 v[220:223], v[164:167], v[188:191], v[220:223]
    ds_read_b128 v[156:159], v15 offset:2048
    s_waitcnt lgkmcnt(8)
    v_mfma_f32_16x16x32_bf16 v[224:227], v[168:171], v[176:179], v[224:227]
    ds_read_b64_tr_b16 v[136:137], v18 offset:0
    v_mfma_f32_16x16x32_bf16 v[228:231], v[168:171], v[180:183], v[228:231]
    ds_read_b64_tr_b16 v[138:139], v18 offset:4096
    v_mfma_f32_16x16x32_bf16 v[232:235], v[168:171], v[184:187], v[232:235]
    ds_read_b64_tr_b16 v[140:141], v19 offset:0
    v_mfma_f32_16x16x32_bf16 v[236:239], v[168:171], v[188:191], v[236:239]
    ds_read_b64_tr_b16 v[142:143], v19 offset:4096
    v_mfma_f32_16x16x32_bf16 v[240:243], v[172:175], v[176:179], v[240:243]
    v_mfma_f32_16x16x32_bf16 v[244:247], v[172:175], v[180:183], v[244:247]
    v_mfma_f32_16x16x32_bf16 v[248:251], v[172:175], v[184:187], v[248:251]
    v_mfma_f32_16x16x32_bf16 v[252:255], v[172:175], v[188:191], v[252:255]
    s_waitcnt lgkmcnt(4)
    v_mfma_f32_16x16x32_bf16 v[192:195], v[128:131], v[144:147], v[192:195]
    ds_read_b64_tr_b16 v[160:161], v16 offset:8192
    v_mfma_f32_16x16x32_bf16 v[196:199], v[128:131], v[148:151], v[196:199]
    ds_read_b64_tr_b16 v[162:163], v16 offset:12288
    v_mfma_f32_16x16x32_bf16 v[208:211], v[132:135], v[144:147], v[208:211]
    ds_read_b128 v[176:179], v14 offset:1024
    v_mfma_f32_16x16x32_bf16 v[212:215], v[132:135], v[148:151], v[212:215]
    ds_read_b128 v[180:183], v14 offset:3072
    v_mfma_f32_16x16x32_bf16 v[200:203], v[128:131], v[152:155], v[200:203]
    ds_read_b64_tr_b16 v[164:165], v17 offset:8192
    v_mfma_f32_16x16x32_bf16 v[204:207], v[128:131], v[156:159], v[204:207]
    ds_read_b64_tr_b16 v[166:167], v17 offset:12288
    v_mfma_f32_16x16x32_bf16 v[216:219], v[132:135], v[152:155], v[216:219]
    ds_read_b128 v[184:187], v15 offset:1024
    v_mfma_f32_16x16x32_bf16 v[220:223], v[132:135], v[156:159], v[220:223]
    ds_read_b128 v[188:191], v15 offset:3072
    s_waitcnt lgkmcnt(8)
    v_mfma_f32_16x16x32_bf16 v[224:227], v[136:139], v[144:147], v[224:227]
    ds_read_b64_tr_b16 v[168:169], v18 offset:8192
    v_mfma_f32_16x16x32_bf16 v[228:231], v[136:139], v[148:151], v[228:231]
    ds_read_b64_tr_b16 v[170:171], v18 offset:12288
    v_mfma_f32_16x16x32_bf16 v[232:235], v[136:139], v[152:155], v[232:235]
    ds_read_b64_tr_b16 v[172:173], v19 offset:8192
    v_mfma_f32_16x16x32_bf16 v[236:239], v[136:139], v[156:159], v[236:239]
    ds_read_b64_tr_b16 v[174:175], v19 offset:12288
    v_mfma_f32_16x16x32_bf16 v[240:243], v[140:143], v[144:147], v[240:243]
    v_mfma_f32_16x16x32_bf16 v[244:247], v[140:143], v[148:151], v[244:247]
    v_mfma_f32_16x16x32_bf16 v[248:251], v[140:143], v[152:155], v[248:251]
    v_mfma_f32_16x16x32_bf16 v[252:255], v[140:143], v[156:159], v[252:255]
    s_barrier
    s_waitcnt lgkmcnt(4)
    v_mfma_f32_16x16x32_bf16 v[192:195], v[160:163], v[176:179], v[192:195]
    ds_read_b64_tr_b16 v[128:129], v22 offset:0
    v_mfma_f32_16x16x32_bf16 v[196:199], v[160:163], v[180:183], v[196:199]
    ds_read_b64_tr_b16 v[130:131], v22 offset:4096
    v_mfma_f32_16x16x32_bf16 v[208:211], v[164:167], v[176:179], v[208:211]
    ds_read_b128 v[144:147], v20 offset:0
    v_mfma_f32_16x16x32_bf16 v[212:215], v[164:167], v[180:183], v[212:215]
    ds_read_b128 v[148:151], v20 offset:2048
    v_mfma_f32_16x16x32_bf16 v[200:203], v[160:163], v[184:187], v[200:203]
    ds_read_b64_tr_b16 v[132:133], v23 offset:0
    v_mfma_f32_16x16x32_bf16 v[204:207], v[160:163], v[188:191], v[204:207]
    ds_read_b64_tr_b16 v[134:135], v23 offset:4096
    v_mfma_f32_16x16x32_bf16 v[216:219], v[164:167], v[184:187], v[216:219]
    ds_read_b128 v[152:155], v21 offset:0
    v_mfma_f32_16x16x32_bf16 v[220:223], v[164:167], v[188:191], v[220:223]
    ds_read_b128 v[156:159], v21 offset:2048
    s_waitcnt lgkmcnt(8)
    v_mfma_f32_16x16x32_bf16 v[224:227], v[168:171], v[176:179], v[224:227]
    ds_read_b64_tr_b16 v[136:137], v24 offset:0
    v_mfma_f32_16x16x32_bf16 v[228:231], v[168:171], v[180:183], v[228:231]
    ds_read_b64_tr_b16 v[138:139], v24 offset:4096
    v_mfma_f32_16x16x32_bf16 v[232:235], v[168:171], v[184:187], v[232:235]
    ds_read_b64_tr_b16 v[140:141], v25 offset:0
    v_mfma_f32_16x16x32_bf16 v[236:239], v[168:171], v[188:191], v[236:239]
    ds_read_b64_tr_b16 v[142:143], v25 offset:4096
    v_mfma_f32_16x16x32_bf16 v[240:243], v[172:175], v[176:179], v[240:243]
    v_mfma_f32_16x16x32_bf16 v[244:247], v[172:175], v[180:183], v[244:247]
    v_mfma_f32_16x16x32_bf16 v[248:251], v[172:175], v[184:187], v[248:251]
    v_mfma_f32_16x16x32_bf16 v[252:255], v[172:175], v[188:191], v[252:255]
    s_waitcnt lgkmcnt(4)
    v_mfma_f32_16x16x32_bf16 v[192:195], v[128:131], v[144:147], v[192:195]
    ds_read_b64_tr_b16 v[160:161], v22 offset:8192
    v_mfma_f32_16x16x32_bf16 v[196:199], v[128:131], v[148:151], v[196:199]
    ds_read_b64_tr_b16 v[162:163], v22 offset:12288
    v_mfma_f32_16x16x32_bf16 v[208:211], v[132:135], v[144:147], v[208:211]
    ds_read_b128 v[176:179], v20 offset:1024
    v_mfma_f32_16x16x32_bf16 v[212:215], v[132:135], v[148:151], v[212:215]
    ds_read_b128 v[180:183], v20 offset:3072
    v_mfma_f32_16x16x32_bf16 v[200:203], v[128:131], v[152:155], v[200:203]
    ds_read_b64_tr_b16 v[164:165], v23 offset:8192
    v_mfma_f32_16x16x32_bf16 v[204:207], v[128:131], v[156:159], v[204:207]
    ds_read_b64_tr_b16 v[166:167], v23 offset:12288
    v_mfma_f32_16x16x32_bf16 v[216:219], v[132:135], v[152:155], v[216:219]
    ds_read_b128 v[184:187], v21 offset:1024
    v_mfma_f32_16x16x32_bf16 v[220:223], v[132:135], v[156:159], v[220:223]
    ds_read_b128 v[188:191], v21 offset:3072
    s_waitcnt lgkmcnt(8)
    v_mfma_f32_16x16x32_bf16 v[224:227], v[136:139], v[144:147], v[224:227]
    ds_read_b64_tr_b16 v[168:169], v24 offset:8192
    v_mfma_f32_16x16x32_bf16 v[228:231], v[136:139], v[148:151], v[228:231]
    ds_read_b64_tr_b16 v[170:171], v24 offset:12288
    v_mfma_f32_16x16x32_bf16 v[232:235], v[136:139], v[152:155], v[232:235]
    ds_read_b64_tr_b16 v[172:173], v25 offset:8192
    v_mfma_f32_16x16x32_bf16 v[236:239], v[136:139], v[156:159], v[236:239]
    ds_read_b64_tr_b16 v[174:175], v25 offset:12288
    v_mfma_f32_16x16x32_bf16 v[240:243], v[140:143], v[144:147], v[240:243]
    v_mfma_f32_16x16x32_bf16 v[244:247], v[140:143], v[148:151], v[244:247]
    v_mfma_f32_16x16x32_bf16 v[248:251], v[140:143], v[152:155], v[248:251]
    v_mfma_f32_16x16x32_bf16 v[252:255], v[140:143], v[156:159], v[252:255]
    s_barrier
    s_waitcnt lgkmcnt(4)
    v_mfma_f32_16x16x32_bf16 v[192:195], v[160:163], v[176:179], v[192:195]
    ds_read_b64_tr_b16 v[128:129], v28 offset:0
    v_mfma_f32_16x16x32_bf16 v[196:199], v[160:163], v[180:183], v[196:199]
    ds_read_b64_tr_b16 v[130:131], v28 offset:4096
    v_mfma_f32_16x16x32_bf16 v[208:211], v[164:167], v[176:179], v[208:211]
    ds_read_b128 v[144:147], v26 offset:0
    v_mfma_f32_16x16x32_bf16 v[212:215], v[164:167], v[180:183], v[212:215]
    ds_read_b128 v[148:151], v26 offset:2048
    v_mfma_f32_16x16x32_bf16 v[200:203], v[160:163], v[184:187], v[200:203]
    ds_read_b64_tr_b16 v[132:133], v29 offset:0
    v_mfma_f32_16x16x32_bf16 v[204:207], v[160:163], v[188:191], v[204:207]
    ds_read_b64_tr_b16 v[134:135], v29 offset:4096
    v_mfma_f32_16x16x32_bf16 v[216:219], v[164:167], v[184:187], v[216:219]
    ds_read_b128 v[152:155], v27 offset:0
    v_mfma_f32_16x16x32_bf16 v[220:223], v[164:167], v[188:191], v[220:223]
    ds_read_b128 v[156:159], v27 offset:2048
    s_waitcnt lgkmcnt(8)
    v_mfma_f32_16x16x32_bf16 v[224:227], v[168:171], v[176:179], v[224:227]
    ds_read_b64_tr_b16 v[136:137], v30 offset:0
    v_mfma_f32_16x16x32_bf16 v[228:231], v[168:171], v[180:183], v[228:231]
    ds_read_b64_tr_b16 v[138:139], v30 offset:4096
    v_mfma_f32_16x16x32_bf16 v[232:235], v[168:171], v[184:187], v[232:235]
    ds_read_b64_tr_b16 v[140:141], v31 offset:0
    v_mfma_f32_16x16x32_bf16 v[236:239], v[168:171], v[188:191], v[236:239]
    ds_read_b64_tr_b16 v[142:143], v31 offset:4096
    v_mfma_f32_16x16x32_bf16 v[240:243], v[172:175], v[176:179], v[240:243]
    v_mfma_f32_16x16x32_bf16 v[244:247], v[172:175], v[180:183], v[244:247]
    v_mfma_f32_16x16x32_bf16 v[248:251], v[172:175], v[184:187], v[248:251]
    v_mfma_f32_16x16x32_bf16 v[252:255], v[172:175], v[188:191], v[252:255]
    s_waitcnt lgkmcnt(4)
    v_mfma_f32_16x16x32_bf16 v[192:195], v[128:131], v[144:147], v[192:195]
    ds_read_b64_tr_b16 v[160:161], v28 offset:8192
    v_mfma_f32_16x16x32_bf16 v[196:199], v[128:131], v[148:151], v[196:199]
    ds_read_b64_tr_b16 v[162:163], v28 offset:12288
    v_mfma_f32_16x16x32_bf16 v[208:211], v[132:135], v[144:147], v[208:211]
    ds_read_b128 v[176:179], v26 offset:1024
    v_mfma_f32_16x16x32_bf16 v[212:215], v[132:135], v[148:151], v[212:215]
    ds_read_b128 v[180:183], v26 offset:3072
    v_mfma_f32_16x16x32_bf16 v[200:203], v[128:131], v[152:155], v[200:203]
    ds_read_b64_tr_b16 v[164:165], v29 offset:8192
    v_mfma_f32_16x16x32_bf16 v[204:207], v[128:131], v[156:159], v[204:207]
    ds_read_b64_tr_b16 v[166:167], v29 offset:12288
    v_mfma_f32_16x16x32_bf16 v[216:219], v[132:135], v[152:155], v[216:219]
    ds_read_b128 v[184:187], v27 offset:1024
    v_mfma_f32_16x16x32_bf16 v[220:223], v[132:135], v[156:159], v[220:223]
    ds_read_b128 v[188:191], v27 offset:3072
    s_waitcnt lgkmcnt(8)
    v_mfma_f32_16x16x32_bf16 v[224:227], v[136:139], v[144:147], v[224:227]
    ds_read_b64_tr_b16 v[168:169], v30 offset:8192
    v_mfma_f32_16x16x32_bf16 v[228:231], v[136:139], v[148:151], v[228:231]
    ds_read_b64_tr_b16 v[170:171], v30 offset:12288
    v_mfma_f32_16x16x32_bf16 v[232:235], v[136:139], v[152:155], v[232:235]
    ds_read_b64_tr_b16 v[172:173], v31 offset:8192
    v_mfma_f32_16x16x32_bf16 v[236:239], v[136:139], v[156:159], v[236:239]
    ds_read_b64_tr_b16 v[174:175], v31 offset:12288
    v_mfma_f32_16x16x32_bf16 v[240:243], v[140:143], v[144:147], v[240:243]
    v_mfma_f32_16x16x32_bf16 v[244:247], v[140:143], v[148:151], v[244:247]
    v_mfma_f32_16x16x32_bf16 v[248:251], v[140:143], v[152:155], v[248:251]
    v_mfma_f32_16x16x32_bf16 v[252:255], v[140:143], v[156:159], v[252:255]
    s_barrier
    s_waitcnt lgkmcnt(4)
    v_mfma_f32_16x16x32_bf16 v[192:195], v[160:163], v[176:179], v[192:195]
    ds_read_b64_tr_b16 v[128:129], v34 offset:0
    v_mfma_f32_16x16x32_bf16 v[196:199], v[160:163], v[180:183], v[196:199]
    ds_read_b64_tr_b16 v[130:131], v34 offset:4096
    v_mfma_f32_16x16x32_bf16 v[208:211], v[164:167], v[176:179], v[208:211]
    ds_read_b128 v[144:147], v32 offset:0
    v_mfma_f32_16x16x32_bf16 v[212:215], v[164:167], v[180:183], v[212:215]
    ds_read_b128 v[148:151], v32 offset:2048
    v_mfma_f32_16x16x32_bf16 v[200:203], v[160:163], v[184:187], v[200:203]
    ds_read_b64_tr_b16 v[132:133], v35 offset:0
    v_mfma_f32_16x16x32_bf16 v[204:207], v[160:163], v[188:191], v[204:207]
    ds_read_b64_tr_b16 v[134:135], v35 offset:4096
    v_mfma_f32_16x16x32_bf16 v[216:219], v[164:167], v[184:187], v[216:219]
    ds_read_b128 v[152:155], v33 offset:0
    v_mfma_f32_16x16x32_bf16 v[220:223], v[164:167], v[188:191], v[220:223]
    ds_read_b128 v[156:159], v33 offset:2048
    s_waitcnt lgkmcnt(8)
    v_mfma_f32_16x16x32_bf16 v[224:227], v[168:171], v[176:179], v[224:227]
    ds_read_b64_tr_b16 v[136:137], v36 offset:0
    v_mfma_f32_16x16x32_bf16 v[228:231], v[168:171], v[180:183], v[228:231]
    ds_read_b64_tr_b16 v[138:139], v36 offset:4096
    v_mfma_f32_16x16x32_bf16 v[232:235], v[168:171], v[184:187], v[232:235]
    ds_read_b64_tr_b16 v[140:141], v37 offset:0
    v_mfma_f32_16x16x32_bf16 v[236:239], v[168:171], v[188:191], v[236:239]
    ds_read_b64_tr_b16 v[142:143], v37 offset:4096
    v_mfma_f32_16x16x32_bf16 v[240:243], v[172:175], v[176:179], v[240:243]
    v_mfma_f32_16x16x32_bf16 v[244:247], v[172:175], v[180:183], v[244:247]
    v_mfma_f32_16x16x32_bf16 v[248:251], v[172:175], v[184:187], v[248:251]
    v_mfma_f32_16x16x32_bf16 v[252:255], v[172:175], v[188:191], v[252:255]
    s_waitcnt lgkmcnt(4)
    v_mfma_f32_16x16x32_bf16 v[192:195], v[128:131], v[144:147], v[192:195]
    ds_read_b64_tr_b16 v[160:161], v34 offset:8192
    v_mfma_f32_16x16x32_bf16 v[196:199], v[128:131], v[148:151], v[196:199]
    ds_read_b64_tr_b16 v[162:163], v34 offset:12288
    v_mfma_f32_16x16x32_bf16 v[208:211], v[132:135], v[144:147], v[208:211]
    ds_read_b128 v[176:179], v32 offset:1024
    v_mfma_f32_16x16x32_bf16 v[212:215], v[132:135], v[148:151], v[212:215]
    ds_read_b128 v[180:183], v32 offset:3072
    v_mfma_f32_16x16x32_bf16 v[200:203], v[128:131], v[152:155], v[200:203]
    ds_read_b64_tr_b16 v[164:165], v35 offset:8192
    v_mfma_f32_16x16x32_bf16 v[204:207], v[128:131], v[156:159], v[204:207]
    ds_read_b64_tr_b16 v[166:167], v35 offset:12288
    v_mfma_f32_16x16x32_bf16 v[216:219], v[132:135], v[152:155], v[216:219]
    ds_read_b128 v[184:187], v33 offset:1024
    v_mfma_f32_16x16x32_bf16 v[220:223], v[132:135], v[156:159], v[220:223]
    ds_read_b128 v[188:191], v33 offset:3072
    s_waitcnt lgkmcnt(8)
    v_mfma_f32_16x16x32_bf16 v[224:227], v[136:139], v[144:147], v[224:227]
    ds_read_b64_tr_b16 v[168:169], v36 offset:8192
    v_mfma_f32_16x16x32_bf16 v[228:231], v[136:139], v[148:151], v[228:231]
    ds_read_b64_tr_b16 v[170:171], v36 offset:12288
    v_mfma_f32_16x16x32_bf16 v[232:235], v[136:139], v[152:155], v[232:235]
    ds_read_b64_tr_b16 v[172:173], v37 offset:8192
    v_mfma_f32_16x16x32_bf16 v[236:239], v[136:139], v[156:159], v[236:239]
    ds_read_b64_tr_b16 v[174:175], v37 offset:12288
    v_mfma_f32_16x16x32_bf16 v[240:243], v[140:143], v[144:147], v[240:243]
    v_mfma_f32_16x16x32_bf16 v[244:247], v[140:143], v[148:151], v[244:247]
    v_mfma_f32_16x16x32_bf16 v[248:251], v[140:143], v[152:155], v[248:251]
    v_mfma_f32_16x16x32_bf16 v[252:255], v[140:143], v[156:159], v[252:255]
    s_barrier
    s_waitcnt lgkmcnt(4)
    v_mfma_f32_16x16x32_bf16 v[192:195], v[160:163], v[176:179], v[192:195]
    ds_read_b64_tr_b16 v[128:129], v10 offset:0
    v_mfma_f32_16x16x32_bf16 v[196:199], v[160:163], v[180:183], v[196:199]
    ds_read_b64_tr_b16 v[130:131], v10 offset:4096
    v_mfma_f32_16x16x32_bf16 v[208:211], v[164:167], v[176:179], v[208:211]
    ds_read_b128 v[144:147], v8 offset:0
    v_mfma_f32_16x16x32_bf16 v[212:215], v[164:167], v[180:183], v[212:215]
    ds_read_b128 v[148:151], v8 offset:2048
    v_mfma_f32_16x16x32_bf16 v[200:203], v[160:163], v[184:187], v[200:203]
    ds_read_b64_tr_b16 v[132:133], v11 offset:0
    v_mfma_f32_16x16x32_bf16 v[204:207], v[160:163], v[188:191], v[204:207]
    ds_read_b64_tr_b16 v[134:135], v11 offset:4096
    v_mfma_f32_16x16x32_bf16 v[216:219], v[164:167], v[184:187], v[216:219]
    ds_read_b128 v[152:155], v9 offset:0
    v_mfma_f32_16x16x32_bf16 v[220:223], v[164:167], v[188:191], v[220:223]
    ds_read_b128 v[156:159], v9 offset:2048
    s_waitcnt lgkmcnt(8)
    v_mfma_f32_16x16x32_bf16 v[224:227], v[168:171], v[176:179], v[224:227]
    ds_read_b64_tr_b16 v[136:137], v12 offset:0
    v_mfma_f32_16x16x32_bf16 v[228:231], v[168:171], v[180:183], v[228:231]
    ds_read_b64_tr_b16 v[138:139], v12 offset:4096
    v_mfma_f32_16x16x32_bf16 v[232:235], v[168:171], v[184:187], v[232:235]
    ds_read_b64_tr_b16 v[140:141], v13 offset:0
    v_mfma_f32_16x16x32_bf16 v[236:239], v[168:171], v[188:191], v[236:239]
    ds_read_b64_tr_b16 v[142:143], v13 offset:4096
    v_mfma_f32_16x16x32_bf16 v[240:243], v[172:175], v[176:179], v[240:243]
    s_sub_u32 s45, s45, 1
    v_mfma_f32_16x16x32_bf16 v[244:247], v[172:175], v[180:183], v[244:247]
    s_cmp_lg_u32 s45, 0
    v_mfma_f32_16x16x32_bf16 v[248:251], v[172:175], v[184:187], v[248:251]
    v_mfma_f32_16x16x32_bf16 v[252:255], v[172:175], v[188:191], v[252:255]
    s_cbranch_scc1 L_g2loop
    s_waitcnt lgkmcnt(4)
    v_mfma_f32_16x16x32_bf16 v[200:203], v[128:131], v[152:155], v[200:203]
    ds_read_b64_tr_b16 v[160:161], v10 offset:8192
    ds_read_b64_tr_b16 v[162:163], v10 offset:12288
    v_mfma_f32_16x16x32_bf16 v[204:207], v[128:131], v[156:159], v[204:207]
    ds_read_b128 v[184:187], v9 offset:1024
    ds_read_b64_tr_b16 v[164:165], v11 offset:8192
    v_mfma_f32_16x16x32_bf16 v[216:219], v[132:135], v[152:155], v[216:219]
    ds_read_b64_tr_b16 v[166:167], v11 offset:12288
    v_mfma_f32_16x16x32_bf16 v[220:223], v[132:135], v[156:159], v[220:223]
    ds_read_b128 v[188:191], v9 offset:3072
    s_waitcnt lgkmcnt(6)
    v_mfma_f32_16x16x32_bf16 v[232:235], v[136:139], v[152:155], v[232:235]
    ds_read_b64_tr_b16 v[168:169], v12 offset:8192
    v_mfma_f32_16x16x32_bf16 v[236:239], v[136:139], v[156:159], v[236:239]
    ds_read_b64_tr_b16 v[170:171], v12 offset:12288
    v_mfma_f32_16x16x32_bf16 v[248:251], v[140:143], v[152:155], v[248:251]
    ds_read_b64_tr_b16 v[172:173], v13 offset:8192
    v_mfma_f32_16x16x32_bf16 v[252:255], v[140:143], v[156:159], v[252:255]
    ds_read_b64_tr_b16 v[174:175], v13 offset:12288
    s_barrier
    s_waitcnt lgkmcnt(4)
    v_mfma_f32_16x16x32_bf16 v[200:203], v[160:163], v[184:187], v[200:203]
    ds_read_b64_tr_b16 v[128:129], v16 offset:0
    ds_read_b64_tr_b16 v[130:131], v16 offset:4096
    v_mfma_f32_16x16x32_bf16 v[204:207], v[160:163], v[188:191], v[204:207]
    ds_read_b128 v[152:155], v15 offset:0
    ds_read_b64_tr_b16 v[132:133], v17 offset:0
    v_mfma_f32_16x16x32_bf16 v[216:219], v[164:167], v[184:187], v[216:219]
    ds_read_b64_tr_b16 v[134:135], v17 offset:4096
    v_mfma_f32_16x16x32_bf16 v[220:223], v[164:167], v[188:191], v[220:223]
    ds_read_b128 v[156:159], v15 offset:2048
    s_waitcnt lgkmcnt(6)
    v_mfma_f32_16x16x32_bf16 v[232:235], v[168:171], v[184:187], v[232:235]
    ds_read_b64_tr_b16 v[136:137], v18 offset:0
    v_mfma_f32_16x16x32_bf16 v[236:239], v[168:171], v[188:191], v[236:239]
    ds_read_b64_tr_b16 v[138:139], v18 offset:4096
    v_mfma_f32_16x16x32_bf16 v[248:251], v[172:175], v[184:187], v[248:251]
    ds_read_b64_tr_b16 v[140:141], v19 offset:0
    v_mfma_f32_16x16x32_bf16 v[252:255], v[172:175], v[188:191], v[252:255]
    ds_read_b64_tr_b16 v[142:143], v19 offset:4096
    s_waitcnt lgkmcnt(4)
    v_mfma_f32_16x16x32_bf16 v[200:203], v[128:131], v[152:155], v[200:203]
    ds_read_b64_tr_b16 v[160:161], v16 offset:8192
    ds_read_b64_tr_b16 v[162:163], v16 offset:12288
    v_mfma_f32_16x16x32_bf16 v[204:207], v[128:131], v[156:159], v[204:207]
    ds_read_b128 v[184:187], v15 offset:1024
    ds_read_b64_tr_b16 v[164:165], v17 offset:8192
    v_mfma_f32_16x16x32_bf16 v[216:219], v[132:135], v[152:155], v[216:219]
    ds_read_b64_tr_b16 v[166:167], v17 offset:12288
    v_mfma_f32_16x16x32_bf16 v[220:223], v[132:135], v[156:159], v[220:223]
    ds_read_b128 v[188:191], v15 offset:3072
    s_waitcnt lgkmcnt(6)
    v_mfma_f32_16x16x32_bf16 v[232:235], v[136:139], v[152:155], v[232:235]
    ds_read_b64_tr_b16 v[168:169], v18 offset:8192
    v_mfma_f32_16x16x32_bf16 v[236:239], v[136:139], v[156:159], v[236:239]
    ds_read_b64_tr_b16 v[170:171], v18 offset:12288
    v_mfma_f32_16x16x32_bf16 v[248:251], v[140:143], v[152:155], v[248:251]
    ds_read_b64_tr_b16 v[172:173], v19 offset:8192
    v_mfma_f32_16x16x32_bf16 v[252:255], v[140:143], v[156:159], v[252:255]
    ds_read_b64_tr_b16 v[174:175], v19 offset:12288
    s_barrier
    s_waitcnt lgkmcnt(4)
    v_mfma_f32_16x16x32_bf16 v[200:203], v[160:163], v[184:187], v[200:203]
    ds_read_b64_tr_b16 v[128:129], v22 offset:0
    ds_read_b64_tr_b16 v[130:131], v22 offset:4096
    v_mfma_f32_16x16x32_bf16 v[204:207], v[160:163], v[188:191], v[204:207]
    ds_read_b128 v[152:155], v21 offset:0
    ds_read_b64_tr_b16 v[132:133], v23 offset:0
    v_mfma_f32_16x16x32_bf16 v[216:219], v[164:167], v[184:187], v[216:219]
    ds_read_b64_tr_b16 v[134:135], v23 offset:4096
    v_mfma_f32_16x16x32_bf16 v[220:223], v[164:167], v[188:191], v[220:223]
    ds_read_b128 v[156:159], v21 offset:2048
    s_waitcnt lgkmcnt(6)
    v_mfma_f32_16x16x32_bf16 v[232:235], v[168:171], v[184:187], v[232:235]
    ds_read_b64_tr_b16 v[136:137], v24 offset:0
    v_mfma_f32_16x16x32_bf16 v[236:239], v[168:171], v[188:191], v[236:239]
    ds_read_b64_tr_b16 v[138:139], v24 offset:4096
    v_mfma_f32_16x16x32_bf16 v[248:251], v[172:175], v[184:187], v[248:251]
    ds_read_b64_tr_b16 v[140:141], v25 offset:0
    v_mfma_f32_16x16x32_bf16 v[252:255], v[172:175], v[188:191], v[252:255]
    ds_read_b64_tr_b16 v[142:143], v25 offset:4096
    s_waitcnt lgkmcnt(4)
    v_mfma_f32_16x16x32_bf16 v[200:203], v[128:131], v[152:155], v[200:203]
    ds_read_b64_tr_b16 v[160:161], v22 offset:8192
    ds_read_b64_tr_b16 v[162:163], v22 offset:12288
    v_mfma_f32_16x16x32_bf16 v[204:207], v[128:131], v[156:159], v[204:207]
    ds_read_b128 v[184:187], v21 offset:1024
    ds_read_b64_tr_b16 v[164:165], v23 offset:8192
    v_mfma_f32_16x16x32_bf16 v[216:219], v[132:135], v[152:155], v[216:219]
    ds_read_b64_tr_b16 v[166:167], v23 offset:12288
    v_mfma_f32_16x16x32_bf16 v[220:223], v[132:135], v[156:159], v[220:223]
    ds_read_b128 v[188:191], v21 offset:3072
    s_waitcnt lgkmcnt(6)
    v_mfma_f32_16x16x32_bf16 v[232:235], v[136:139], v[152:155], v[232:235]
    ds_read_b64_tr_b16 v[168:169], v24 offset:8192
    v_mfma_f32_16x16x32_bf16 v[236:239], v[136:139], v[156:159], v[236:239]
    ds_read_b64_tr_b16 v[170:171], v24 offset:12288
    v_mfma_f32_16x16x32_bf16 v[248:251], v[140:143], v[152:155], v[248:251]
    ds_read_b64_tr_b16 v[172:173], v25 offset:8192
    v_mfma_f32_16x16x32_bf16 v[252:255], v[140:143], v[156:159], v[252:255]
    ds_read_b64_tr_b16 v[174:175], v25 offset:12288
    s_waitcnt lgkmcnt(4)
    v_mfma_f32_16x16x32_bf16 v[200:203], v[160:163], v[184:187], v[200:203]
    ds_read_b64_tr_b16 v[128:129], v10 offset:0
    ds_read_b64_tr_b16 v[130:131], v10 offset:4096
    v_mfma_f32_16x16x32_bf16 v[204:207], v[160:163], v[188:191], v[204:207]
    ds_read_b128 v[144:147], v8 offset:0
    ds_read_b64_tr_b16 v[132:133], v11 offset:0
    v_mfma_f32_16x16x32_bf16 v[216:219], v[164:167], v[184:187], v[216:219]
    ds_read_b64_tr_b16 v[134:135], v11 offset:4096
    v_mfma_f32_16x16x32_bf16 v[220:223], v[164:167], v[188:191], v[220:223]
    ds_read_b128 v[148:151], v8 offset:2048
    s_waitcnt lgkmcnt(6)
    v_mfma_f32_16x16x32_bf16 v[232:235], v[168:171], v[184:187], v[232:235]
    ds_read_b64_tr_b16 v[136:137], v12 offset:0
    v_mfma_f32_16x16x32_bf16 v[236:239], v[168:171], v[188:191], v[236:239]
    ds_read_b64_tr_b16 v[138:139], v12 offset:4096
    v_mfma_f32_16x16x32_bf16 v[248:251], v[172:175], v[184:187], v[248:251]
    ds_read_b64_tr_b16 v[140:141], v13 offset:0
    v_mfma_f32_16x16x32_bf16 v[252:255], v[172:175], v[188:191], v[252:255]
    ds_read_b64_tr_b16 v[142:143], v13 offset:4096
    s_waitcnt lgkmcnt(4)
    v_mfma_f32_16x16x32_bf16 v[192:195], v[128:131], v[144:147], v[192:195]
    ds_read_b64_tr_b16 v[160:161], v10 offset:8192
    ds_read_b64_tr_b16 v[162:163], v10 offset:12288
    v_mfma_f32_16x16x32_bf16 v[196:199], v[128:131], v[148:151], v[196:199]
    ds_read_b128 v[176:179], v8 offset:1024
    ds_read_b64_tr_b16 v[164:165], v11 offset:8192
    v_mfma_f32_16x16x32_bf16 v[208:211], v[132:135], v[144:147], v[208:211]
    ds_read_b64_tr_b16 v[166:167], v11 offset:12288
    v_mfma_f32_16x16x32_bf16 v[212:215], v[132:135], v[148:151], v[212:215]
    ds_read_b128 v[180:183], v8 offset:3072
    s_waitcnt lgkmcnt(6)
    v_mfma_f32_16x16x32_bf16 v[224:227], v[136:139], v[144:147], v[224:227]
    ds_read_b64_tr_b16 v[168:169], v12 offset:8192
    v_mfma_f32_16x16x32_bf16 v[228:231], v[136:139], v[148:151], v[228:231]
    ds_read_b64_tr_b16 v[170:171], v12 offset:12288
    v_mfma_f32_16x16x32_bf16 v[240:243], v[140:143], v[144:147], v[240:243]
    ds_read_b64_tr_b16 v[172:173], v13 offset:8192
    v_mfma_f32_16x16x32_bf16 v[244:247], v[140:143], v[148:151], v[244:247]
    ds_read_b64_tr_b16 v[174:175], v13 offset:12288
    s_waitcnt lgkmcnt(4)
    v_mfma_f32_16x16x32_bf16 v[192:195], v[160:163], v[176:179], v[192:195]
    ds_read_b64_tr_b16 v[128:129], v16 offset:0
    ds_read_b64_tr_b16 v[130:131], v16 offset:4096
    v_mfma_f32_16x16x32_bf16 v[196:199], v[160:163], v[180:183], v[196:199]
    ds_read_b128 v[144:147], v14 offset:0
    ds_read_b64_tr_b16 v[132:133], v17 offset:0
    v_mfma_f32_16x16x32_bf16 v[208:211], v[164:167], v[176:179], v[208:211]
    ds_read_b64_tr_b16 v[134:135], v17 offset:4096
    v_mfma_f32_16x16x32_bf16 v[212:215], v[164:167], v[180:183], v[212:215]
    ds_read_b128 v[148:151], v14 offset:2048
    s_waitcnt lgkmcnt(6)
    v_mfma_f32_16x16x32_bf16 v[224:227], v[168:171], v[176:179], v[224:227]
    ds_read_b64_tr_b16 v[136:137], v18 offset:0
    v_mfma_f32_16x16x32_bf16 v[228:231], v[168:171], v[180:183], v[228:231]
    ds_read_b64_tr_b16 v[138:139], v18 offset:4096
    v_mfma_f32_16x16x32_bf16 v[240:243], v[172:175], v[176:179], v[240:243]
    ds_read_b64_tr_b16 v[140:141], v19 offset:0
    v_cvt_pk_bf16_f32 v72, v200, v201
    v_cvt_pk_bf16_f32 v73, v202, v203
    v_cvt_pk_bf16_f32 v74, v216, v217
    v_cvt_pk_bf16_f32 v75, v218, v219
    buffer_store_dwordx4 v[72:75], v55, s[20:23], s44 offen offset:0 sc1
    v_mfma_f32_16x16x32_bf16 v[244:247], v[172:175], v[180:183], v[244:247]
    ds_read_b64_tr_b16 v[142:143], v19 offset:4096
    s_waitcnt lgkmcnt(4)
    v_mfma_f32_16x16x32_bf16 v[192:195], v[128:131], v[144:147], v[192:195]
    ds_read_b64_tr_b16 v[160:161], v16 offset:8192
    ds_read_b64_tr_b16 v[162:163], v16 offset:12288
    v_mfma_f32_16x16x32_bf16 v[196:199], v[128:131], v[148:151], v[196:199]
    ds_read_b128 v[176:179], v14 offset:1024
    ds_read_b64_tr_b16 v[164:165], v17 offset:8192
    v_mfma_f32_16x16x32_bf16 v[208:211], v[132:135], v[144:147], v[208:211]
    ds_read_b64_tr_b16 v[166:167], v17 offset:12288
    v_mfma_f32_16x16x32_bf16 v[212:215], v[132:135], v[148:151], v[212:215]
    ds_read_b128 v[180:183], v14 offset:3072
    s_waitcnt lgkmcnt(6)
    v_mfma_f32_16x16x32_bf16 v[224:227], v[136:139], v[144:147], v[224:227]
    ds_read_b64_tr_b16 v[168:169], v18 offset:8192
    v_mfma_f32_16x16x32_bf16 v[228:231], v[136:139], v[148:151], v[228:231]
    ds_read_b64_tr_b16 v[170:171], v18 offset:12288
    v_mfma_f32_16x16x32_bf16 v[240:243], v[140:143], v[144:147], v[240:243]
    ds_read_b64_tr_b16 v[172:173], v19 offset:8192
    v_cvt_pk_bf16_f32 v76, v232, v233
    v_cvt_pk_bf16_f32 v77, v234, v235
    v_cvt_pk_bf16_f32 v78, v248, v249
    v_cvt_pk_bf16_f32 v79, v250, v251
    buffer_store_dwordx4 v[76:79], v55, s[20:23], s44 offen offset:1024 sc1
    v_mfma_f32_16x16x32_bf16 v[244:247], v[140:143], v[148:151], v[244:247]
    ds_read_b64_tr_b16 v[174:175], v19 offset:12288
    s_waitcnt lgkmcnt(4)
    v_mfma_f32_16x16x32_bf16 v[192:195], v[160:163], v[176:179], v[192:195]
    ds_read_b64_tr_b16 v[128:129], v22 offset:0
    ds_read_b64_tr_b16 v[130:131], v22 offset:4096
    v_mfma_f32_16x16x32_bf16 v[196:199], v[160:163], v[180:183], v[196:199]
    ds_read_b128 v[144:147], v20 offset:0
    ds_read_b64_tr_b16 v[132:133], v23 offset:0
    v_mfma_f32_16x16x32_bf16 v[208:211], v[164:167], v[176:179], v[208:211]
    ds_read_b64_tr_b16 v[134:135], v23 offset:4096
    v_mfma_f32_16x16x32_bf16 v[212:215], v[164:167], v[180:183], v[212:215]
    ds_read_b128 v[148:151], v20 offset:2048
    s_waitcnt lgkmcnt(6)
    v_mfma_f32_16x16x32_bf16 v[224:227], v[168:171], v[176:179], v[224:227]
    ds_read_b64_tr_b16 v[136:137], v24 offset:0
    v_mfma_f32_16x16x32_bf16 v[228:231], v[168:171], v[180:183], v[228:231]
    ds_read_b64_tr_b16 v[138:139], v24 offset:4096
    v_mfma_f32_16x16x32_bf16 v[240:243], v[172:175], v[176:179], v[240:243]
    ds_read_b64_tr_b16 v[140:141], v25 offset:0
    v_cvt_pk_bf16_f32 v80, v204, v205
    v_cvt_pk_bf16_f32 v81, v206, v207
    v_cvt_pk_bf16_f32 v82, v220, v221
    v_cvt_pk_bf16_f32 v83, v222, v223
    buffer_store_dwordx4 v[80:83], v55, s[20:23], s44 offen offset:2048 sc1
    v_mfma_f32_16x16x32_bf16 v[244:247], v[172:175], v[180:183], v[244:247]
    ds_read_b64_tr_b16 v[142:143], v25 offset:4096
    s_waitcnt lgkmcnt(4)
    v_mfma_f32_16x16x32_bf16 v[192:195], v[128:131], v[144:147], v[192:195]
    ds_read_b64_tr_b16 v[160:161], v22 offset:8192
    ds_read_b64_tr_b16 v[162:163], v22 offset:12288
    v_mfma_f32_16x16x32_bf16 v[196:199], v[128:131], v[148:151], v[196:199]
    ds_read_b128 v[176:179], v20 offset:1024
    ds_read_b64_tr_b16 v[164:165], v23 offset:8192
    v_mfma_f32_16x16x32_bf16 v[208:211], v[132:135], v[144:147], v[208:211]
    ds_read_b64_tr_b16 v[166:167], v23 offset:12288
    v_mfma_f32_16x16x32_bf16 v[212:215], v[132:135], v[148:151], v[212:215]
    ds_read_b128 v[180:183], v20 offset:3072
    s_waitcnt lgkmcnt(6)
    v_mfma_f32_16x16x32_bf16 v[224:227], v[136:139], v[144:147], v[224:227]
    ds_read_b64_tr_b16 v[168:169], v24 offset:8192
    v_mfma_f32_16x16x32_bf16 v[228:231], v[136:139], v[148:151], v[228:231]
    ds_read_b64_tr_b16 v[170:171], v24 offset:12288
    v_mfma_f32_16x16x32_bf16 v[240:243], v[140:143], v[144:147], v[240:243]
    ds_read_b64_tr_b16 v[172:173], v25 offset:8192
    v_cvt_pk_bf16_f32 v84, v236, v237
    v_cvt_pk_bf16_f32 v85, v238, v239
    v_cvt_pk_bf16_f32 v86, v252, v253
    v_cvt_pk_bf16_f32 v87, v254, v255
    buffer_store_dwordx4 v[84:87], v55, s[20:23], s44 offen offset:3072 sc1
    v_mfma_f32_16x16x32_bf16 v[244:247], v[140:143], v[148:151], v[244:247]
    ds_read_b64_tr_b16 v[174:175], v25 offset:12288
    s_waitcnt lgkmcnt(4)
    v_mfma_f32_16x16x32_bf16 v[192:195], v[160:163], v[176:179], v[192:195]
    v_mfma_f32_16x16x32_bf16 v[196:199], v[160:163], v[180:183], v[196:199]
    v_mfma_f32_16x16x32_bf16 v[208:211], v[164:167], v[176:179], v[208:211]
    v_mfma_f32_16x16x32_bf16 v[212:215], v[164:167], v[180:183], v[212:215]
    s_waitcnt lgkmcnt(0)
    v_mfma_f32_16x16x32_bf16 v[224:227], v[168:171], v[176:179], v[224:227]
    v_mfma_f32_16x16x32_bf16 v[228:231], v[168:171], v[180:183], v[228:231]
    v_mfma_f32_16x16x32_bf16 v[240:243], v[172:175], v[176:179], v[240:243]
    v_mfma_f32_16x16x32_bf16 v[244:247], v[172:175], v[180:183], v[244:247]
    s_nop 7
    s_barrier
    buffer_load_dwordx4 v[128:131], v55, s[20:23], s47 offen offset:0 sc1
    buffer_load_dwordx4 v[132:135], v55, s[20:23], s47 offen offset:1024 sc1
    buffer_load_dwordx4 v[136:139], v55, s[20:23], s47 offen offset:2048 sc1
    buffer_load_dwordx4 v[140:143], v55, s[20:23], s47 offen offset:3072 sc1
    ds_read_b64 v[96:97], v48 offset:0
    ds_read_b64_tr_b16 v[112:113], v52 offset:0
    ds_read_b64 v[98:99], v49 offset:0
    ds_read_b64_tr_b16 v[114:115], v52 offset:2048
    ds_read_b64 v[100:101], v50 offset:0
    ds_read_b64_tr_b16 v[116:117], v52 offset:4096
    ds_read_b64 v[102:103], v51 offset:0
    ds_read_b64_tr_b16 v[118:119], v52 offset:6144
    ds_read_b64 v[104:105], v48 offset:4096
    ds_read_b64_tr_b16 v[120:121], v53 offset:0
    ds_read_b64 v[106:107], v49 offset:4096
    ds_read_b64_tr_b16 v[122:123], v53 offset:2048
    ds_read_b64 v[108:109], v50 offset:4096
    ds_read_b64_tr_b16 v[124:125], v53 offset:4096
    ds_read_b64 v[110:111], v51 offset:4096
    ds_read_b64_tr_b16 v[126:127], v53 offset:6144
    s_waitcnt lgkmcnt(0)
    v_lshlrev_b32 v160, 16, v96
    v_and_b32 v161, 0xffff0000, v96
    v_lshlrev_b32 v162, 16, v97
    v_and_b32 v163, 0xffff0000, v97
    v_lshlrev_b32 v68, 16, v112
    v_and_b32 v69, 0xffff0000, v112
    v_lshlrev_b32 v70, 16, v113
    v_and_b32 v71, 0xffff0000, v113
    v_fma_f32 v64, v160, v42, v46
    v_fma_f32 v65, v161, v42, v46
    v_fma_f32 v66, v162, v42, v46
    v_fma_f32 v67, v163, v42, v46
    v_pk_fma_f32 v[160:161], v[64:65], v[68:69], v[160:161]
    v_pk_fma_f32 v[162:163], v[66:67], v[70:71], v[162:163]
    v_lshlrev_b32 v164, 16, v98
    v_and_b32 v165, 0xffff0000, v98
    v_lshlrev_b32 v166, 16, v99
    v_and_b32 v167, 0xffff0000, v99
    v_lshlrev_b32 v68, 16, v114
    v_and_b32 v69, 0xffff0000, v114
    v_lshlrev_b32 v70, 16, v115
    v_and_b32 v71, 0xffff0000, v115
    v_fma_f32 v64, v164, v42, v46
    v_fma_f32 v65, v165, v42, v46
    v_fma_f32 v66, v166, v42, v46
    v_fma_f32 v67, v167, v42, v46
    v_pk_fma_f32 v[164:165], v[64:65], v[68:69], v[164:165]
    v_pk_fma_f32 v[166:167], v[66:67], v[70:71], v[166:167]
    v_lshlrev_b32 v168, 16, v100
    v_and_b32 v169, 0xffff0000, v100
    v_lshlrev_b32 v170, 16, v101
    v_and_b32 v171, 0xffff0000, v101
    v_lshlrev_b32 v68, 16, v116
    v_and_b32 v69, 0xffff0000, v116
    v_lshlrev_b32 v70, 16, v117
    v_and_b32 v71, 0xffff0000, v117
    v_fma_f32 v64, v168, v42, v46
    v_fma_f32 v65, v169, v42, v46
    v_fma_f32 v66, v170, v42, v46
    v_fma_f32 v67, v171, v42, v46
    v_pk_fma_f32 v[168:169], v[64:65], v[68:69], v[168:169]
    v_pk_fma_f32 v[170:171], v[66:67], v[70:71], v[170:171]
    v_lshlrev_b32 v172, 16, v102
    v_and_b32 v173, 0xffff0000, v102
    v_lshlrev_b32 v174, 16, v103
    v_and_b32 v175, 0xffff0000, v103
    v_lshlrev_b32 v68, 16, v118
    v_and_b32 v69, 0xffff0000, v118
    v_lshlrev_b32 v70, 16, v119
    v_and_b32 v71, 0xffff0000, v119
    v_fma_f32 v64, v172, v42, v46
    v_fma_f32 v65, v173, v42, v46
    v_fma_f32 v66, v174, v42, v46
    v_fma_f32 v67, v175, v42, v46
    v_pk_fma_f32 v[172:173], v[64:65], v[68:69], v[172:173]
    v_pk_fma_f32 v[174:175], v[66:67], v[70:71], v[174:175]
    v_lshlrev_b32 v176, 16, v104
    v_and_b32 v177, 0xffff0000, v104
    v_lshlrev_b32 v178, 16, v105
    v_and_b32 v179, 0xffff0000, v105
    v_lshlrev_b32 v68, 16, v120
    v_and_b32 v69, 0xffff0000, v120
    v_lshlrev_b32 v70, 16, v121
    v_and_b32 v71, 0xffff0000, v121
    v_fma_f32 v64, v176, v44, v47
    v_fma_f32 v65, v177, v44, v47
    v_fma_f32 v66, v178, v44, v47
    v_fma_f32 v67, v179, v44, v47
    v_pk_fma_f32 v[176:177], v[64:65], v[68:69], v[176:177]
    v_pk_fma_f32 v[178:179], v[66:67], v[70:71], v[178:179]
    v_lshlrev_b32 v180, 16, v106
    v_and_b32 v181, 0xffff0000, v106
    v_lshlrev_b32 v182, 16, v107
    v_and_b32 v183, 0xffff0000, v107
    v_lshlrev_b32 v68, 16, v122
    v_and_b32 v69, 0xffff0000, v122
    v_lshlrev_b32 v70, 16, v123
    v_and_b32 v71, 0xffff0000, v123
    v_fma_f32 v64, v180, v44, v47
    v_fma_f32 v65, v181, v44, v47
    v_fma_f32 v66, v182, v44, v47
    v_fma_f32 v67, v183, v44, v47
    v_pk_fma_f32 v[180:181], v[64:65], v[68:69], v[180:181]
    v_pk_fma_f32 v[182:183], v[66:67], v[70:71], v[182:183]
    v_lshlrev_b32 v184, 16, v108
    v_and_b32 v185, 0xffff0000, v108
    v_lshlrev_b32 v186, 16, v109
    v_and_b32 v187, 0xffff0000, v109
    v_lshlrev_b32 v68, 16, v124
    v_and_b32 v69, 0xffff0000, v124
    v_lshlrev_b32 v70, 16, v125
    v_and_b32 v71, 0xffff0000, v125
    v_fma_f32 v64, v184, v44, v47
    v_fma_f32 v65, v185, v44, v47
    v_fma_f32 v66, v186, v44, v47
    v_fma_f32 v67, v187, v44, v47
    v_pk_fma_f32 v[184:185], v[64:65], v[68:69], v[184:185]
    v_pk_fma_f32 v[186:187], v[66:67], v[70:71], v[186:187]
    v_lshlrev_b32 v188, 16, v110
    v_and_b32 v189, 0xffff0000, v110
    v_lshlrev_b32 v190, 16, v111
    v_and_b32 v191, 0xffff0000, v111
    v_lshlrev_b32 v68, 16, v126
    v_and_b32 v69, 0xffff0000, v126
    v_lshlrev_b32 v70, 16, v127
    v_and_b32 v71, 0xffff0000, v127
    v_fma_f32 v64, v188, v44, v47
    v_fma_f32 v65, v189, v44, v47
    v_fma_f32 v66, v190, v44, v47
    v_fma_f32 v67, v191, v44, v47
    v_pk_fma_f32 v[188:189], v[64:65], v[68:69], v[188:189]
    v_pk_fma_f32 v[190:191], v[66:67], v[70:71], v[190:191]
    s_mov_b32 s54, 0
L_ppoll:
    s_waitcnt vmcnt(0)
    v_max3_u32 v56, v128, v129, v130
    v_max3_u32 v56, v56, v131, v132
    v_max3_u32 v56, v56, v133, v134
    v_max3_u32 v56, v56, v135, v136
    v_max3_u32 v56, v56, v137, v138
    v_max3_u32 v56, v56, v139, v140
    v_max3_u32 v56, v56, v141, v142
    v_max_u32 v56, v56, v143
    v_cmp_eq_u32 vcc, -1, v56
    s_nop 3
    s_cbranch_vccz L_pgot
    buffer_load_dwordx4 v[128:131], v55, s[20:23], s47 offen offset:0 sc1
    buffer_load_dwordx4 v[132:135], v55, s[20:23], s47 offen offset:1024 sc1
    buffer_load_dwordx4 v[136:139], v55, s[20:23], s47 offen offset:2048 sc1
    buffer_load_dwordx4 v[140:143], v55, s[20:23], s47 offen offset:3072 sc1
    s_add_u32 s54, s54, 1
    s_cmp_lt_u32 s54, 0x20000
    s_cbranch_scc1 L_ppoll
    s_waitcnt vmcnt(0)
L_pgot:
    v_lshlrev_b32 v64, 16, v128
    v_and_b32 v65, 0xffff0000, v128
    v_lshlrev_b32 v66, 16, v129
    v_and_b32 v67, 0xffff0000, v129
    v_pk_add_f32 v[192:193], v[192:193], v[64:65]
    v_pk_add_f32 v[194:195], v[194:195], v[66:67]
    v_pk_fma_f32 v[192:193], v[192:193], v[42:43], v[160:161] op_sel_hi:[1,0,1]
    v_pk_fma_f32 v[194:195], v[194:195], v[42:43], v[162:163] op_sel_hi:[1,0,1]
    v_cvt_pk_bf16_f32 v56, v192, v193
    v_cvt_pk_bf16_f32 v57, v194, v195
    v_lshlrev_b32 v64, 16, v130
    v_and_b32 v65, 0xffff0000, v130
    v_lshlrev_b32 v66, 16, v131
    v_and_b32 v67, 0xffff0000, v131
    v_pk_add_f32 v[208:209], v[208:209], v[64:65]
    v_pk_add_f32 v[210:211], v[210:211], v[66:67]
    v_pk_fma_f32 v[208:209], v[208:209], v[42:43], v[164:165] op_sel_hi:[1,0,1]
    v_pk_fma_f32 v[210:211], v[210:211], v[42:43], v[166:167] op_sel_hi:[1,0,1]
    v_cvt_pk_bf16_f32 v58, v208, v209
    v_cvt_pk_bf16_f32 v59, v210, v211
    s_nop 1
    v_permlane16_swap_b32 v56, v58
    v_permlane16_swap_b32 v57, v59
    s_mov_b32 s42, 0
    buffer_store_dwordx4 v[56:59], v54, s[32:35], s42 offen offset:0 nt
    v_lshlrev_b32 v64, 16, v132
    v_and_b32 v65, 0xffff0000, v132
    v_lshlrev_b32 v66, 16, v133
    v_and_b32 v67, 0xffff0000, v133
    v_pk_add_f32 v[224:225], v[224:225], v[64:65]
    v_pk_add_f32 v[226:227], v[226:227], v[66:67]
    v_pk_fma_f32 v[224:225], v[224:225], v[42:43], v[168:169] op_sel_hi:[1,0,1]
    v_pk_fma_f32 v[226:227], v[226:227], v[42:43], v[170:171] op_sel_hi:[1,0,1]
    v_cvt_pk_bf16_f32 v60, v224, v225
    v_cvt_pk_bf16_f32 v61, v226, v227
    v_lshlrev_b32 v64, 16, v134
    v_and_b32 v65, 0xffff0000, v134
    v_lshlrev_b32 v66, 16, v135
    v_and_b32 v67, 0xffff0000, v135
    v_pk_add_f32 v[240:241], v[240:241], v[64:65]
    v_pk_add_f32 v[242:243], v[242:243], v[66:67]
    v_pk_fma_f32 v[240:241], v[240:241], v[42:43], v[172:173] op_sel_hi:[1,0,1]
    v_pk_fma_f32 v[242:243], v[242:243], v[42:43], v[174:175] op_sel_hi:[1,0,1]
    v_cvt_pk_bf16_f32 v62, v240, v241
    v_cvt_pk_bf16_f32 v63, v242, v243
    s_nop 1
    v_permlane16_swap_b32 v60, v62
    v_permlane16_swap_b32 v61, v63
    s_mov_b32 s42, 0
    buffer_store_dwordx4 v[60:63], v54, s[32:35], s42 offen offset:64 nt
    v_lshlrev_b32 v64, 16, v136
    v_and_b32 v65, 0xffff0000, v136
    v_lshlrev_b32 v66, 16, v137
    v_and_b32 v67, 0xffff0000, v137
    v_pk_add_f32 v[196:197], v[196:197], v[64:65]
    v_pk_add_f32 v[198:199], v[198:199], v[66:67]
    v_pk_fma_f32 v[196:197], v[196:197], v[44:45], v[176:177] op_sel_hi:[1,0,1]
    v_pk_fma_f32 v[198:199], v[198:199], v[44:45], v[178:179] op_sel_hi:[1,0,1]
    v_cvt_pk_bf16_f32 v56, v196, v197
    v_cvt_pk_bf16_f32 v57, v198, v199
    v_lshlrev_b32 v64, 16, v138
    v_and_b32 v65, 0xffff0000, v138
    v_lshlrev_b32 v66, 16, v139
    v_and_b32 v67, 0xffff0000, v139
    v_pk_add_f32 v[212:213], v[212:213], v[64:65]
    v_pk_add_f32 v[214:215], v[214:215], v[66:67]
    v_pk_fma_f32 v[212:213], v[212:213], v[44:45], v[180:181] op_sel_hi:[1,0,1]
    v_pk_fma_f32 v[214:215], v[214:215], v[44:45], v[182:183] op_sel_hi:[1,0,1]
    v_cvt_pk_bf16_f32 v58, v212, v213
    v_cvt_pk_bf16_f32 v59, v214, v215
    s_nop 1
    v_permlane16_swap_b32 v56, v58
    v_permlane16_swap_b32 v57, v59
    s_mov_b32 s42, 32768
    buffer_store_dwordx4 v[56:59], v54, s[32:35], s42 offen offset:0 nt
    v_lshlrev_b32 v64, 16, v140
    v_and_b32 v65, 0xffff0000, v140
    v_lshlrev_b32 v66, 16, v141
    v_and_b32 v67, 0xffff0000, v141
    v_pk_add_f32 v[228:229], v[228:229], v[64:65]
    v_pk_add_f32 v[230:231], v[230:231], v[66:67]
    v_pk_fma_f32 v[228:229], v[228:229], v[44:45], v[184:185] op_sel_hi:[1,0,1]
    v_pk_fma_f32 v[230:231], v[230:231], v[44:45], v[186:187] op_sel_hi:[1,0,1]
    v_cvt_pk_bf16_f32 v60, v228, v229
    v_cvt_pk_bf16_f32 v61, v230, v231
    v_lshlrev_b32 v64, 16, v142
    v_and_b32 v65, 0xffff0000, v142
    v_lshlrev_b32 v66, 16, v143
    v_and_b32 v67, 0xffff0000, v143
    v_pk_add_f32 v[244:245], v[244:245], v[64:65]
    v_pk_add_f32 v[246:247], v[246:247], v[66:67]
    v_pk_fma_f32 v[244:245], v[244:245], v[44:45], v[188:189] op_sel_hi:[1,0,1]
    v_pk_fma_f32 v[246:247], v[246:247], v[44:45], v[190:191] op_sel_hi:[1,0,1]
    v_cvt_pk_bf16_f32 v62, v244, v245
    v_cvt_pk_bf16_f32 v63, v246, v247
    s_nop 1
    v_permlane16_swap_b32 v60, v62
    v_permlane16_swap_b32 v61, v63
    s_mov_b32 s42, 32768
    buffer_store_dwordx4 v[60:63], v54, s[32:35], s42 offen offset:64 nt
    s_waitcnt vmcnt(0)
L_fin:
    s_waitcnt vmcnt(0) lgkmcnt(0)
L_end:
    s_endpgm
L_codeend:
.fill 64, 4, 0xbf800000
.section .rodata,"a"
.p2align 6
.amdhsa_kernel parallel_sum__ssm_conv_h3__dense_activation_relu__prompt_kernel
  .amdhsa_next_free_vgpr 256
  .amdhsa_next_free_sgpr 102
  .amdhsa_accum_offset 256
  .amdhsa_float_denorm_mode_32 3
  .amdhsa_group_segment_fixed_size 0
  .amdhsa_kernarg_size 96
  .amdhsa_user_sgpr_count 2
  .amdhsa_user_sgpr_kernarg_segment_ptr 1
  .amdhsa_system_sgpr_workgroup_id_x 1
.end_amdhsa_kernel
.text
```
